```python
import torch

def _softmax(x, axis=-1):
    return torch.softmax(x, dim=axis)

def _gelu(x):
    return torch.nn.functional.gelu(x, approximate='tanh')

def _silu(x):
    return torch.nn.functional.silu(x)

def _sigmoid(x):
    return torch.sigmoid(x)

def _layernorm(x, axis=-1, eps=1e-05):
    m = x.mean(dim=axis, keepdim=True)
    v = x.var(dim=axis, keepdim=True, unbiased=False)
    return (x - m) / torch.sqrt(v + eps)

def _scatter_add(tgt, idx, src, axis=0):
    return tgt.clone().index_add_(axis, idx, src)

def _segment_sum(src, seg, n):
    out = torch.zeros((n,) + src.shape[1:], dtype=src.dtype)
    return out.index_add_(0, seg, src)

def _pad(x, pw):
    flat = tuple((v for pair in reversed(pw) for v in pair))
    return torch.nn.functional.pad(x, flat)
kernel_name = 'gated_mix__sliding_local_dilated__mixer_gmlp__prompt'

def setup_inputs():

    _w = lambda a: (lambda t: t.to(torch.bfloat16) if t.is_floating_point() else t)(torch.as_tensor(a))

    def _A_setup():
        B, S, D = (1, 2048, 448)
        return {'x': _w((lambda *s: torch.randn(*s, dtype=torch.bfloat16) * 0.05)(B, S, D)), 'wqkv': _w((lambda *s: torch.randn(*s, dtype=torch.bfloat16) * 1.6)(D, 3 * D)), 'wo': _w((lambda *s: torch.randn(*s, dtype=torch.bfloat16) * 0.05)(D, D))}
    _A_in = _A_setup()

    def _B_setup():
        B, S, D, F = (1, 2048, 448, 1792)
        Fh = F // 2
        return {'x': _w((lambda *s: torch.randn(*s, dtype=torch.bfloat16) * 0.05)(B, S, D)), 'w_in': _w((lambda *s: torch.randn(*s, dtype=torch.bfloat16) * 0.4)(D, 2 * Fh)), 'w_sp': _w(0.01 * (lambda *s: torch.randn(*s, dtype=torch.bfloat16) * 0.4)(S, S)), 'b_sp': _w(1.0 + 0.01 * (lambda *s: torch.randn(*s, dtype=torch.bfloat16) * 0.2)(S)), 'w_out': _w((lambda *s: torch.randn(*s, dtype=torch.bfloat16) * 0.2)(Fh, D))}
    _B_in = _B_setup()
    return {'A_x': _A_in['x'], 'A_wqkv': _A_in['wqkv'], 'A_wo': _A_in['wo'], 'B_x': _B_in['x'], 'B_w_in': _B_in['w_in'], 'B_w_sp': _B_in['w_sp'], 'B_b_sp': _B_in['b_sp'], 'B_w_out': _B_in['w_out'], 'gate_w': _w((lambda *s: torch.randn(*s, dtype=torch.bfloat16) * 0.05)(448) * 16.0)}

def reference(A_x, A_wqkv, A_wo, B_x, B_w_in, B_w_sp, B_b_sp, B_w_out, gate_w):

    def _A_ref(x, wqkv, wo):
        B, S, D = x.shape
        H = 16
        Dh = D // H
        W, dil = (8, 2)
        qkv = (lambda x, *d: x.permute(*d))((x @ wqkv).reshape(B, S, 3, H, Dh), 2, 0, 3, 1, 4)
        q, k, v = (qkv[0], qkv[1], qkv[2])
        scale = Dh ** (-0.5)
        pos = torch.arange(S)
        off = torch.arange(W) * dil
        idx = pos[:, None] - off[None, :]
        mask = idx >= 0
        idx_c = torch.where(mask, idx, 0).reshape(-1)
        kg = k[:, :, idx_c, :].reshape(B, H, S, W, Dh)
        vg = v[:, :, idx_c, :].reshape(B, H, S, W, Dh)
        logits = torch.einsum('bhsd,bhswd->bhsw', q, kg) * scale
        logits = torch.where(mask[None, None, :, :], logits, -1000000000.0)
        attn = _softmax(logits, axis=-1)
        o = torch.einsum('bhsw,bhswd->bhsd', attn, vg)
        return (lambda x, *d: x.permute(*d))(o, 0, 2, 1, 3).reshape(B, S, D) @ wo

    def _B_ref(x, w_in, w_sp, b_sp, w_out):
        B, S, D = x.shape
        F = w_in.shape[-1]
        Fh = F // 2
        z = _gelu(torch.einsum('bsd,df->bsf', x, w_in))
        z1 = z[..., :Fh].clone()
        z2 = _layernorm(z[..., Fh:], axis=-1)
        g = torch.einsum('ts,bsf->btf', w_sp, z2) + b_sp[None, :, None]
        return torch.einsum('bsf,fd->bsd', z1 * g, w_out)
    x = A_x
    g = _sigmoid((x * gate_w).sum(-1, keepdims=True))
    a = _A_ref(x, A_wqkv, A_wo)
    b = _B_ref(x, B_w_in, B_w_sp, B_b_sp, B_w_out)
    return g * a + (1 - g) * b
```

```asm
; @launch grid=(256,1,1) block=(256,1,1) lds=163840
.amdgcn_target "amdgcn-amd-amdhsa--gfx950"
.text
.globl gated_mix__sliding_local_dilated__mixer_gmlp__prompt_kernel
.p2align 8
.type gated_mix__sliding_local_dilated__mixer_gmlp__prompt_kernel,@function
.set CODE_BYTES, .Lcode_end - gated_mix__sliding_local_dilated__mixer_gmlp__prompt_kernel - 64
gated_mix__sliding_local_dilated__mixer_gmlp__prompt_kernel:
  s_cmp_ge_u32 s2, 256
  s_cbranch_scc1 L_end
  s_load_dwordx16 s[64:79], s[0:1], 0
  s_load_dwordx8 s[80:87], s[0:1], 64
  s_getpc_b64 s[46:47]
  s_lshr_b32 s44, s2, 3
  s_lshl_b32 s44, s44, 12
  v_lshlrev_b32 v2, 4, v0
  v_add_u32 v2, s44, v2
  v_min_u32 v2, CODE_BYTES, v2
  global_load_dwordx4 v[28:31], v2, s[46:47]
  s_and_b32 s60, s2, 7
  s_lshr_b32 s61, s2, 3
  s_lshr_b32 s62, s60, 1
  s_lshl_b32 s62, s62, 3
  s_and_b32 s60, s60, 1
  s_lshl_b32 s60, s60, 2
  s_mul_i32 s63, s61, 43
  s_lshr_b32 s63, s63, 7
  s_add_u32 s53, s62, s63
  s_mul_i32 s63, s63, 3
  s_sub_u32 s54, s61, s63
  s_add_u32 s54, s54, s60
  s_add_u32 s62, s62, s60
  s_add_u32 s62, s62, s61
  s_sub_u32 s63, s62, 24
  s_cmp_ge_u32 s61, 24
  s_cselect_b32 s53, s63, s53
  s_cselect_b32 s54, 3, s54
  s_sub_u32 s63, s62, 28
  s_cmp_ge_u32 s61, 28
  s_cselect_b32 s53, s63, s53
  s_cselect_b32 s54, 7, s54
  v_lshrrev_b32 v1, 6, v0
  v_and_b32 v2, 63, v0
  v_readfirstlane_b32 s52, v1
  s_lshr_b32 s56, s52, 1
  s_and_b32 s57, s52, 1
  s_lshl_b32 s58, s52, 10
  s_lshl_b32 s59, s52, 11
  s_lshl_b32 s3, s52, 13
  v_lshrrev_b32 v5, 5, v2
  v_bfe_u32 v6, v2, 3, 2
  v_lshl_add_u32 v34, v5, 3, v6
  v_lshrrev_b32 v5, 3, v2
  v_xor_b32 v5, v5, v2
  v_and_b32 v5, 7, v5
  v_lshlrev_b32 v35, 4, v5
  v_mul_u32_u24 v36, 896, v34
  v_add_u32 v36, v36, v35
  v_bfe_u32 v5, v2, 3, 2
  v_lshrrev_b32 v6, 5, v2
  v_lshl_add_u32 v37, v6, 3, v5
  v_lshrrev_b32 v5, 1, v5
  v_lshl_or_b32 v5, v6, 1, v5
  v_lshlrev_b32 v5, 1, v5
  v_xor_b32 v5, v5, v2
  v_and_b32 v5, 7, v5
  v_lshlrev_b32 v8, 4, v5
  v_mul_u32_u24 v38, 3584, v37
  v_add_u32 v38, v38, v8
  v_lshrrev_b32 v3, 4, v2
  v_and_b32 v4, 15, v2
  v_bfe_u32 v32, v2, 2, 2
  v_and_b32 v33, 3, v2
  s_lshl_b32 s60, s53, 6
  s_lshl_b32 s61, s56, 5
  s_add_u32 s60, s60, s61
  s_lshl_b32 s61, s57, 2
  s_add_u32 s60, s60, s61
  s_mul_i32 s88, s60, 896
  s_add_u32 s89, s88, 14336
  s_waitcnt lgkmcnt(0)
  s_mov_b32 s4, s64
  s_and_b32 s5, s65, 0xffff
  s_mov_b32 s6, 1835008
  s_mov_b32 s7, 0x20000
  s_mov_b32 s20, s86
  s_and_b32 s21, s87, 0xffff
  s_mov_b32 s22, 67108864
  s_mov_b32 s23, 0x20000
  s_cmp_eq_u32 s54, 7
  s_cbranch_scc1 L_spare
  s_add_u32 m0, s59, 0
  s_nop 0
  buffer_load_dwordx4 v36, s[4:7], s88 offen offset:0 lds
  s_add_u32 m0, s59, 1024
  s_nop 0
  buffer_load_dwordx4 v36, s[4:7], s89 offen offset:0 lds
  s_mov_b32 s8, s72
  s_and_b32 s9, s73, 0xffff
  s_mov_b32 s10, 1605632
  s_mov_b32 s11, 0x20000
  s_lshl_b32 s60, s56, 4
  s_lshl_b32 s61, s57, 2
  s_add_u32 s60, s60, s61
  s_mul_i32 s91, s60, 3584
  s_lshl_b32 s62, s54, 8
  s_add_u32 s91, s91, s62
  s_add_u32 s90, s91, 1792
  s_mul_i32 s92, s60, 2688
  s_mul_i32 s62, s54, 384
  s_add_u32 s92, s92, s62
  s_load_dword s55, s[86:87], 0
  s_add_u32 m0, s59, 8064
  s_mov_b32 s12, s66
  buffer_load_dwordx4 v36, s[4:7], s88 offen offset:128 lds
  s_and_b32 s13, s67, 0xffff
  s_mov_b32 s14, 1204224
  s_mov_b32 s15, 0x20000
  s_mov_b32 s40, s80
  s_and_b32 s41, s81, 0xffff
  s_mov_b32 s42, 896
  s_mov_b32 s43, 0x20000
  s_mov_b32 s16, s74
  s_and_b32 s17, s75, 0xffff
  s_mov_b32 s18, 8388608
  s_mov_b32 s19, 0x20000
  s_mov_b32 s36, s76
  s_and_b32 s37, s77, 0xffff
  s_mov_b32 s38, 4096
  s_mov_b32 s39, 0x20000
  s_add_u32 m0, s59, 9088
  s_mov_b32 s24, s68
  buffer_load_dwordx4 v36, s[4:7], s89 offen offset:128 lds
  s_and_b32 s25, s69, 0xffff
  s_mov_b32 s26, 401408
  s_mov_b32 s27, 0x20000
  s_mov_b32 s28, s78
  s_and_b32 s29, s79, 0xffff
  s_mov_b32 s30, 802816
  s_mov_b32 s31, 0x20000
  s_mov_b32 s32, s82
  s_and_b32 s33, s83, 0xffff
  s_mov_b32 s34, 1835008
  s_mov_b32 s35, 0x20000
  v_mul_u32_u24 v39, 2688, v37
  v_add_u32 v39, v39, v8
  v_lshlrev_b32 v9, 4, v2
  s_add_u32 m0, s59, 16128
  s_mov_b32 s93, 0
  buffer_load_dwordx4 v36, s[4:7], s88 offen offset:256 lds
  v_and_b32 v5, 7, v4
  v_xor_b32 v5, v5, v3
  v_lshlrev_b32 v5, 4, v5
  v_lshl_add_u32 v40, v4, 7, v5
  s_lshl_b32 s60, s56, 12
  v_add_u32 v40, s60, v40
  v_xor_b32 v41, 64, v40
  v_and_b32 v5, 1, v3
  v_lshrrev_b32 v6, 1, v32
  v_lshl_or_b32 v6, v5, 1, v6
  v_lshlrev_b32 v5, 9, v5
  s_add_u32 m0, s59, 17152
  v_lshl_add_u32 v5, v32, 7, v5
  buffer_load_dwordx4 v36, s[4:7], s89 offen offset:256 lds
  v_lshrrev_b32 v7, 1, v3
  v_lshl_add_u32 v5, v7, 11, v5
  v_lshl_add_u32 v5, v33, 3, v5
  v_xor_b32 v7, 0, v6
  v_lshl_add_u32 v10, v7, 5, v5
  v_xor_b32 v7, 1, v6
  v_lshl_add_u32 v11, v7, 5, v5
  v_xor_b32 v7, 2, v6
  v_lshl_add_u32 v12, v7, 5, v5
  v_xor_b32 v7, 3, v6
  s_add_u32 m0, s59, 24192
  v_lshl_add_u32 v13, v7, 5, v5
  buffer_load_dwordx4 v36, s[4:7], s88 offen offset:384 lds
  s_lshl_b32 s60, s57, 12
  s_add_u32 s60, s60, 0
  v_add_u32 v47, s60, v10
  v_add_u32 v48, s60, v11
  v_add_u32 v49, s60, v12
  v_add_u32 v50, s60, v13
  s_lshl_b32 s60, s57, 12
  s_add_u32 s60, s60, 57344
  v_add_u32 v51, s60, v10
  v_add_u32 v52, s60, v11
  v_add_u32 v53, s60, v12
  v_add_u32 v54, s60, v13
  s_add_u32 m0, s59, 25216
  s_lshl_b32 s60, s57, 12
  buffer_load_dwordx4 v36, s[4:7], s89 offen offset:384 lds
  s_add_u32 s60, s60, 122880
  v_add_u32 v55, s60, v10
  v_add_u32 v56, s60, v11
  v_add_u32 v57, s60, v12
  v_add_u32 v58, s60, v13
  v_mov_b32 v60, 3222493025
  v_mov_b32 v61, 3222493025
  s_mov_b32 s68, 3184710632
  s_mov_b32 s69, 3184710632
  s_mov_b32 s70, 1.0
  s_mov_b32 s71, 1.0
  s_add_u32 m0, s59, 32256
  s_nop 0
  buffer_load_dwordx4 v36, s[4:7], s88 offen offset:512 lds
  s_add_u32 m0, s59, 33280
  s_nop 0
  buffer_load_dwordx4 v36, s[4:7], s89 offen offset:512 lds
  s_add_u32 m0, s59, 40320
  s_nop 0
  buffer_load_dwordx4 v36, s[4:7], s88 offen offset:640 lds
  s_add_u32 m0, s59, 41344
  s_nop 0
  buffer_load_dwordx4 v36, s[4:7], s89 offen offset:640 lds
  s_add_u32 m0, s59, 48384
  s_nop 0
  buffer_load_dwordx4 v36, s[4:7], s88 offen offset:768 lds
  s_add_u32 m0, s59, 49408
  s_nop 0
  buffer_load_dwordx4 v36, s[4:7], s89 offen offset:768 lds
  s_add_u32 m0, s58, 57344
  s_nop 0
  buffer_load_dwordx4 v38, s[8:11], s90 offen offset:0 lds
  s_add_u32 m0, s58, 61312
  s_nop 0
  buffer_load_dwordx4 v38, s[8:11], s90 offen offset:128 lds
  s_add_u32 s90, s90, 114688
  s_add_u32 m0, s58, 65536
  s_nop 0
  buffer_load_dwordx4 v38, s[8:11], s90 offen offset:0 lds
  s_add_u32 m0, s58, 69504
  s_nop 0
  buffer_load_dwordx4 v38, s[8:11], s90 offen offset:128 lds
  s_add_u32 s90, s90, 114688
  s_add_u32 m0, s58, 73728
  s_nop 0
  buffer_load_dwordx4 v38, s[8:11], s90 offen offset:0 lds
  s_add_u32 m0, s58, 77696
  s_nop 0
  buffer_load_dwordx4 v38, s[8:11], s90 offen offset:128 lds
  s_add_u32 s90, s90, 114688
  s_add_u32 m0, s58, 81920
  s_nop 0
  buffer_load_dwordx4 v38, s[8:11], s90 offen offset:0 lds
  s_add_u32 m0, s58, 85888
  s_nop 0
  buffer_load_dwordx4 v38, s[8:11], s90 offen offset:128 lds
  s_add_u32 s90, s90, 114688
  s_add_u32 m0, s58, 90112
  s_nop 0
  buffer_load_dwordx4 v38, s[8:11], s90 offen offset:0 lds
  s_add_u32 m0, s58, 94080
  s_nop 0
  buffer_load_dwordx4 v38, s[8:11], s90 offen offset:128 lds
  s_add_u32 s90, s90, 114688
  s_add_u32 m0, s58, 98304
  s_nop 0
  buffer_load_dwordx4 v38, s[8:11], s90 offen offset:0 lds
  s_add_u32 m0, s58, 102272
  s_nop 0
  buffer_load_dwordx4 v38, s[8:11], s90 offen offset:128 lds
  s_add_u32 s90, s90, 114688
  s_waitcnt vmcnt(12)
  s_barrier
  ds_read_b128 a[144:147], v40 offset:0
  s_add_u32 m0, s58, 106496
  ds_read_b128 a[148:151], v40 offset:2048
  buffer_load_dwordx4 v38, s[8:11], s90 offen offset:0 lds
  ds_read_b128 a[152:155], v41 offset:0
  ds_read_b128 a[156:159], v41 offset:2048
  ds_read_b128 a[160:163], v40 offset:8192
  ds_read_b128 a[164:167], v40 offset:10240
  s_add_u32 m0, s58, 110464
  ds_read_b128 a[168:171], v41 offset:8192
  buffer_load_dwordx4 v38, s[8:11], s90 offen offset:128 lds
  s_add_u32 s90, s90, 114688
  ds_read_b128 a[172:175], v41 offset:10240
  ds_read_b128 a[176:179], v40 offset:16384
  ds_read_b128 a[180:183], v40 offset:18432
  ds_read_b128 a[184:187], v41 offset:16384
  s_add_u32 m0, s58, 114688
  ds_read_b128 a[188:191], v41 offset:18432
  buffer_load_dwordx4 v38, s[8:11], s90 offen offset:0 lds
  ds_read_b128 a[192:195], v40 offset:24576
  ds_read_b128 a[196:199], v40 offset:26624
  ds_read_b128 a[200:203], v41 offset:24576
  s_waitcnt lgkmcnt(14)
  ds_read_b128 a[204:207], v41 offset:26624
  s_add_u32 m0, s58, 118656
  s_waitcnt lgkmcnt(14)
  ds_read_b128 a[208:211], v40 offset:32768
  buffer_load_dwordx4 v38, s[8:11], s90 offen offset:128 lds
  s_add_u32 s90, s90, 114688
  s_waitcnt lgkmcnt(14)
  ds_read_b128 a[212:215], v40 offset:34816
  s_waitcnt lgkmcnt(14)
  ds_read_b128 a[216:219], v41 offset:32768
  s_waitcnt lgkmcnt(14)
  ds_read_b128 a[220:223], v41 offset:34816
  s_waitcnt lgkmcnt(14)
  ds_read_b128 a[224:227], v40 offset:40960
  s_add_u32 m0, s58, 122880
  s_waitcnt lgkmcnt(14)
  ds_read_b128 a[228:231], v40 offset:43008
  buffer_load_dwordx4 v38, s[8:11], s90 offen offset:0 lds
  s_waitcnt lgkmcnt(14)
  ds_read_b128 a[232:235], v41 offset:40960
  s_waitcnt lgkmcnt(14)
  ds_read_b128 a[236:239], v41 offset:43008
  s_waitcnt lgkmcnt(14)
  ds_read_b128 a[240:243], v40 offset:49152
  s_waitcnt lgkmcnt(14)
  ds_read_b128 a[244:247], v40 offset:51200
  s_add_u32 m0, s58, 126848
  s_waitcnt lgkmcnt(14)
  ds_read_b128 a[248:251], v41 offset:49152
  buffer_load_dwordx4 v38, s[8:11], s90 offen offset:128 lds
  s_add_u32 s90, s90, 114688
  s_waitcnt lgkmcnt(14)
  ds_read_b128 a[252:255], v41 offset:51200
  s_waitcnt lgkmcnt(0)
  s_mul_i32 s55, s55, 1664525
  s_add_u32 s55, s55, 1013904223
  v_mov_b32 v14, s55
  v_lshl_add_u32 v46, v34, 12, v35
  s_lshl_b32 s60, s53, 18
  s_add_u32 s60, s60, s58
  s_add_u32 s72, s60, 0
  s_add_u32 s73, s60, 65536
  s_add_u32 s74, s60, 16384
  s_add_u32 m0, s58, 131072
  s_add_u32 s75, s60, 81920
  buffer_load_dwordx4 v38, s[8:11], s90 offen offset:0 lds
  s_add_u32 s76, s60, 131072
  s_add_u32 s77, s60, 196608
  s_add_u32 s78, s60, 147456
  s_add_u32 s79, s60, 212992
  v_add_u32 v45, s3, v40
  v_add_u32 v44, s3, v41
  v_xor_b32 v43, 4096, v40
  v_add_u32 v43, s3, v43
  v_xor_b32 v42, 4096, v41
  v_add_u32 v42, s3, v42
  s_waitcnt vmcnt(15)
  s_barrier
  s_add_u32 m0, s58, 135040
  ds_read_b64_tr_b16 v[96:97], v51 offset:0
  buffer_load_dwordx4 v38, s[8:11], s90 offen offset:128 lds
  s_add_u32 s90, s90, 114688
  ds_read_b64_tr_b16 v[98:99], v51 offset:1024
  ds_read_b64_tr_b16 v[100:101], v52 offset:0
  ds_read_b64_tr_b16 v[102:103], v52 offset:1024
  ds_read_b64_tr_b16 v[104:105], v53 offset:0
  ds_read_b64_tr_b16 v[106:107], v53 offset:1024
  ds_read_b64_tr_b16 v[108:109], v54 offset:0
  ds_read_b64_tr_b16 v[110:111], v54 offset:1024
  s_waitcnt lgkmcnt(6)
  v_mfma_f32_16x16x32_bf16 v[64:67], a[144:147], v[96:99], 0
  ds_read_b64_tr_b16 v[112:113], v51 offset:8192
  v_mfma_f32_16x16x32_bf16 v[80:83], a[148:151], v[96:99], 0
  s_add_u32 m0, s58, 139264
  ds_read_b64_tr_b16 v[114:115], v51 offset:9216
  buffer_load_dwordx4 v38, s[8:11], s90 offen offset:0 lds
  s_waitcnt lgkmcnt(6)
  v_mfma_f32_16x16x32_bf16 v[68:71], a[144:147], v[100:103], 0
  ds_read_b64_tr_b16 v[116:117], v52 offset:8192
  v_mfma_f32_16x16x32_bf16 v[84:87], a[148:151], v[100:103], 0
  ds_read_b64_tr_b16 v[118:119], v52 offset:9216
  s_waitcnt lgkmcnt(6)
  v_mfma_f32_16x16x32_bf16 v[72:75], a[144:147], v[104:107], 0
  ds_read_b64_tr_b16 v[120:121], v53 offset:8192
  v_mfma_f32_16x16x32_bf16 v[88:91], a[148:151], v[104:107], 0
  s_add_u32 m0, s58, 143232
  ds_read_b64_tr_b16 v[122:123], v53 offset:9216
  buffer_load_dwordx4 v38, s[8:11], s90 offen offset:128 lds
  s_add_u32 s90, s90, 114688
  s_waitcnt lgkmcnt(6)
  v_mfma_f32_16x16x32_bf16 v[76:79], a[144:147], v[108:111], 0
  ds_read_b64_tr_b16 v[124:125], v54 offset:8192
  v_mfma_f32_16x16x32_bf16 v[92:95], a[148:151], v[108:111], 0
  ds_read_b64_tr_b16 v[126:127], v54 offset:9216
  s_waitcnt vmcnt(14)
  s_barrier
  s_add_u32 m0, s58, 147456
  s_waitcnt lgkmcnt(6)
  v_mfma_f32_16x16x32_bf16 v[64:67], a[152:155], v[112:115], v[64:67]
  buffer_load_dwordx4 v38, s[8:11], s90 offen offset:0 lds
  ds_read_b64_tr_b16 v[96:97], v51 offset:16384
  v_mfma_f32_16x16x32_bf16 v[80:83], a[156:159], v[112:115], v[80:83]
  ds_read_b64_tr_b16 v[98:99], v51 offset:17408
  s_waitcnt lgkmcnt(6)
  v_mfma_f32_16x16x32_bf16 v[68:71], a[152:155], v[116:119], v[68:71]
  ds_read_b64_tr_b16 v[100:101], v52 offset:16384
  v_mfma_f32_16x16x32_bf16 v[84:87], a[156:159], v[116:119], v[84:87]
  ds_read_b64_tr_b16 v[102:103], v52 offset:17408
  s_waitcnt lgkmcnt(6)
  v_mfma_f32_16x16x32_bf16 v[72:75], a[152:155], v[120:123], v[72:75]
  s_add_u32 m0, s58, 151424
  ds_read_b64_tr_b16 v[104:105], v53 offset:16384
  buffer_load_dwordx4 v38, s[8:11], s90 offen offset:128 lds
  s_add_u32 s90, s90, 114688
  v_mfma_f32_16x16x32_bf16 v[88:91], a[156:159], v[120:123], v[88:91]
  ds_read_b64_tr_b16 v[106:107], v53 offset:17408
  s_waitcnt lgkmcnt(6)
  v_mfma_f32_16x16x32_bf16 v[76:79], a[152:155], v[124:127], v[76:79]
  ds_read_b64_tr_b16 v[108:109], v54 offset:16384
  v_mfma_f32_16x16x32_bf16 v[92:95], a[156:159], v[124:127], v[92:95]
  ds_read_b64_tr_b16 v[110:111], v54 offset:17408
  s_waitcnt lgkmcnt(6)
  v_mfma_f32_16x16x32_bf16 v[64:67], a[160:163], v[96:99], v[64:67]
  s_mov_b32 m0, 155648
  ds_read_b64_tr_b16 v[112:113], v51 offset:24576
  buffer_load_dwordx4 v9, s[40:43], s93 offen lds
  v_mfma_f32_16x16x32_bf16 v[80:83], a[164:167], v[96:99], v[80:83]
  ds_read_b64_tr_b16 v[114:115], v51 offset:25600
  s_waitcnt lgkmcnt(6)
  v_mfma_f32_16x16x32_bf16 v[68:71], a[160:163], v[100:103], v[68:71]
  ds_read_b64_tr_b16 v[116:117], v52 offset:24576
  v_mfma_f32_16x16x32_bf16 v[84:87], a[164:167], v[100:103], v[84:87]
  ds_read_b64_tr_b16 v[118:119], v52 offset:25600
  s_waitcnt lgkmcnt(6)
  v_mfma_f32_16x16x32_bf16 v[72:75], a[160:163], v[104:107], v[72:75]
  s_add_u32 m0, s58, 0
  ds_read_b64_tr_b16 v[120:121], v53 offset:24576
  buffer_load_dwordx4 v38, s[8:11], s90 offen offset:0 lds
  v_mfma_f32_16x16x32_bf16 v[88:91], a[164:167], v[104:107], v[88:91]
  ds_read_b64_tr_b16 v[122:123], v53 offset:25600
  s_waitcnt lgkmcnt(6)
  v_mfma_f32_16x16x32_bf16 v[76:79], a[160:163], v[108:111], v[76:79]
  ds_read_b64_tr_b16 v[124:125], v54 offset:24576
  v_mfma_f32_16x16x32_bf16 v[92:95], a[164:167], v[108:111], v[92:95]
  ds_read_b64_tr_b16 v[126:127], v54 offset:25600
  s_waitcnt vmcnt(14)
  s_barrier
  s_add_u32 m0, s58, 3968
  s_waitcnt lgkmcnt(6)
  v_mfma_f32_16x16x32_bf16 v[64:67], a[168:171], v[112:115], v[64:67]
  buffer_load_dwordx4 v38, s[8:11], s90 offen offset:128 lds
  s_add_u32 s90, s90, 114688
  ds_read_b64_tr_b16 v[96:97], v51 offset:32768
  v_mfma_f32_16x16x32_bf16 v[80:83], a[172:175], v[112:115], v[80:83]
  ds_read_b64_tr_b16 v[98:99], v51 offset:33792
  s_waitcnt lgkmcnt(6)
  v_mfma_f32_16x16x32_bf16 v[68:71], a[168:171], v[116:119], v[68:71]
  ds_read_b64_tr_b16 v[100:101], v52 offset:32768
  v_mfma_f32_16x16x32_bf16 v[84:87], a[172:175], v[116:119], v[84:87]
  ds_read_b64_tr_b16 v[102:103], v52 offset:33792
  s_waitcnt lgkmcnt(6)
  v_mfma_f32_16x16x32_bf16 v[72:75], a[168:171], v[120:123], v[72:75]
  s_add_u32 m0, s58, 8192
  ds_read_b64_tr_b16 v[104:105], v53 offset:32768
  buffer_load_dwordx4 v38, s[8:11], s90 offen offset:0 lds
  v_mfma_f32_16x16x32_bf16 v[88:91], a[172:175], v[120:123], v[88:91]
  ds_read_b64_tr_b16 v[106:107], v53 offset:33792
  s_waitcnt lgkmcnt(6)
  v_mfma_f32_16x16x32_bf16 v[76:79], a[168:171], v[124:127], v[76:79]
  ds_read_b64_tr_b16 v[108:109], v54 offset:32768
  v_mfma_f32_16x16x32_bf16 v[92:95], a[172:175], v[124:127], v[92:95]
  ds_read_b64_tr_b16 v[110:111], v54 offset:33792
  s_waitcnt lgkmcnt(6)
  v_mfma_f32_16x16x32_bf16 v[64:67], a[176:179], v[96:99], v[64:67]
  s_add_u32 m0, s58, 12160
  ds_read_b64_tr_b16 v[112:113], v51 offset:40960
  buffer_load_dwordx4 v38, s[8:11], s90 offen offset:128 lds
  s_add_u32 s90, s90, 114688
  v_mfma_f32_16x16x32_bf16 v[80:83], a[180:183], v[96:99], v[80:83]
  ds_read_b64_tr_b16 v[114:115], v51 offset:41984
  s_waitcnt lgkmcnt(6)
  v_mfma_f32_16x16x32_bf16 v[68:71], a[176:179], v[100:103], v[68:71]
  ds_read_b64_tr_b16 v[116:117], v52 offset:40960
  v_mfma_f32_16x16x32_bf16 v[84:87], a[180:183], v[100:103], v[84:87]
  ds_read_b64_tr_b16 v[118:119], v52 offset:41984
  s_waitcnt lgkmcnt(6)
  v_mfma_f32_16x16x32_bf16 v[72:75], a[176:179], v[104:107], v[72:75]
  s_add_u32 m0, s3, 24576
  ds_read_b64_tr_b16 v[120:121], v53 offset:40960
  buffer_load_dwordx4 v46, s[16:19], s72 offen offset:0 lds
  v_mfma_f32_16x16x32_bf16 v[88:91], a[180:183], v[104:107], v[88:91]
  ds_read_b64_tr_b16 v[122:123], v53 offset:41984
  s_waitcnt lgkmcnt(6)
  v_mfma_f32_16x16x32_bf16 v[76:79], a[176:179], v[108:111], v[76:79]
  ds_read_b64_tr_b16 v[124:125], v54 offset:40960
  v_mfma_f32_16x16x32_bf16 v[92:95], a[180:183], v[108:111], v[92:95]
  ds_read_b64_tr_b16 v[126:127], v54 offset:41984
  s_waitcnt vmcnt(14)
  s_barrier
  s_add_u32 m0, s3, 25600
  s_waitcnt lgkmcnt(6)
  v_mfma_f32_16x16x32_bf16 v[64:67], a[184:187], v[112:115], v[64:67]
  buffer_load_dwordx4 v46, s[16:19], s73 offen offset:0 lds
  ds_read_b64_tr_b16 v[96:97], v51 offset:49152
  v_mfma_f32_16x16x32_bf16 v[80:83], a[188:191], v[112:115], v[80:83]
  ds_read_b64_tr_b16 v[98:99], v51 offset:50176
  s_waitcnt lgkmcnt(6)
  v_mfma_f32_16x16x32_bf16 v[68:71], a[184:187], v[116:119], v[68:71]
  ds_read_b64_tr_b16 v[100:101], v52 offset:49152
  v_mfma_f32_16x16x32_bf16 v[84:87], a[188:191], v[116:119], v[84:87]
  ds_read_b64_tr_b16 v[102:103], v52 offset:50176
  s_waitcnt lgkmcnt(6)
  v_mfma_f32_16x16x32_bf16 v[72:75], a[184:187], v[120:123], v[72:75]
  s_add_u32 m0, s3, 26624
  ds_read_b64_tr_b16 v[104:105], v53 offset:49152
  buffer_load_dwordx4 v46, s[16:19], s74 offen offset:0 lds
  v_mfma_f32_16x16x32_bf16 v[88:91], a[188:191], v[120:123], v[88:91]
  ds_read_b64_tr_b16 v[106:107], v53 offset:50176
  s_waitcnt lgkmcnt(6)
  v_mfma_f32_16x16x32_bf16 v[76:79], a[184:187], v[124:127], v[76:79]
  ds_read_b64_tr_b16 v[108:109], v54 offset:49152
  v_mfma_f32_16x16x32_bf16 v[92:95], a[188:191], v[124:127], v[92:95]
  ds_read_b64_tr_b16 v[110:111], v54 offset:50176
  s_waitcnt lgkmcnt(6)
  v_mfma_f32_16x16x32_bf16 v[64:67], a[192:195], v[96:99], v[64:67]
  s_add_u32 m0, s3, 27648
  ds_read_b64_tr_b16 v[112:113], v51 offset:57344
  buffer_load_dwordx4 v46, s[16:19], s75 offen offset:0 lds
  v_mfma_f32_16x16x32_bf16 v[80:83], a[196:199], v[96:99], v[80:83]
  ds_read_b64_tr_b16 v[114:115], v51 offset:58368
  s_waitcnt lgkmcnt(6)
  v_mfma_f32_16x16x32_bf16 v[68:71], a[192:195], v[100:103], v[68:71]
  ds_read_b64_tr_b16 v[116:117], v52 offset:57344
  v_mfma_f32_16x16x32_bf16 v[84:87], a[196:199], v[100:103], v[84:87]
  ds_read_b64_tr_b16 v[118:119], v52 offset:58368
  s_waitcnt lgkmcnt(6)
  v_mfma_f32_16x16x32_bf16 v[72:75], a[192:195], v[104:107], v[72:75]
  s_add_u32 m0, s3, 28672
  ds_read_b64_tr_b16 v[120:121], v53 offset:57344
  buffer_load_dwordx4 v46, s[16:19], s76 offen offset:0 lds
  v_mfma_f32_16x16x32_bf16 v[88:91], a[196:199], v[104:107], v[88:91]
  ds_read_b64_tr_b16 v[122:123], v53 offset:58368
  s_waitcnt lgkmcnt(6)
  v_mfma_f32_16x16x32_bf16 v[76:79], a[192:195], v[108:111], v[76:79]
  ds_read_b64_tr_b16 v[124:125], v54 offset:57344
  v_mfma_f32_16x16x32_bf16 v[92:95], a[196:199], v[108:111], v[92:95]
  ds_read_b64_tr_b16 v[126:127], v54 offset:58368
  s_waitcnt vmcnt(14)
  s_barrier
  s_add_u32 m0, s3, 29696
  s_waitcnt lgkmcnt(6)
  v_mfma_f32_16x16x32_bf16 v[64:67], a[200:203], v[112:115], v[64:67]
  buffer_load_dwordx4 v46, s[16:19], s77 offen offset:0 lds
  ds_read_b64_tr_b16 v[96:97], v55 offset:0
  v_mfma_f32_16x16x32_bf16 v[80:83], a[204:207], v[112:115], v[80:83]
  ds_read_b64_tr_b16 v[98:99], v55 offset:1024
  s_waitcnt lgkmcnt(6)
  v_mfma_f32_16x16x32_bf16 v[68:71], a[200:203], v[116:119], v[68:71]
  ds_read_b64_tr_b16 v[100:101], v56 offset:0
  v_mfma_f32_16x16x32_bf16 v[84:87], a[204:207], v[116:119], v[84:87]
  ds_read_b64_tr_b16 v[102:103], v56 offset:1024
  s_waitcnt lgkmcnt(6)
  v_mfma_f32_16x16x32_bf16 v[72:75], a[200:203], v[120:123], v[72:75]
  s_add_u32 m0, s3, 30720
  ds_read_b64_tr_b16 v[104:105], v57 offset:0
  buffer_load_dwordx4 v46, s[16:19], s78 offen offset:0 lds
  v_mfma_f32_16x16x32_bf16 v[88:91], a[204:207], v[120:123], v[88:91]
  ds_read_b64_tr_b16 v[106:107], v57 offset:1024
  s_waitcnt lgkmcnt(6)
  v_mfma_f32_16x16x32_bf16 v[76:79], a[200:203], v[124:127], v[76:79]
  ds_read_b64_tr_b16 v[108:109], v58 offset:0
  v_mfma_f32_16x16x32_bf16 v[92:95], a[204:207], v[124:127], v[92:95]
  ds_read_b64_tr_b16 v[110:111], v58 offset:1024
  s_waitcnt lgkmcnt(6)
  v_mfma_f32_16x16x32_bf16 v[64:67], a[208:211], v[96:99], v[64:67]
  s_add_u32 m0, s3, 31744
  ds_read_b64_tr_b16 v[112:113], v55 offset:8192
  buffer_load_dwordx4 v46, s[16:19], s79 offen offset:0 lds
  v_add_u32 v46, 128, v46
  v_mfma_f32_16x16x32_bf16 v[80:83], a[212:215], v[96:99], v[80:83]
  ds_read_b64_tr_b16 v[114:115], v55 offset:9216
  s_waitcnt lgkmcnt(6)
  v_mfma_f32_16x16x32_bf16 v[68:71], a[208:211], v[100:103], v[68:71]
  ds_read_b64_tr_b16 v[116:117], v56 offset:8192
  v_mfma_f32_16x16x32_bf16 v[84:87], a[212:215], v[100:103], v[84:87]
  ds_read_b64_tr_b16 v[118:119], v56 offset:9216
  s_waitcnt lgkmcnt(6)
  v_mfma_f32_16x16x32_bf16 v[72:75], a[208:211], v[104:107], v[72:75]
  s_add_u32 m0, s58, 57344
  ds_read_b64_tr_b16 v[120:121], v57 offset:8192
  buffer_load_dwordx4 v39, s[12:15], s92 offen offset:0 lds
  v_mfma_f32_16x16x32_bf16 v[88:91], a[212:215], v[104:107], v[88:91]
  ds_read_b64_tr_b16 v[122:123], v57 offset:9216
  s_waitcnt lgkmcnt(6)
  v_mfma_f32_16x16x32_bf16 v[76:79], a[208:211], v[108:111], v[76:79]
  ds_read_b64_tr_b16 v[124:125], v58 offset:8192
  v_mfma_f32_16x16x32_bf16 v[92:95], a[212:215], v[108:111], v[92:95]
  ds_read_b64_tr_b16 v[126:127], v58 offset:9216
  s_waitcnt vmcnt(14)
  s_barrier
  s_add_u32 m0, s58, 61312
  s_waitcnt lgkmcnt(6)
  v_mfma_f32_16x16x32_bf16 v[64:67], a[216:219], v[112:115], v[64:67]
  buffer_load_dwordx4 v39, s[12:15], s92 offen offset:128 lds
  ds_read_b64_tr_b16 v[96:97], v55 offset:16384
  v_mfma_f32_16x16x32_bf16 v[80:83], a[220:223], v[112:115], v[80:83]
  ds_read_b64_tr_b16 v[98:99], v55 offset:17408
  s_waitcnt lgkmcnt(6)
  v_mfma_f32_16x16x32_bf16 v[68:71], a[216:219], v[116:119], v[68:71]
  ds_read_b64_tr_b16 v[100:101], v56 offset:16384
  v_mfma_f32_16x16x32_bf16 v[84:87], a[220:223], v[116:119], v[84:87]
  ds_read_b64_tr_b16 v[102:103], v56 offset:17408
  s_waitcnt lgkmcnt(6)
  v_mfma_f32_16x16x32_bf16 v[72:75], a[216:219], v[120:123], v[72:75]
  s_add_u32 m0, s58, 65280
  ds_read_b64_tr_b16 v[104:105], v57 offset:16384
  buffer_load_dwordx4 v39, s[12:15], s92 offen offset:256 lds
  s_add_u32 s92, s92, 86016
  v_mfma_f32_16x16x32_bf16 v[88:91], a[220:223], v[120:123], v[88:91]
  ds_read_b64_tr_b16 v[106:107], v57 offset:17408
  s_waitcnt lgkmcnt(6)
  v_mfma_f32_16x16x32_bf16 v[76:79], a[216:219], v[124:127], v[76:79]
  ds_read_b64_tr_b16 v[108:109], v58 offset:16384
  v_mfma_f32_16x16x32_bf16 v[92:95], a[220:223], v[124:127], v[92:95]
  ds_read_b64_tr_b16 v[110:111], v58 offset:17408
  s_waitcnt lgkmcnt(6)
  v_mfma_f32_16x16x32_bf16 v[64:67], a[224:227], v[96:99], v[64:67]
  s_add_u32 m0, s58, 69632
  ds_read_b64_tr_b16 v[112:113], v55 offset:24576
  buffer_load_dwordx4 v39, s[12:15], s92 offen offset:0 lds
  v_mfma_f32_16x16x32_bf16 v[80:83], a[228:231], v[96:99], v[80:83]
  ds_read_b64_tr_b16 v[114:115], v55 offset:25600
  s_waitcnt lgkmcnt(6)
  v_mfma_f32_16x16x32_bf16 v[68:71], a[224:227], v[100:103], v[68:71]
  ds_read_b64_tr_b16 v[116:117], v56 offset:24576
  v_mfma_f32_16x16x32_bf16 v[84:87], a[228:231], v[100:103], v[84:87]
  ds_read_b64_tr_b16 v[118:119], v56 offset:25600
  s_waitcnt lgkmcnt(6)
  v_mfma_f32_16x16x32_bf16 v[72:75], a[224:227], v[104:107], v[72:75]
  s_add_u32 m0, s58, 73600
  ds_read_b64_tr_b16 v[120:121], v57 offset:24576
  buffer_load_dwordx4 v39, s[12:15], s92 offen offset:128 lds
  v_mfma_f32_16x16x32_bf16 v[88:91], a[228:231], v[104:107], v[88:91]
  ds_read_b64_tr_b16 v[122:123], v57 offset:25600
  s_waitcnt lgkmcnt(6)
  v_mfma_f32_16x16x32_bf16 v[76:79], a[224:227], v[108:111], v[76:79]
  ds_read_b64_tr_b16 v[124:125], v58 offset:24576
  v_mfma_f32_16x16x32_bf16 v[92:95], a[228:231], v[108:111], v[92:95]
  ds_read_b64_tr_b16 v[126:127], v58 offset:25600
  s_waitcnt vmcnt(13)
  s_barrier
  s_add_u32 m0, s58, 77568
  s_waitcnt lgkmcnt(6)
  v_mfma_f32_16x16x32_bf16 v[64:67], a[232:235], v[112:115], v[64:67]
  buffer_load_dwordx4 v39, s[12:15], s92 offen offset:256 lds
  s_add_u32 s92, s92, 86016
  ds_read_b64_tr_b16 v[96:97], v47 offset:0
  v_mfma_f32_16x16x32_bf16 v[80:83], a[236:239], v[112:115], v[80:83]
  ds_read_b64_tr_b16 v[98:99], v47 offset:1024
  s_waitcnt lgkmcnt(6)
  v_mfma_f32_16x16x32_bf16 v[68:71], a[232:235], v[116:119], v[68:71]
  ds_read_b64_tr_b16 v[100:101], v48 offset:0
  v_mfma_f32_16x16x32_bf16 v[84:87], a[236:239], v[116:119], v[84:87]
  ds_read_b64_tr_b16 v[102:103], v48 offset:1024
  s_waitcnt lgkmcnt(6)
  v_mfma_f32_16x16x32_bf16 v[72:75], a[232:235], v[120:123], v[72:75]
  s_add_u32 m0, s58, 81920
  ds_read_b64_tr_b16 v[104:105], v49 offset:0
  buffer_load_dwordx4 v39, s[12:15], s92 offen offset:0 lds
  v_mfma_f32_16x16x32_bf16 v[88:91], a[236:239], v[120:123], v[88:91]
  ds_read_b64_tr_b16 v[106:107], v49 offset:1024
  s_waitcnt lgkmcnt(6)
  v_mfma_f32_16x16x32_bf16 v[76:79], a[232:235], v[124:127], v[76:79]
  ds_read_b64_tr_b16 v[108:109], v50 offset:0
  v_mfma_f32_16x16x32_bf16 v[92:95], a[236:239], v[124:127], v[92:95]
  ds_read_b64_tr_b16 v[110:111], v50 offset:1024
  s_waitcnt lgkmcnt(6)
  v_mfma_f32_16x16x32_bf16 v[64:67], a[240:243], v[96:99], v[64:67]
  s_add_u32 m0, s58, 85888
  ds_read_b64_tr_b16 v[112:113], v47 offset:8192
  buffer_load_dwordx4 v39, s[12:15], s92 offen offset:128 lds
  v_mfma_f32_16x16x32_bf16 v[80:83], a[244:247], v[96:99], v[80:83]
  ds_read_b64_tr_b16 v[114:115], v47 offset:9216
  s_waitcnt lgkmcnt(6)
  v_mfma_f32_16x16x32_bf16 v[68:71], a[240:243], v[100:103], v[68:71]
  ds_read_b64_tr_b16 v[116:117], v48 offset:8192
  v_mfma_f32_16x16x32_bf16 v[84:87], a[244:247], v[100:103], v[84:87]
  ds_read_b64_tr_b16 v[118:119], v48 offset:9216
  s_waitcnt lgkmcnt(6)
  v_mfma_f32_16x16x32_bf16 v[72:75], a[240:243], v[104:107], v[72:75]
  s_add_u32 m0, s58, 89856
  ds_read_b64_tr_b16 v[120:121], v49 offset:8192
  buffer_load_dwordx4 v39, s[12:15], s92 offen offset:256 lds
  s_add_u32 s92, s92, 86016
  v_mfma_f32_16x16x32_bf16 v[88:91], a[244:247], v[104:107], v[88:91]
  ds_read_b64_tr_b16 v[122:123], v49 offset:9216
  s_waitcnt lgkmcnt(6)
  v_mfma_f32_16x16x32_bf16 v[76:79], a[240:243], v[108:111], v[76:79]
  ds_read_b64_tr_b16 v[124:125], v50 offset:8192
  v_mfma_f32_16x16x32_bf16 v[92:95], a[244:247], v[108:111], v[92:95]
  ds_read_b64_tr_b16 v[126:127], v50 offset:9216
  s_waitcnt lgkmcnt(6)
  v_mfma_f32_16x16x32_bf16 v[64:67], a[248:251], v[112:115], v[64:67]
  s_add_u32 m0, s58, 94208
  v_mfma_f32_16x16x32_bf16 v[80:83], a[252:255], v[112:115], v[80:83]
  buffer_load_dwordx4 v39, s[12:15], s92 offen offset:0 lds
  s_waitcnt lgkmcnt(4)
  v_mfma_f32_16x16x32_bf16 v[68:71], a[248:251], v[116:119], v[68:71]
  v_mfma_f32_16x16x32_bf16 v[84:87], a[252:255], v[116:119], v[84:87]
  s_waitcnt lgkmcnt(2)
  v_mfma_f32_16x16x32_bf16 v[72:75], a[248:251], v[120:123], v[72:75]
  v_mfma_f32_16x16x32_bf16 v[88:91], a[252:255], v[120:123], v[88:91]
  s_add_u32 m0, s58, 98176
  s_waitcnt lgkmcnt(0)
  v_mfma_f32_16x16x32_bf16 v[76:79], a[248:251], v[124:127], v[76:79]
  buffer_load_dwordx4 v39, s[12:15], s92 offen offset:128 lds
  v_mfma_f32_16x16x32_bf16 v[92:95], a[252:255], v[124:127], v[92:95]
  s_barrier
  s_waitcnt vmcnt(11)
  ds_read_b128 a[0:3], v45 offset:24576
  s_add_u32 m0, s58, 102144
  ds_read_b128 a[4:7], v45 offset:26624
  buffer_load_dwordx4 v39, s[12:15], s92 offen offset:256 lds
  s_add_u32 s92, s92, 86016
  ds_read_b128 a[8:11], v43 offset:24576
  ds_read_b128 a[12:15], v43 offset:26624
  ds_read_b128 a[16:19], v44 offset:24576
  ds_read_b128 a[20:23], v44 offset:26624
  s_add_u32 m0, s58, 106496
  ds_read_b128 a[24:27], v42 offset:24576
  buffer_load_dwordx4 v39, s[12:15], s92 offen offset:0 lds
  ds_read_b128 a[28:31], v42 offset:26624
  s_waitcnt lgkmcnt(0)
  v_pk_mul_f32 v[96:97], v[64:65], v[64:65]
  v_pk_mul_f32 v[98:99], v[66:67], v[66:67]
  v_pk_mul_f32 v[100:101], v[68:69], v[68:69]
  v_pk_mul_f32 v[102:103], v[70:71], v[70:71]
  v_pk_fma_f32 v[96:97], v[96:97], s[68:69], v[60:61]
  v_pk_fma_f32 v[98:99], v[98:99], s[68:69], v[60:61]
  v_pk_fma_f32 v[100:101], v[100:101], s[68:69], v[60:61]
  v_pk_fma_f32 v[102:103], v[102:103], s[68:69], v[60:61]
  s_add_u32 m0, s58, 110464
  v_pk_mul_f32 v[96:97], v[96:97], v[64:65]
  buffer_load_dwordx4 v39, s[12:15], s92 offen offset:128 lds
  v_pk_mul_f32 v[98:99], v[98:99], v[66:67]
  v_pk_mul_f32 v[100:101], v[100:101], v[68:69]
  v_pk_mul_f32 v[102:103], v[102:103], v[70:71]
  v_exp_f32 v96, v96
  v_exp_f32 v97, v97
  v_exp_f32 v98, v98
  v_exp_f32 v99, v99
  v_exp_f32 v100, v100
  s_add_u32 m0, s58, 114432
  v_exp_f32 v101, v101
  buffer_load_dwordx4 v39, s[12:15], s92 offen offset:256 lds
  s_add_u32 s92, s92, 86016
  v_exp_f32 v102, v102
  v_exp_f32 v103, v103
  v_pk_add_f32 v[96:97], v[96:97], s[70:71]
  v_pk_add_f32 v[98:99], v[98:99], s[70:71]
  v_pk_add_f32 v[100:101], v[100:101], s[70:71]
  v_pk_add_f32 v[102:103], v[102:103], s[70:71]
  v_rcp_f32 v96, v96
  v_rcp_f32 v97, v97
  s_add_u32 m0, s58, 118784
  v_rcp_f32 v98, v98
  buffer_load_dwordx4 v39, s[12:15], s92 offen offset:0 lds
  v_rcp_f32 v99, v99
  v_rcp_f32 v100, v100
  v_rcp_f32 v101, v101
  v_rcp_f32 v102, v102
  v_rcp_f32 v103, v103
  v_pk_mul_f32 v[64:65], v[64:65], v[96:97]
  v_pk_mul_f32 v[66:67], v[66:67], v[98:99]
  s_add_u32 m0, s58, 122752
  v_pk_mul_f32 v[68:69], v[68:69], v[100:101]
  buffer_load_dwordx4 v39, s[12:15], s92 offen offset:128 lds
  v_pk_mul_f32 v[70:71], v[70:71], v[102:103]
  v_pk_mul_f32 v[96:97], v[72:73], v[72:73]
  v_pk_mul_f32 v[98:99], v[74:75], v[74:75]
  v_pk_mul_f32 v[100:101], v[76:77], v[76:77]
  v_pk_mul_f32 v[102:103], v[78:79], v[78:79]
  v_pk_fma_f32 v[96:97], v[96:97], s[68:69], v[60:61]
  v_pk_fma_f32 v[98:99], v[98:99], s[68:69], v[60:61]
  v_pk_fma_f32 v[100:101], v[100:101], s[68:69], v[60:61]
  v_pk_fma_f32 v[102:103], v[102:103], s[68:69], v[60:61]
  v_pk_mul_f32 v[96:97], v[96:97], v[72:73]
  s_add_u32 m0, s58, 126720
  v_pk_mul_f32 v[98:99], v[98:99], v[74:75]
  buffer_load_dwordx4 v39, s[12:15], s92 offen offset:256 lds
  s_add_u32 s92, s92, 86016
  v_pk_mul_f32 v[100:101], v[100:101], v[76:77]
  v_pk_mul_f32 v[102:103], v[102:103], v[78:79]
  v_exp_f32 v96, v96
  v_exp_f32 v97, v97
  v_exp_f32 v98, v98
  v_exp_f32 v99, v99
  v_exp_f32 v100, v100
  s_add_u32 m0, s3, 24576
  v_exp_f32 v101, v101
  buffer_load_dwordx4 v46, s[16:19], s72 offen offset:0 lds
  v_exp_f32 v102, v102
  v_exp_f32 v103, v103
  v_pk_add_f32 v[96:97], v[96:97], s[70:71]
  v_pk_add_f32 v[98:99], v[98:99], s[70:71]
  v_pk_add_f32 v[100:101], v[100:101], s[70:71]
  v_pk_add_f32 v[102:103], v[102:103], s[70:71]
  v_rcp_f32 v96, v96
  v_rcp_f32 v97, v97
  s_add_u32 m0, s3, 25600
  v_rcp_f32 v98, v98
  buffer_load_dwordx4 v46, s[16:19], s73 offen offset:0 lds
  v_rcp_f32 v99, v99
  v_rcp_f32 v100, v100
  v_rcp_f32 v101, v101
  v_rcp_f32 v102, v102
  v_rcp_f32 v103, v103
  v_pk_mul_f32 v[72:73], v[72:73], v[96:97]
  v_pk_mul_f32 v[74:75], v[74:75], v[98:99]
  s_add_u32 m0, s3, 26624
  v_pk_mul_f32 v[76:77], v[76:77], v[100:101]
  buffer_load_dwordx4 v46, s[16:19], s74 offen offset:0 lds
  v_pk_mul_f32 v[78:79], v[78:79], v[102:103]
  v_pk_mul_f32 v[96:97], v[80:81], v[80:81]
  v_pk_mul_f32 v[98:99], v[82:83], v[82:83]
  v_pk_mul_f32 v[100:101], v[84:85], v[84:85]
  v_pk_mul_f32 v[102:103], v[86:87], v[86:87]
  v_pk_fma_f32 v[96:97], v[96:97], s[68:69], v[60:61]
  v_pk_fma_f32 v[98:99], v[98:99], s[68:69], v[60:61]
  v_pk_fma_f32 v[100:101], v[100:101], s[68:69], v[60:61]
  v_pk_fma_f32 v[102:103], v[102:103], s[68:69], v[60:61]
  v_pk_mul_f32 v[96:97], v[96:97], v[80:81]
  s_add_u32 m0, s3, 27648
  v_pk_mul_f32 v[98:99], v[98:99], v[82:83]
  buffer_load_dwordx4 v46, s[16:19], s75 offen offset:0 lds
  v_pk_mul_f32 v[100:101], v[100:101], v[84:85]
  v_pk_mul_f32 v[102:103], v[102:103], v[86:87]
  v_exp_f32 v96, v96
  v_exp_f32 v97, v97
  v_exp_f32 v98, v98
  v_exp_f32 v99, v99
  v_exp_f32 v100, v100
  s_add_u32 m0, s3, 28672
  v_exp_f32 v101, v101
  buffer_load_dwordx4 v46, s[16:19], s76 offen offset:0 lds
  v_exp_f32 v102, v102
  v_exp_f32 v103, v103
  v_pk_add_f32 v[96:97], v[96:97], s[70:71]
  v_pk_add_f32 v[98:99], v[98:99], s[70:71]
  v_pk_add_f32 v[100:101], v[100:101], s[70:71]
  v_pk_add_f32 v[102:103], v[102:103], s[70:71]
  v_rcp_f32 v96, v96
  v_rcp_f32 v97, v97
  s_add_u32 m0, s3, 29696
  v_rcp_f32 v98, v98
  buffer_load_dwordx4 v46, s[16:19], s77 offen offset:0 lds
  v_rcp_f32 v99, v99
  v_rcp_f32 v100, v100
  v_rcp_f32 v101, v101
  v_rcp_f32 v102, v102
  v_rcp_f32 v103, v103
  v_pk_mul_f32 v[80:81], v[80:81], v[96:97]
  v_pk_mul_f32 v[82:83], v[82:83], v[98:99]
  s_add_u32 m0, s3, 30720
  v_pk_mul_f32 v[84:85], v[84:85], v[100:101]
  buffer_load_dwordx4 v46, s[16:19], s78 offen offset:0 lds
  v_pk_mul_f32 v[86:87], v[86:87], v[102:103]
  v_pk_mul_f32 v[96:97], v[88:89], v[88:89]
  v_pk_mul_f32 v[98:99], v[90:91], v[90:91]
  v_pk_mul_f32 v[100:101], v[92:93], v[92:93]
  v_pk_mul_f32 v[102:103], v[94:95], v[94:95]
  v_pk_fma_f32 v[96:97], v[96:97], s[68:69], v[60:61]
  v_pk_fma_f32 v[98:99], v[98:99], s[68:69], v[60:61]
  v_pk_fma_f32 v[100:101], v[100:101], s[68:69], v[60:61]
  v_pk_fma_f32 v[102:103], v[102:103], s[68:69], v[60:61]
  v_pk_mul_f32 v[96:97], v[96:97], v[88:89]
  s_add_u32 m0, s3, 31744
  v_pk_mul_f32 v[98:99], v[98:99], v[90:91]
  buffer_load_dwordx4 v46, s[16:19], s79 offen offset:0 lds
  v_add_u32 v46, 128, v46
  v_pk_mul_f32 v[100:101], v[100:101], v[92:93]
  v_pk_mul_f32 v[102:103], v[102:103], v[94:95]
  v_exp_f32 v96, v96
  v_exp_f32 v97, v97
  v_exp_f32 v98, v98
  v_exp_f32 v99, v99
  v_exp_f32 v100, v100
  s_add_u32 m0, s58, 131072
  v_exp_f32 v101, v101
  buffer_load_dwordx4 v39, s[12:15], s92 offen offset:0 lds
  v_exp_f32 v102, v102
  v_exp_f32 v103, v103
  v_pk_add_f32 v[96:97], v[96:97], s[70:71]
  v_pk_add_f32 v[98:99], v[98:99], s[70:71]
  v_pk_add_f32 v[100:101], v[100:101], s[70:71]
  v_pk_add_f32 v[102:103], v[102:103], s[70:71]
  v_rcp_f32 v96, v96
  v_rcp_f32 v97, v97
  s_add_u32 m0, s58, 135040
  v_rcp_f32 v98, v98
  buffer_load_dwordx4 v39, s[12:15], s92 offen offset:128 lds
  v_rcp_f32 v99, v99
  v_rcp_f32 v100, v100
  v_rcp_f32 v101, v101
  v_rcp_f32 v102, v102
  v_rcp_f32 v103, v103
  v_pk_mul_f32 v[88:89], v[88:89], v[96:97]
  v_pk_mul_f32 v[90:91], v[90:91], v[98:99]
  s_add_u32 m0, s58, 139008
  v_pk_mul_f32 v[92:93], v[92:93], v[100:101]
  buffer_load_dwordx4 v39, s[12:15], s92 offen offset:256 lds
  s_add_u32 s92, s92, 86016
  v_pk_mul_f32 v[94:95], v[94:95], v[102:103]
  v_pk_add_f32 v[96:97], v[64:65], v[68:69]
  v_pk_mul_f32 v[104:105], v[64:65], v[64:65]
  v_pk_add_f32 v[98:99], v[66:67], v[70:71]
  v_pk_mul_f32 v[106:107], v[66:67], v[66:67]
  v_pk_add_f32 v[100:101], v[80:81], v[84:85]
  v_pk_mul_f32 v[108:109], v[80:81], v[80:81]
  v_pk_add_f32 v[102:103], v[82:83], v[86:87]
  v_pk_mul_f32 v[110:111], v[82:83], v[82:83]
  v_pk_fma_f32 v[104:105], v[68:69], v[68:69], v[104:105]
  s_add_u32 m0, s58, 143360
  v_pk_fma_f32 v[106:107], v[70:71], v[70:71], v[106:107]
  buffer_load_dwordx4 v39, s[12:15], s92 offen offset:0 lds
  v_pk_fma_f32 v[108:109], v[84:85], v[84:85], v[108:109]
  v_pk_fma_f32 v[110:111], v[86:87], v[86:87], v[110:111]
  v_pk_add_f32 v[96:97], v[96:97], v[72:73]
  v_pk_fma_f32 v[104:105], v[72:73], v[72:73], v[104:105]
  v_pk_add_f32 v[98:99], v[98:99], v[74:75]
  v_pk_fma_f32 v[106:107], v[74:75], v[74:75], v[106:107]
  v_pk_add_f32 v[100:101], v[100:101], v[88:89]
  v_pk_fma_f32 v[108:109], v[88:89], v[88:89], v[108:109]
  v_pk_add_f32 v[102:103], v[102:103], v[90:91]
  v_pk_fma_f32 v[110:111], v[90:91], v[90:91], v[110:111]
  s_add_u32 m0, s58, 147328
  v_pk_add_f32 v[96:97], v[96:97], v[76:77]
  buffer_load_dwordx4 v39, s[12:15], s92 offen offset:128 lds
  v_pk_fma_f32 v[104:105], v[76:77], v[76:77], v[104:105]
  v_pk_add_f32 v[98:99], v[98:99], v[78:79]
  v_pk_fma_f32 v[106:107], v[78:79], v[78:79], v[106:107]
  v_pk_add_f32 v[100:101], v[100:101], v[92:93]
  v_pk_fma_f32 v[108:109], v[92:93], v[92:93], v[108:109]
  v_pk_add_f32 v[102:103], v[102:103], v[94:95]
  v_pk_fma_f32 v[110:111], v[94:95], v[94:95], v[110:111]
  v_add_f32_dpp v96, v96, v96 row_ror:8 row_mask:0xf bank_mask:0xf
  v_add_f32_dpp v97, v97, v97 row_ror:8 row_mask:0xf bank_mask:0xf
  v_add_f32_dpp v98, v98, v98 row_ror:8 row_mask:0xf bank_mask:0xf
  s_add_u32 m0, s58, 151296
  v_add_f32_dpp v99, v99, v99 row_ror:8 row_mask:0xf bank_mask:0xf
  buffer_load_dwordx4 v39, s[12:15], s92 offen offset:256 lds
  s_add_u32 s92, s92, 86016
  v_add_f32_dpp v100, v100, v100 row_ror:8 row_mask:0xf bank_mask:0xf
  v_add_f32_dpp v101, v101, v101 row_ror:8 row_mask:0xf bank_mask:0xf
  v_add_f32_dpp v102, v102, v102 row_ror:8 row_mask:0xf bank_mask:0xf
  v_add_f32_dpp v103, v103, v103 row_ror:8 row_mask:0xf bank_mask:0xf
  v_add_f32_dpp v104, v104, v104 row_ror:8 row_mask:0xf bank_mask:0xf
  v_add_f32_dpp v105, v105, v105 row_ror:8 row_mask:0xf bank_mask:0xf
  v_add_f32_dpp v106, v106, v106 row_ror:8 row_mask:0xf bank_mask:0xf
  v_add_f32_dpp v107, v107, v107 row_ror:8 row_mask:0xf bank_mask:0xf
  v_add_f32_dpp v108, v108, v108 row_ror:8 row_mask:0xf bank_mask:0xf
  v_add_f32_dpp v109, v109, v109 row_ror:8 row_mask:0xf bank_mask:0xf
  s_add_u32 m0, s58, 0
  v_add_f32_dpp v110, v110, v110 row_ror:8 row_mask:0xf bank_mask:0xf
  buffer_load_dwordx4 v39, s[12:15], s92 offen offset:0 lds
  v_add_f32_dpp v111, v111, v111 row_ror:8 row_mask:0xf bank_mask:0xf
  v_add_f32_dpp v96, v96, v96 row_ror:4 row_mask:0xf bank_mask:0xf
  v_add_f32_dpp v97, v97, v97 row_ror:4 row_mask:0xf bank_mask:0xf
  v_add_f32_dpp v98, v98, v98 row_ror:4 row_mask:0xf bank_mask:0xf
  v_add_f32_dpp v99, v99, v99 row_ror:4 row_mask:0xf bank_mask:0xf
  v_add_f32_dpp v100, v100, v100 row_ror:4 row_mask:0xf bank_mask:0xf
  v_add_f32_dpp v101, v101, v101 row_ror:4 row_mask:0xf bank_mask:0xf
  v_add_f32_dpp v102, v102, v102 row_ror:4 row_mask:0xf bank_mask:0xf
  v_add_f32_dpp v103, v103, v103 row_ror:4 row_mask:0xf bank_mask:0xf
  v_add_f32_dpp v104, v104, v104 row_ror:4 row_mask:0xf bank_mask:0xf
  s_add_u32 m0, s58, 3968
  v_add_f32_dpp v105, v105, v105 row_ror:4 row_mask:0xf bank_mask:0xf
  buffer_load_dwordx4 v39, s[12:15], s92 offen offset:128 lds
  v_add_f32_dpp v106, v106, v106 row_ror:4 row_mask:0xf bank_mask:0xf
  v_add_f32_dpp v107, v107, v107 row_ror:4 row_mask:0xf bank_mask:0xf
  v_add_f32_dpp v108, v108, v108 row_ror:4 row_mask:0xf bank_mask:0xf
  v_add_f32_dpp v109, v109, v109 row_ror:4 row_mask:0xf bank_mask:0xf
  v_add_f32_dpp v110, v110, v110 row_ror:4 row_mask:0xf bank_mask:0xf
  v_add_f32_dpp v111, v111, v111 row_ror:4 row_mask:0xf bank_mask:0xf
  v_add_f32_dpp v96, v96, v96 row_ror:2 row_mask:0xf bank_mask:0xf
  v_add_f32_dpp v97, v97, v97 row_ror:2 row_mask:0xf bank_mask:0xf
  v_add_f32_dpp v98, v98, v98 row_ror:2 row_mask:0xf bank_mask:0xf
  v_add_f32_dpp v99, v99, v99 row_ror:2 row_mask:0xf bank_mask:0xf
  s_add_u32 m0, s58, 7936
  v_add_f32_dpp v100, v100, v100 row_ror:2 row_mask:0xf bank_mask:0xf
  buffer_load_dwordx4 v39, s[12:15], s92 offen offset:256 lds
  s_add_u32 s92, s92, 86016
  v_add_f32_dpp v101, v101, v101 row_ror:2 row_mask:0xf bank_mask:0xf
  v_add_f32_dpp v102, v102, v102 row_ror:2 row_mask:0xf bank_mask:0xf
  v_add_f32_dpp v103, v103, v103 row_ror:2 row_mask:0xf bank_mask:0xf
  v_add_f32_dpp v104, v104, v104 row_ror:2 row_mask:0xf bank_mask:0xf
  v_add_f32_dpp v105, v105, v105 row_ror:2 row_mask:0xf bank_mask:0xf
  v_add_f32_dpp v106, v106, v106 row_ror:2 row_mask:0xf bank_mask:0xf
  v_add_f32_dpp v107, v107, v107 row_ror:2 row_mask:0xf bank_mask:0xf
  v_add_f32_dpp v108, v108, v108 row_ror:2 row_mask:0xf bank_mask:0xf
  v_add_f32_dpp v109, v109, v109 row_ror:2 row_mask:0xf bank_mask:0xf
  v_add_f32_dpp v110, v110, v110 row_ror:2 row_mask:0xf bank_mask:0xf
  s_add_u32 m0, s58, 12288
  v_add_f32_dpp v111, v111, v111 row_ror:2 row_mask:0xf bank_mask:0xf
  buffer_load_dwordx4 v39, s[12:15], s92 offen offset:0 lds
  v_add_f32_dpp v96, v96, v96 row_ror:1 row_mask:0xf bank_mask:0xf
  v_add_f32_dpp v97, v97, v97 row_ror:1 row_mask:0xf bank_mask:0xf
  v_add_f32_dpp v98, v98, v98 row_ror:1 row_mask:0xf bank_mask:0xf
  v_add_f32_dpp v99, v99, v99 row_ror:1 row_mask:0xf bank_mask:0xf
  v_add_f32_dpp v100, v100, v100 row_ror:1 row_mask:0xf bank_mask:0xf
  v_add_f32_dpp v101, v101, v101 row_ror:1 row_mask:0xf bank_mask:0xf
  v_add_f32_dpp v102, v102, v102 row_ror:1 row_mask:0xf bank_mask:0xf
  v_add_f32_dpp v103, v103, v103 row_ror:1 row_mask:0xf bank_mask:0xf
  v_add_f32_dpp v104, v104, v104 row_ror:1 row_mask:0xf bank_mask:0xf
  v_add_f32_dpp v105, v105, v105 row_ror:1 row_mask:0xf bank_mask:0xf
  s_add_u32 m0, s58, 16256
  v_add_f32_dpp v106, v106, v106 row_ror:1 row_mask:0xf bank_mask:0xf
  buffer_load_dwordx4 v39, s[12:15], s92 offen offset:128 lds
  v_add_f32_dpp v107, v107, v107 row_ror:1 row_mask:0xf bank_mask:0xf
  v_add_f32_dpp v108, v108, v108 row_ror:1 row_mask:0xf bank_mask:0xf
  v_add_f32_dpp v109, v109, v109 row_ror:1 row_mask:0xf bank_mask:0xf
  v_add_f32_dpp v110, v110, v110 row_ror:1 row_mask:0xf bank_mask:0xf
  v_add_f32_dpp v111, v111, v111 row_ror:1 row_mask:0xf bank_mask:0xf
  v_and_b32 v5, 1, v2
  v_cmp_ne_u32 s[44:45], 0, v5
  v_and_b32 v5, 2, v2
  v_cmp_ne_u32 s[46:47], 0, v5
  v_and_b32 v5, 4, v2
  s_add_u32 m0, s58, 20224
  v_cmp_ne_u32 s[48:49], 0, v5
  buffer_load_dwordx4 v39, s[12:15], s92 offen offset:256 lds
  s_add_u32 s92, s92, 86016
  v_cndmask_b32 v96, v96, v97, s[44:45]
  v_cndmask_b32 v98, v98, v99, s[44:45]
  v_cndmask_b32 v100, v100, v101, s[44:45]
  v_cndmask_b32 v102, v102, v103, s[44:45]
  v_cndmask_b32 v96, v96, v98, s[46:47]
  v_cndmask_b32 v100, v100, v102, s[46:47]
  v_cndmask_b32 v112, v96, v100, s[48:49]
  v_cndmask_b32 v104, v104, v105, s[44:45]
  v_cndmask_b32 v106, v106, v107, s[44:45]
  v_cndmask_b32 v108, v108, v109, s[44:45]
  v_cndmask_b32 v110, v110, v111, s[44:45]
  v_cndmask_b32 v104, v104, v106, s[46:47]
  v_cndmask_b32 v108, v108, v110, s[46:47]
  v_cndmask_b32 v114, v104, v108, s[48:49]
  v_mov_b32 v113, s55
  v_mov_b32 v115, s55
  v_and_b32 v5, 7, v2
  v_lshl_add_u32 v5, v3, 3, v5
  v_lshlrev_b32 v59, 4, v5
  s_lshl_b32 s60, s53, 1
  s_add_u32 s60, s60, s56
  s_mul_i32 s94, s60, 7168
  s_add_u32 s94, s94, 65536
  s_lshl_b32 s60, s54, 1
  s_add_u32 s60, s60, s57
  s_lshl_b32 s60, s60, 9
  s_add_u32 s60, s60, s94
  s_mov_b32 exec_lo, 0x00ff00ff
  s_mov_b32 exec_hi, 0x00ff00ff
  buffer_store_dwordx4 v[112:115], v59, s[20:23], s60 offen sc1
  s_mov_b64 exec, -1
  s_cmp_eq_u32 s57, 1
  s_cselect_b64 s[46:47], -1, 0
  v_lshlrev_b32 v212, 4, v3
  v_add_u32 v212, 155648, v212
  v_cndmask_b32 v47, v10, v12, s[46:47]
  s_mul_i32 s60, s57, 4096
  s_add_u32 s60, s60, 0
  v_add_u32 v47, s60, v47
  v_add_u32 v200, 57344, v47
  v_add_u32 v206, 131072, v47
  v_cndmask_b32 v56, v11, v13, s[46:47]
  s_mul_i32 s60, s57, 4096
  s_add_u32 s60, s60, 0
  v_add_u32 v56, s60, v56
  v_add_u32 v201, 57344, v56
  v_add_u32 v207, 131072, v56
  v_cndmask_b32 v57, v12, v10, s[46:47]
  s_mul_i32 s60, s57, 8192
  s_add_u32 s60, s60, 0
  v_add_u32 v57, s60, v57
  v_add_u32 v202, 57344, v57
  v_add_u32 v208, 131072, v57
  v_cndmask_b32 v58, v13, v11, s[46:47]
  s_mul_i32 s60, s57, 8192
  s_add_u32 s60, s60, 0
  v_add_u32 v58, s60, v58
  v_add_u32 v203, 57344, v58
  v_add_u32 v209, 131072, v58
  v_cndmask_b32 v62, v10, v12, s[46:47]
  s_mul_i32 s60, s57, 4096
  s_add_u32 s60, s60, 4096
  v_add_u32 v62, s60, v62
  v_add_u32 v204, 57344, v62
  v_add_u32 v210, 131072, v62
  v_cndmask_b32 v63, v11, v13, s[46:47]
  s_mul_i32 s60, s57, 4096
  s_add_u32 s60, s60, 4096
  v_add_u32 v63, s60, v63
  v_add_u32 v205, 57344, v63
  v_add_u32 v211, 131072, v63
  v_lshrrev_b32 v5, 3, v4
  v_mul_u32_u24 v5, 3584, v5
  v_add_u32 v213, v5, v59
  s_waitcnt vmcnt(33)
  s_barrier
  s_waitcnt vmcnt(13)
  ds_read_b128 a[32:35], v45 offset:24576
  ds_read_b128 a[36:39], v45 offset:26624
  ds_read_b128 a[40:43], v43 offset:24576
  ds_read_b128 a[44:47], v43 offset:26624
  ds_read_b128 a[48:51], v44 offset:24576
  ds_read_b128 a[52:55], v44 offset:26624
  ds_read_b128 a[56:59], v42 offset:24576
  ds_read_b128 a[60:63], v42 offset:26624
  s_waitcnt lgkmcnt(0)
  ds_read_b128 v[192:195], v212 offset:0
  ds_read_b64_tr_b16 v[144:145], v200 offset:0
  ds_read_b64_tr_b16 v[146:147], v200 offset:1024
  ds_read_b64_tr_b16 v[148:149], v201 offset:0
  ds_read_b64_tr_b16 v[150:151], v201 offset:1024
  ds_read_b64_tr_b16 v[152:153], v202 offset:0
  ds_read_b64_tr_b16 v[154:155], v202 offset:1024
  ds_read_b64_tr_b16 v[156:157], v203 offset:0
  ds_read_b64_tr_b16 v[158:159], v203 offset:1024
  ds_read_b64_tr_b16 v[160:161], v204 offset:0
  ds_read_b64_tr_b16 v[162:163], v204 offset:1024
  ds_read_b64_tr_b16 v[164:165], v205 offset:0
  ds_read_b64_tr_b16 v[166:167], v205 offset:1024
  s_waitcnt lgkmcnt(12)
  v_mfma_f32_16x16x32_bf16 v[48:51], v[192:195], a[144:147], 0
  v_mfma_f32_16x16x32_bf16 v[52:55], v[192:195], a[148:151], 0
  ds_read_b128 v[196:199], v212 offset:64
  s_waitcnt lgkmcnt(11)
  v_mfma_f32_16x16x32_bf16 v[96:99], v[144:147], a[144:147], 0
  ds_read_b64_tr_b16 v[168:169], v200 offset:12288
  v_mfma_f32_16x16x32_bf16 v[100:103], v[144:147], a[148:151], 0
  ds_read_b64_tr_b16 v[170:171], v200 offset:13312
  s_waitcnt lgkmcnt(11)
  v_mfma_f32_16x16x32_bf16 v[104:107], v[148:151], a[144:147], 0
  ds_read_b64_tr_b16 v[172:173], v201 offset:12288
  v_mfma_f32_16x16x32_bf16 v[108:111], v[148:151], a[148:151], 0
  ds_read_b64_tr_b16 v[174:175], v201 offset:13312
  s_waitcnt lgkmcnt(11)
  v_mfma_f32_16x16x32_bf16 v[112:115], v[152:155], a[144:147], 0
  ds_read_b64_tr_b16 v[176:177], v202 offset:12288
  v_mfma_f32_16x16x32_bf16 v[116:119], v[152:155], a[148:151], 0
  ds_read_b64_tr_b16 v[178:179], v202 offset:13312
  s_waitcnt lgkmcnt(11)
  v_mfma_f32_16x16x32_bf16 v[120:123], v[156:159], a[144:147], 0
  ds_read_b64_tr_b16 v[180:181], v203 offset:12288
  v_mfma_f32_16x16x32_bf16 v[124:127], v[156:159], a[148:151], 0
  ds_read_b64_tr_b16 v[182:183], v203 offset:13312
  s_waitcnt lgkmcnt(11)
  v_mfma_f32_16x16x32_bf16 v[128:131], v[160:163], a[144:147], 0
  ds_read_b64_tr_b16 v[184:185], v204 offset:12288
  v_mfma_f32_16x16x32_bf16 v[132:135], v[160:163], a[148:151], 0
  ds_read_b64_tr_b16 v[186:187], v204 offset:13312
  s_waitcnt lgkmcnt(11)
  v_mfma_f32_16x16x32_bf16 v[136:139], v[164:167], a[144:147], 0
  ds_read_b64_tr_b16 v[188:189], v205 offset:12288
  v_mfma_f32_16x16x32_bf16 v[140:143], v[164:167], a[148:151], 0
  ds_read_b64_tr_b16 v[190:191], v205 offset:13312
  s_barrier
  s_waitcnt lgkmcnt(12)
  v_mfma_f32_16x16x32_bf16 v[48:51], v[196:199], a[152:155], v[48:51]
  v_mfma_f32_16x16x32_bf16 v[52:55], v[196:199], a[156:159], v[52:55]
  ds_read_b128 v[192:195], v212 offset:128
  s_waitcnt lgkmcnt(11)
  v_mfma_f32_16x16x32_bf16 v[96:99], v[168:171], a[152:155], v[96:99]
  ds_read_b64_tr_b16 v[144:145], v200 offset:24576
  v_mfma_f32_16x16x32_bf16 v[100:103], v[168:171], a[156:159], v[100:103]
  ds_read_b64_tr_b16 v[146:147], v200 offset:25600
  s_waitcnt lgkmcnt(11)
  v_mfma_f32_16x16x32_bf16 v[104:107], v[172:175], a[152:155], v[104:107]
  ds_read_b64_tr_b16 v[148:149], v201 offset:24576
  v_mfma_f32_16x16x32_bf16 v[108:111], v[172:175], a[156:159], v[108:111]
  ds_read_b64_tr_b16 v[150:151], v201 offset:25600
  s_waitcnt lgkmcnt(11)
  v_mfma_f32_16x16x32_bf16 v[112:115], v[176:179], a[152:155], v[112:115]
  ds_read_b64_tr_b16 v[152:153], v202 offset:24576
  v_mfma_f32_16x16x32_bf16 v[116:119], v[176:179], a[156:159], v[116:119]
  ds_read_b64_tr_b16 v[154:155], v202 offset:25600
  s_waitcnt lgkmcnt(11)
  v_mfma_f32_16x16x32_bf16 v[120:123], v[180:183], a[152:155], v[120:123]
  ds_read_b64_tr_b16 v[156:157], v203 offset:24576
  v_mfma_f32_16x16x32_bf16 v[124:127], v[180:183], a[156:159], v[124:127]
  ds_read_b64_tr_b16 v[158:159], v203 offset:25600
  s_waitcnt lgkmcnt(11)
  v_mfma_f32_16x16x32_bf16 v[128:131], v[184:187], a[152:155], v[128:131]
  s_add_u32 m0, s3, 24576
  ds_read_b64_tr_b16 v[160:161], v204 offset:24576
  buffer_load_dwordx4 v46, s[16:19], s72 offen offset:0 lds
  v_mfma_f32_16x16x32_bf16 v[132:135], v[184:187], a[156:159], v[132:135]
  ds_read_b64_tr_b16 v[162:163], v204 offset:25600
  s_waitcnt lgkmcnt(11)
  v_mfma_f32_16x16x32_bf16 v[136:139], v[188:191], a[152:155], v[136:139]
  ds_read_b64_tr_b16 v[164:165], v205 offset:24576
  v_mfma_f32_16x16x32_bf16 v[140:143], v[188:191], a[156:159], v[140:143]
  ds_read_b64_tr_b16 v[166:167], v205 offset:25600
  s_waitcnt lgkmcnt(12)
  v_mfma_f32_16x16x32_bf16 v[48:51], v[192:195], a[160:163], v[48:51]
  s_add_u32 m0, s3, 25600
  v_mfma_f32_16x16x32_bf16 v[52:55], v[192:195], a[164:167], v[52:55]
  buffer_load_dwordx4 v46, s[16:19], s73 offen offset:0 lds
  ds_read_b128 v[196:199], v212 offset:192
  s_waitcnt lgkmcnt(11)
  v_mfma_f32_16x16x32_bf16 v[96:99], v[144:147], a[160:163], v[96:99]
  ds_read_b64_tr_b16 v[168:169], v200 offset:36864
  v_mfma_f32_16x16x32_bf16 v[100:103], v[144:147], a[164:167], v[100:103]
  ds_read_b64_tr_b16 v[170:171], v200 offset:37888
  s_waitcnt lgkmcnt(11)
  v_mfma_f32_16x16x32_bf16 v[104:107], v[148:151], a[160:163], v[104:107]
  ds_read_b64_tr_b16 v[172:173], v201 offset:36864
  v_mfma_f32_16x16x32_bf16 v[108:111], v[148:151], a[164:167], v[108:111]
  s_add_u32 m0, s3, 26624
  ds_read_b64_tr_b16 v[174:175], v201 offset:37888
  buffer_load_dwordx4 v46, s[16:19], s74 offen offset:0 lds
  s_waitcnt lgkmcnt(11)
  v_mfma_f32_16x16x32_bf16 v[112:115], v[152:155], a[160:163], v[112:115]
  ds_read_b64_tr_b16 v[176:177], v202 offset:36864
  v_mfma_f32_16x16x32_bf16 v[116:119], v[152:155], a[164:167], v[116:119]
  ds_read_b64_tr_b16 v[178:179], v202 offset:37888
  s_waitcnt lgkmcnt(11)
  v_mfma_f32_16x16x32_bf16 v[120:123], v[156:159], a[160:163], v[120:123]
  ds_read_b64_tr_b16 v[180:181], v203 offset:36864
  v_mfma_f32_16x16x32_bf16 v[124:127], v[156:159], a[164:167], v[124:127]
  s_add_u32 m0, s3, 27648
  ds_read_b64_tr_b16 v[182:183], v203 offset:37888
  buffer_load_dwordx4 v46, s[16:19], s75 offen offset:0 lds
  s_waitcnt lgkmcnt(11)
  v_mfma_f32_16x16x32_bf16 v[128:131], v[160:163], a[160:163], v[128:131]
  ds_read_b64_tr_b16 v[184:185], v204 offset:36864
  v_mfma_f32_16x16x32_bf16 v[132:135], v[160:163], a[164:167], v[132:135]
  ds_read_b64_tr_b16 v[186:187], v204 offset:37888
  s_waitcnt lgkmcnt(11)
  v_mfma_f32_16x16x32_bf16 v[136:139], v[164:167], a[160:163], v[136:139]
  ds_read_b64_tr_b16 v[188:189], v205 offset:36864
  v_mfma_f32_16x16x32_bf16 v[140:143], v[164:167], a[164:167], v[140:143]
  s_add_u32 m0, s3, 28672
  ds_read_b64_tr_b16 v[190:191], v205 offset:37888
  buffer_load_dwordx4 v46, s[16:19], s76 offen offset:0 lds
  s_barrier
  s_waitcnt lgkmcnt(12)
  v_mfma_f32_16x16x32_bf16 v[48:51], v[196:199], a[168:171], v[48:51]
  v_mfma_f32_16x16x32_bf16 v[52:55], v[196:199], a[172:175], v[52:55]
  s_add_u32 m0, s3, 29696
  ds_read_b128 v[192:195], v212 offset:256
  buffer_load_dwordx4 v46, s[16:19], s77 offen offset:0 lds
  s_waitcnt lgkmcnt(11)
  v_mfma_f32_16x16x32_bf16 v[96:99], v[168:171], a[168:171], v[96:99]
  ds_read_b64_tr_b16 v[144:145], v200 offset:49152
  v_mfma_f32_16x16x32_bf16 v[100:103], v[168:171], a[172:175], v[100:103]
  ds_read_b64_tr_b16 v[146:147], v200 offset:50176
  s_waitcnt lgkmcnt(11)
  v_mfma_f32_16x16x32_bf16 v[104:107], v[172:175], a[168:171], v[104:107]
  ds_read_b64_tr_b16 v[148:149], v201 offset:49152
  v_mfma_f32_16x16x32_bf16 v[108:111], v[172:175], a[172:175], v[108:111]
  s_add_u32 m0, s3, 30720
  ds_read_b64_tr_b16 v[150:151], v201 offset:50176
  buffer_load_dwordx4 v46, s[16:19], s78 offen offset:0 lds
  s_waitcnt lgkmcnt(11)
  v_mfma_f32_16x16x32_bf16 v[112:115], v[176:179], a[168:171], v[112:115]
  ds_read_b64_tr_b16 v[152:153], v202 offset:49152
  v_mfma_f32_16x16x32_bf16 v[116:119], v[176:179], a[172:175], v[116:119]
  ds_read_b64_tr_b16 v[154:155], v202 offset:50176
  s_waitcnt lgkmcnt(11)
  v_mfma_f32_16x16x32_bf16 v[120:123], v[180:183], a[168:171], v[120:123]
  ds_read_b64_tr_b16 v[156:157], v203 offset:49152
  v_mfma_f32_16x16x32_bf16 v[124:127], v[180:183], a[172:175], v[124:127]
  s_add_u32 m0, s3, 31744
  ds_read_b64_tr_b16 v[158:159], v203 offset:50176
  buffer_load_dwordx4 v46, s[16:19], s79 offen offset:0 lds
  v_add_u32 v46, 128, v46
  s_waitcnt lgkmcnt(11)
  v_mfma_f32_16x16x32_bf16 v[128:131], v[184:187], a[168:171], v[128:131]
  ds_read_b64_tr_b16 v[160:161], v204 offset:49152
  v_mfma_f32_16x16x32_bf16 v[132:135], v[184:187], a[172:175], v[132:135]
  ds_read_b64_tr_b16 v[162:163], v204 offset:50176
  s_waitcnt lgkmcnt(11)
  v_mfma_f32_16x16x32_bf16 v[136:139], v[188:191], a[168:171], v[136:139]
  ds_read_b64_tr_b16 v[164:165], v205 offset:49152
  v_mfma_f32_16x16x32_bf16 v[140:143], v[188:191], a[172:175], v[140:143]
  s_add_u32 m0, s58, 57344
  ds_read_b64_tr_b16 v[166:167], v205 offset:50176
  buffer_load_dwordx4 v39, s[12:15], s92 offen offset:0 lds
  s_waitcnt lgkmcnt(12)
  v_mfma_f32_16x16x32_bf16 v[48:51], v[192:195], a[176:179], v[48:51]
  v_mfma_f32_16x16x32_bf16 v[52:55], v[192:195], a[180:183], v[52:55]
  ds_read_b128 v[196:199], v212 offset:320
  s_waitcnt lgkmcnt(11)
  v_mfma_f32_16x16x32_bf16 v[96:99], v[144:147], a[176:179], v[96:99]
  ds_read_b64_tr_b16 v[168:169], v200 offset:61440
  v_mfma_f32_16x16x32_bf16 v[100:103], v[144:147], a[180:183], v[100:103]
  s_add_u32 m0, s58, 61312
  ds_read_b64_tr_b16 v[170:171], v200 offset:62464
  buffer_load_dwordx4 v39, s[12:15], s92 offen offset:128 lds
  s_waitcnt lgkmcnt(11)
  v_mfma_f32_16x16x32_bf16 v[104:107], v[148:151], a[176:179], v[104:107]
  ds_read_b64_tr_b16 v[172:173], v201 offset:61440
  v_mfma_f32_16x16x32_bf16 v[108:111], v[148:151], a[180:183], v[108:111]
  ds_read_b64_tr_b16 v[174:175], v201 offset:62464
  s_waitcnt lgkmcnt(11)
  v_mfma_f32_16x16x32_bf16 v[112:115], v[152:155], a[176:179], v[112:115]
  ds_read_b64_tr_b16 v[176:177], v202 offset:61440
  v_mfma_f32_16x16x32_bf16 v[116:119], v[152:155], a[180:183], v[116:119]
  s_add_u32 m0, s58, 65280
  ds_read_b64_tr_b16 v[178:179], v202 offset:62464
  buffer_load_dwordx4 v39, s[12:15], s92 offen offset:256 lds
  s_add_u32 s92, s92, 86016
  s_waitcnt lgkmcnt(11)
  v_mfma_f32_16x16x32_bf16 v[120:123], v[156:159], a[176:179], v[120:123]
  ds_read_b64_tr_b16 v[180:181], v203 offset:61440
  v_mfma_f32_16x16x32_bf16 v[124:127], v[156:159], a[180:183], v[124:127]
  ds_read_b64_tr_b16 v[182:183], v203 offset:62464
  s_waitcnt lgkmcnt(11)
  v_mfma_f32_16x16x32_bf16 v[128:131], v[160:163], a[176:179], v[128:131]
  ds_read_b64_tr_b16 v[184:185], v204 offset:61440
  v_mfma_f32_16x16x32_bf16 v[132:135], v[160:163], a[180:183], v[132:135]
  s_add_u32 m0, s58, 69632
  ds_read_b64_tr_b16 v[186:187], v204 offset:62464
  buffer_load_dwordx4 v39, s[12:15], s92 offen offset:0 lds
  s_waitcnt lgkmcnt(11)
  v_mfma_f32_16x16x32_bf16 v[136:139], v[164:167], a[176:179], v[136:139]
  ds_read_b64_tr_b16 v[188:189], v205 offset:61440
  v_mfma_f32_16x16x32_bf16 v[140:143], v[164:167], a[180:183], v[140:143]
  ds_read_b64_tr_b16 v[190:191], v205 offset:62464
  s_waitcnt vmcnt(19)
  s_barrier
  s_add_u32 m0, s58, 73600
  s_nop 0
  buffer_load_dwordx4 v39, s[12:15], s92 offen offset:128 lds
  s_waitcnt vmcnt(5)
  ds_read_b128 a[64:67], v45 offset:24576
  ds_read_b128 a[68:71], v45 offset:26624
  s_waitcnt lgkmcnt(14)
  ds_read_b128 a[72:75], v43 offset:24576
  s_waitcnt lgkmcnt(14)
  ds_read_b128 a[76:79], v43 offset:26624
  s_add_u32 m0, s58, 77568
  s_waitcnt lgkmcnt(14)
  ds_read_b128 a[80:83], v44 offset:24576
  buffer_load_dwordx4 v39, s[12:15], s92 offen offset:256 lds
  s_add_u32 s92, s92, 86016
  s_waitcnt lgkmcnt(14)
  ds_read_b128 a[84:87], v44 offset:26624
  s_waitcnt lgkmcnt(14)
  ds_read_b128 a[88:91], v42 offset:24576
  s_waitcnt lgkmcnt(14)
  ds_read_b128 a[92:95], v42 offset:26624
  s_waitcnt lgkmcnt(0)
  v_mfma_f32_16x16x32_bf16 v[48:51], v[196:199], a[184:187], v[48:51]
  s_add_u32 m0, s3, 24576
  v_mfma_f32_16x16x32_bf16 v[52:55], v[196:199], a[188:191], v[52:55]
  buffer_load_dwordx4 v46, s[16:19], s72 offen offset:0 lds
  ds_read_b128 v[192:195], v212 offset:384
  v_mfma_f32_16x16x32_bf16 v[96:99], v[168:171], a[184:187], v[96:99]
  ds_read_b64_tr_b16 v[144:145], v206 offset:0
  v_mfma_f32_16x16x32_bf16 v[100:103], v[168:171], a[188:191], v[100:103]
  ds_read_b64_tr_b16 v[146:147], v206 offset:1024
  v_mfma_f32_16x16x32_bf16 v[104:107], v[172:175], a[184:187], v[104:107]
  ds_read_b64_tr_b16 v[148:149], v207 offset:0
  v_mfma_f32_16x16x32_bf16 v[108:111], v[172:175], a[188:191], v[108:111]
  s_add_u32 m0, s3, 25600
  ds_read_b64_tr_b16 v[150:151], v207 offset:1024
  buffer_load_dwordx4 v46, s[16:19], s73 offen offset:0 lds
  v_mfma_f32_16x16x32_bf16 v[112:115], v[176:179], a[184:187], v[112:115]
  ds_read_b64_tr_b16 v[152:153], v208 offset:0
  v_mfma_f32_16x16x32_bf16 v[116:119], v[176:179], a[188:191], v[116:119]
  ds_read_b64_tr_b16 v[154:155], v208 offset:1024
  v_mfma_f32_16x16x32_bf16 v[120:123], v[180:183], a[184:187], v[120:123]
  ds_read_b64_tr_b16 v[156:157], v209 offset:0
  v_mfma_f32_16x16x32_bf16 v[124:127], v[180:183], a[188:191], v[124:127]
  s_add_u32 m0, s3, 26624
  ds_read_b64_tr_b16 v[158:159], v209 offset:1024
  buffer_load_dwordx4 v46, s[16:19], s74 offen offset:0 lds
  v_mfma_f32_16x16x32_bf16 v[128:131], v[184:187], a[184:187], v[128:131]
  ds_read_b64_tr_b16 v[160:161], v210 offset:0
  v_mfma_f32_16x16x32_bf16 v[132:135], v[184:187], a[188:191], v[132:135]
  ds_read_b64_tr_b16 v[162:163], v210 offset:1024
  v_mfma_f32_16x16x32_bf16 v[136:139], v[188:191], a[184:187], v[136:139]
  ds_read_b64_tr_b16 v[164:165], v211 offset:0
  v_mfma_f32_16x16x32_bf16 v[140:143], v[188:191], a[188:191], v[140:143]
  s_add_u32 m0, s3, 27648
  ds_read_b64_tr_b16 v[166:167], v211 offset:1024
  buffer_load_dwordx4 v46, s[16:19], s75 offen offset:0 lds
  s_waitcnt lgkmcnt(12)
  v_mfma_f32_16x16x32_bf16 v[48:51], v[192:195], a[192:195], v[48:51]
  v_mfma_f32_16x16x32_bf16 v[52:55], v[192:195], a[196:199], v[52:55]
  ds_read_b128 v[196:199], v212 offset:448
  s_waitcnt lgkmcnt(11)
  v_mfma_f32_16x16x32_bf16 v[96:99], v[144:147], a[192:195], v[96:99]
  ds_read_b64_tr_b16 v[168:169], v206 offset:12288
  v_mfma_f32_16x16x32_bf16 v[100:103], v[144:147], a[196:199], v[100:103]
  s_add_u32 m0, s3, 28672
  ds_read_b64_tr_b16 v[170:171], v206 offset:13312
  buffer_load_dwordx4 v46, s[16:19], s76 offen offset:0 lds
  s_waitcnt lgkmcnt(11)
  v_mfma_f32_16x16x32_bf16 v[104:107], v[148:151], a[192:195], v[104:107]
  ds_read_b64_tr_b16 v[172:173], v207 offset:12288
  v_mfma_f32_16x16x32_bf16 v[108:111], v[148:151], a[196:199], v[108:111]
  ds_read_b64_tr_b16 v[174:175], v207 offset:13312
  s_waitcnt lgkmcnt(11)
  v_mfma_f32_16x16x32_bf16 v[112:115], v[152:155], a[192:195], v[112:115]
  ds_read_b64_tr_b16 v[176:177], v208 offset:12288
  v_mfma_f32_16x16x32_bf16 v[116:119], v[152:155], a[196:199], v[116:119]
  s_add_u32 m0, s3, 29696
  ds_read_b64_tr_b16 v[178:179], v208 offset:13312
  buffer_load_dwordx4 v46, s[16:19], s77 offen offset:0 lds
  s_waitcnt lgkmcnt(11)
  v_mfma_f32_16x16x32_bf16 v[120:123], v[156:159], a[192:195], v[120:123]
  ds_read_b64_tr_b16 v[180:181], v209 offset:12288
  v_mfma_f32_16x16x32_bf16 v[124:127], v[156:159], a[196:199], v[124:127]
  ds_read_b64_tr_b16 v[182:183], v209 offset:13312
  s_waitcnt lgkmcnt(11)
  v_mfma_f32_16x16x32_bf16 v[128:131], v[160:163], a[192:195], v[128:131]
  ds_read_b64_tr_b16 v[184:185], v210 offset:12288
  v_mfma_f32_16x16x32_bf16 v[132:135], v[160:163], a[196:199], v[132:135]
  s_add_u32 m0, s3, 30720
  ds_read_b64_tr_b16 v[186:187], v210 offset:13312
  buffer_load_dwordx4 v46, s[16:19], s78 offen offset:0 lds
  s_waitcnt lgkmcnt(11)
  v_mfma_f32_16x16x32_bf16 v[136:139], v[164:167], a[192:195], v[136:139]
  ds_read_b64_tr_b16 v[188:189], v211 offset:12288
  v_mfma_f32_16x16x32_bf16 v[140:143], v[164:167], a[196:199], v[140:143]
  ds_read_b64_tr_b16 v[190:191], v211 offset:13312
  s_barrier
  s_add_u32 m0, s3, 31744
  s_waitcnt lgkmcnt(12)
  v_mfma_f32_16x16x32_bf16 v[48:51], v[196:199], a[200:203], v[48:51]
  buffer_load_dwordx4 v46, s[16:19], s79 offen offset:0 lds
  v_add_u32 v46, 128, v46
  v_mfma_f32_16x16x32_bf16 v[52:55], v[196:199], a[204:207], v[52:55]
  ds_read_b128 v[192:195], v212 offset:512
  s_waitcnt lgkmcnt(11)
  v_mfma_f32_16x16x32_bf16 v[96:99], v[168:171], a[200:203], v[96:99]
  ds_read_b64_tr_b16 v[144:145], v47 offset:0
  v_mfma_f32_16x16x32_bf16 v[100:103], v[168:171], a[204:207], v[100:103]
  ds_read_b64_tr_b16 v[146:147], v47 offset:1024
  s_waitcnt lgkmcnt(11)
  v_mfma_f32_16x16x32_bf16 v[104:107], v[172:175], a[200:203], v[104:107]
  s_add_u32 m0, s58, 81920
  ds_read_b64_tr_b16 v[148:149], v56 offset:0
  buffer_load_dwordx4 v39, s[12:15], s92 offen offset:0 lds
  v_mfma_f32_16x16x32_bf16 v[108:111], v[172:175], a[204:207], v[108:111]
  ds_read_b64_tr_b16 v[150:151], v56 offset:1024
  s_waitcnt lgkmcnt(11)
  v_mfma_f32_16x16x32_bf16 v[112:115], v[176:179], a[200:203], v[112:115]
  ds_read_b64_tr_b16 v[152:153], v57 offset:0
  v_mfma_f32_16x16x32_bf16 v[116:119], v[176:179], a[204:207], v[116:119]
  ds_read_b64_tr_b16 v[154:155], v57 offset:1024
  s_waitcnt lgkmcnt(11)
  v_mfma_f32_16x16x32_bf16 v[120:123], v[180:183], a[200:203], v[120:123]
  s_add_u32 m0, s58, 85888
  ds_read_b64_tr_b16 v[156:157], v58 offset:0
  buffer_load_dwordx4 v39, s[12:15], s92 offen offset:128 lds
  v_mfma_f32_16x16x32_bf16 v[124:127], v[180:183], a[204:207], v[124:127]
  ds_read_b64_tr_b16 v[158:159], v58 offset:1024
  s_waitcnt lgkmcnt(11)
  v_mfma_f32_16x16x32_bf16 v[128:131], v[184:187], a[200:203], v[128:131]
  ds_read_b64_tr_b16 v[160:161], v62 offset:0
  v_mfma_f32_16x16x32_bf16 v[132:135], v[184:187], a[204:207], v[132:135]
  ds_read_b64_tr_b16 v[162:163], v62 offset:1024
  s_waitcnt lgkmcnt(11)
  v_mfma_f32_16x16x32_bf16 v[136:139], v[188:191], a[200:203], v[136:139]
  s_add_u32 m0, s58, 89856
  ds_read_b64_tr_b16 v[164:165], v63 offset:0
  buffer_load_dwordx4 v39, s[12:15], s92 offen offset:256 lds
  s_add_u32 s92, s92, 86016
  v_mfma_f32_16x16x32_bf16 v[140:143], v[188:191], a[204:207], v[140:143]
  ds_read_b64_tr_b16 v[166:167], v63 offset:1024
  s_waitcnt lgkmcnt(12)
  v_mfma_f32_16x16x32_bf16 v[48:51], v[192:195], a[208:211], v[48:51]
  v_mfma_f32_16x16x32_bf16 v[52:55], v[192:195], a[212:215], v[52:55]
  ds_read_b128 v[196:199], v212 offset:576
  s_waitcnt lgkmcnt(11)
  v_mfma_f32_16x16x32_bf16 v[96:99], v[144:147], a[208:211], v[96:99]
  s_add_u32 m0, s58, 94208
  ds_read_b64_tr_b16 v[168:169], v47 offset:12288
  buffer_load_dwordx4 v39, s[12:15], s92 offen offset:0 lds
  v_mfma_f32_16x16x32_bf16 v[100:103], v[144:147], a[212:215], v[100:103]
  ds_read_b64_tr_b16 v[170:171], v47 offset:13312
  s_waitcnt lgkmcnt(11)
  v_mfma_f32_16x16x32_bf16 v[104:107], v[148:151], a[208:211], v[104:107]
  ds_read_b64_tr_b16 v[172:173], v56 offset:12288
  v_mfma_f32_16x16x32_bf16 v[108:111], v[148:151], a[212:215], v[108:111]
  ds_read_b64_tr_b16 v[174:175], v56 offset:13312
  s_waitcnt lgkmcnt(11)
  v_mfma_f32_16x16x32_bf16 v[112:115], v[152:155], a[208:211], v[112:115]
  s_add_u32 m0, s58, 98176
  ds_read_b64_tr_b16 v[176:177], v57 offset:12288
  buffer_load_dwordx4 v39, s[12:15], s92 offen offset:128 lds
  v_mfma_f32_16x16x32_bf16 v[116:119], v[152:155], a[212:215], v[116:119]
  ds_read_b64_tr_b16 v[178:179], v57 offset:13312
  s_waitcnt lgkmcnt(11)
  v_mfma_f32_16x16x32_bf16 v[120:123], v[156:159], a[208:211], v[120:123]
  ds_read_b64_tr_b16 v[180:181], v58 offset:12288
  v_mfma_f32_16x16x32_bf16 v[124:127], v[156:159], a[212:215], v[124:127]
  ds_read_b64_tr_b16 v[182:183], v58 offset:13312
  s_waitcnt lgkmcnt(11)
  v_mfma_f32_16x16x32_bf16 v[128:131], v[160:163], a[208:211], v[128:131]
  s_add_u32 m0, s58, 102144
  ds_read_b64_tr_b16 v[184:185], v62 offset:12288
  buffer_load_dwordx4 v39, s[12:15], s92 offen offset:256 lds
  s_add_u32 s92, s92, 86016
  v_mfma_f32_16x16x32_bf16 v[132:135], v[160:163], a[212:215], v[132:135]
  ds_read_b64_tr_b16 v[186:187], v62 offset:13312
  s_waitcnt lgkmcnt(11)
  v_mfma_f32_16x16x32_bf16 v[136:139], v[164:167], a[208:211], v[136:139]
  ds_read_b64_tr_b16 v[188:189], v63 offset:12288
  v_mfma_f32_16x16x32_bf16 v[140:143], v[164:167], a[212:215], v[140:143]
  ds_read_b64_tr_b16 v[190:191], v63 offset:13312
  s_waitcnt vmcnt(14)
  s_barrier
  s_waitcnt lgkmcnt(12)
  v_mfma_f32_16x16x32_bf16 v[48:51], v[196:199], a[216:219], v[48:51]
  buffer_load_dwordx4 v[216:219], v213, s[20:23], s94 offen offset:0 sc1
  v_mfma_f32_16x16x32_bf16 v[52:55], v[196:199], a[220:223], v[52:55]
  ds_read_b128 v[192:195], v212 offset:640
  s_waitcnt lgkmcnt(11)
  v_mfma_f32_16x16x32_bf16 v[96:99], v[168:171], a[216:219], v[96:99]
  ds_read_b64_tr_b16 v[144:145], v200 offset:0
  v_mfma_f32_16x16x32_bf16 v[100:103], v[168:171], a[220:223], v[100:103]
  ds_read_b64_tr_b16 v[146:147], v200 offset:1024
  s_waitcnt lgkmcnt(11)
  v_mfma_f32_16x16x32_bf16 v[104:107], v[172:175], a[216:219], v[104:107]
  ds_read_b64_tr_b16 v[148:149], v201 offset:0
  buffer_load_dwordx4 v[220:223], v213, s[20:23], s94 offen offset:512 sc1
  v_mfma_f32_16x16x32_bf16 v[108:111], v[172:175], a[220:223], v[108:111]
  ds_read_b64_tr_b16 v[150:151], v201 offset:1024
  s_waitcnt lgkmcnt(11)
  v_mfma_f32_16x16x32_bf16 v[112:115], v[176:179], a[216:219], v[112:115]
  ds_read_b64_tr_b16 v[152:153], v202 offset:0
  v_mfma_f32_16x16x32_bf16 v[116:119], v[176:179], a[220:223], v[116:119]
  ds_read_b64_tr_b16 v[154:155], v202 offset:1024
  s_waitcnt lgkmcnt(11)
  v_mfma_f32_16x16x32_bf16 v[120:123], v[180:183], a[216:219], v[120:123]
  ds_read_b64_tr_b16 v[156:157], v203 offset:0
  buffer_load_dwordx4 v[224:227], v213, s[20:23], s94 offen offset:1024 sc1
  v_mfma_f32_16x16x32_bf16 v[124:127], v[180:183], a[220:223], v[124:127]
  ds_read_b64_tr_b16 v[158:159], v203 offset:1024
  s_waitcnt lgkmcnt(11)
  v_mfma_f32_16x16x32_bf16 v[128:131], v[184:187], a[216:219], v[128:131]
  ds_read_b64_tr_b16 v[160:161], v204 offset:0
  v_mfma_f32_16x16x32_bf16 v[132:135], v[184:187], a[220:223], v[132:135]
  ds_read_b64_tr_b16 v[162:163], v204 offset:1024
  s_waitcnt lgkmcnt(11)
  v_mfma_f32_16x16x32_bf16 v[136:139], v[188:191], a[216:219], v[136:139]
  ds_read_b64_tr_b16 v[164:165], v205 offset:0
  buffer_load_dwordx4 v[228:231], v213, s[20:23], s94 offen offset:1536 sc1
  v_mfma_f32_16x16x32_bf16 v[140:143], v[188:191], a[220:223], v[140:143]
  ds_read_b64_tr_b16 v[166:167], v205 offset:1024
  s_waitcnt lgkmcnt(12)
  v_mfma_f32_16x16x32_bf16 v[48:51], v[192:195], a[224:227], v[48:51]
  v_mfma_f32_16x16x32_bf16 v[52:55], v[192:195], a[228:231], v[52:55]
  ds_read_b128 v[196:199], v212 offset:704
  s_waitcnt lgkmcnt(11)
  v_mfma_f32_16x16x32_bf16 v[96:99], v[144:147], a[224:227], v[96:99]
  ds_read_b64_tr_b16 v[168:169], v200 offset:12288
  buffer_load_dwordx4 v[232:235], v213, s[20:23], s94 offen offset:2048 sc1
  v_mfma_f32_16x16x32_bf16 v[100:103], v[144:147], a[228:231], v[100:103]
  ds_read_b64_tr_b16 v[170:171], v200 offset:13312
  s_waitcnt lgkmcnt(11)
  v_mfma_f32_16x16x32_bf16 v[104:107], v[148:151], a[224:227], v[104:107]
  ds_read_b64_tr_b16 v[172:173], v201 offset:12288
  v_mfma_f32_16x16x32_bf16 v[108:111], v[148:151], a[228:231], v[108:111]
  ds_read_b64_tr_b16 v[174:175], v201 offset:13312
  s_waitcnt lgkmcnt(11)
  v_mfma_f32_16x16x32_bf16 v[112:115], v[152:155], a[224:227], v[112:115]
  ds_read_b64_tr_b16 v[176:177], v202 offset:12288
  buffer_load_dwordx4 v[236:239], v213, s[20:23], s94 offen offset:2560 sc1
  v_mfma_f32_16x16x32_bf16 v[116:119], v[152:155], a[228:231], v[116:119]
  ds_read_b64_tr_b16 v[178:179], v202 offset:13312
  s_waitcnt lgkmcnt(11)
  v_mfma_f32_16x16x32_bf16 v[120:123], v[156:159], a[224:227], v[120:123]
  ds_read_b64_tr_b16 v[180:181], v203 offset:12288
  v_mfma_f32_16x16x32_bf16 v[124:127], v[156:159], a[228:231], v[124:127]
  ds_read_b64_tr_b16 v[182:183], v203 offset:13312
  s_waitcnt lgkmcnt(11)
  v_mfma_f32_16x16x32_bf16 v[128:131], v[160:163], a[224:227], v[128:131]
  ds_read_b64_tr_b16 v[184:185], v204 offset:12288
  buffer_load_dwordx4 v[240:243], v213, s[20:23], s94 offen offset:3072 sc1
  v_mfma_f32_16x16x32_bf16 v[132:135], v[160:163], a[228:231], v[132:135]
  ds_read_b64_tr_b16 v[186:187], v204 offset:13312
  s_waitcnt lgkmcnt(11)
  v_mfma_f32_16x16x32_bf16 v[136:139], v[164:167], a[224:227], v[136:139]
  ds_read_b64_tr_b16 v[188:189], v205 offset:12288
  v_mfma_f32_16x16x32_bf16 v[140:143], v[164:167], a[228:231], v[140:143]
  ds_read_b64_tr_b16 v[190:191], v205 offset:13312
  s_waitcnt vmcnt(7)
  s_barrier
  s_add_u32 m0, s58, 106496
  s_nop 0
  buffer_load_dwordx4 v38, s[8:11], s91 offen offset:0 lds
  ds_read_b128 a[96:99], v45 offset:24576
  ds_read_b128 a[100:103], v45 offset:26624
  s_waitcnt lgkmcnt(14)
  ds_read_b128 a[104:107], v43 offset:24576
  s_waitcnt lgkmcnt(14)
  ds_read_b128 a[108:111], v43 offset:26624
  s_add_u32 m0, s58, 110464
  s_waitcnt lgkmcnt(14)
  ds_read_b128 a[112:115], v44 offset:24576
  buffer_load_dwordx4 v38, s[8:11], s91 offen offset:128 lds
  s_add_u32 s91, s91, 114688
  s_waitcnt lgkmcnt(14)
  ds_read_b128 a[116:119], v44 offset:26624
  s_waitcnt lgkmcnt(14)
  ds_read_b128 a[120:123], v42 offset:24576
  s_waitcnt lgkmcnt(14)
  ds_read_b128 a[124:127], v42 offset:26624
  s_waitcnt lgkmcnt(0)
  s_lshl_b32 s60, s53, 7
  s_lshl_b32 s61, s54, 4
  s_add_u32 m0, s58, 114688
  s_add_u32 s60, s60, s61
  buffer_load_dwordx4 v38, s[8:11], s91 offen offset:0 lds
  s_lshl_b32 s62, s52, 2
  s_add_u32 s60, s60, s62
  s_add_u32 s95, s60, 8192
  s_lshl_b32 s60, s54, 2
  s_lshr_b32 s61, s53, 3
  s_add_u32 s60, s60, s61
  s_lshl_b32 s60, s60, 7
  s_and_b32 s61, s53, 7
  s_lshl_b32 s61, s61, 4
  s_add_u32 s60, s60, s61
  s_add_u32 s60, s60, s62
  s_add_u32 s96, s60, 4096
  v_mfma_f32_16x16x32_bf16 v[48:51], v[196:199], a[232:235], v[48:51]
  s_add_u32 m0, s58, 118656
  v_mfma_f32_16x16x32_bf16 v[52:55], v[196:199], a[236:239], v[52:55]
  buffer_load_dwordx4 v38, s[8:11], s91 offen offset:128 lds
  s_add_u32 s91, s91, 114688
  ds_read_b128 v[192:195], v212 offset:768
  v_mfma_f32_16x16x32_bf16 v[96:99], v[168:171], a[232:235], v[96:99]
  ds_read_b64_tr_b16 v[144:145], v200 offset:24576
  v_mfma_f32_16x16x32_bf16 v[100:103], v[168:171], a[236:239], v[100:103]
  ds_read_b64_tr_b16 v[146:147], v200 offset:25600
  v_mfma_f32_16x16x32_bf16 v[104:107], v[172:175], a[232:235], v[104:107]
  s_add_u32 m0, s58, 122880
  ds_read_b64_tr_b16 v[148:149], v201 offset:24576
  buffer_load_dwordx4 v38, s[8:11], s91 offen offset:0 lds
  v_mfma_f32_16x16x32_bf16 v[108:111], v[172:175], a[236:239], v[108:111]
  ds_read_b64_tr_b16 v[150:151], v201 offset:25600
  v_mfma_f32_16x16x32_bf16 v[112:115], v[176:179], a[232:235], v[112:115]
  ds_read_b64_tr_b16 v[152:153], v202 offset:24576
  v_mfma_f32_16x16x32_bf16 v[116:119], v[176:179], a[236:239], v[116:119]
  ds_read_b64_tr_b16 v[154:155], v202 offset:25600
  v_mfma_f32_16x16x32_bf16 v[120:123], v[180:183], a[232:235], v[120:123]
  s_add_u32 m0, s58, 126848
  ds_read_b64_tr_b16 v[156:157], v203 offset:24576
  buffer_load_dwordx4 v38, s[8:11], s91 offen offset:128 lds
  s_add_u32 s91, s91, 114688
  v_mfma_f32_16x16x32_bf16 v[124:127], v[180:183], a[236:239], v[124:127]
  ds_read_b64_tr_b16 v[158:159], v203 offset:25600
  v_mfma_f32_16x16x32_bf16 v[128:131], v[184:187], a[232:235], v[128:131]
  ds_read_b64_tr_b16 v[160:161], v204 offset:24576
  v_mfma_f32_16x16x32_bf16 v[132:135], v[184:187], a[236:239], v[132:135]
  ds_read_b64_tr_b16 v[162:163], v204 offset:25600
  v_mfma_f32_16x16x32_bf16 v[136:139], v[188:191], a[232:235], v[136:139]
  s_add_u32 m0, s58, 131072
  ds_read_b64_tr_b16 v[164:165], v205 offset:24576
  buffer_load_dwordx4 v38, s[8:11], s91 offen offset:0 lds
  v_mfma_f32_16x16x32_bf16 v[140:143], v[188:191], a[236:239], v[140:143]
  ds_read_b64_tr_b16 v[166:167], v205 offset:25600
  s_waitcnt lgkmcnt(12)
  v_mfma_f32_16x16x32_bf16 v[48:51], v[192:195], a[240:243], v[48:51]
  v_mfma_f32_16x16x32_bf16 v[52:55], v[192:195], a[244:247], v[52:55]
  ds_read_b128 v[196:199], v212 offset:832
  s_waitcnt lgkmcnt(11)
  v_mfma_f32_16x16x32_bf16 v[96:99], v[144:147], a[240:243], v[96:99]
  s_add_u32 m0, s58, 135040
  ds_read_b64_tr_b16 v[168:169], v200 offset:36864
  buffer_load_dwordx4 v38, s[8:11], s91 offen offset:128 lds
  s_add_u32 s91, s91, 114688
  v_mfma_f32_16x16x32_bf16 v[100:103], v[144:147], a[244:247], v[100:103]
  ds_read_b64_tr_b16 v[170:171], v200 offset:37888
  s_waitcnt lgkmcnt(11)
  v_mfma_f32_16x16x32_bf16 v[104:107], v[148:151], a[240:243], v[104:107]
  ds_read_b64_tr_b16 v[172:173], v201 offset:36864
  v_mfma_f32_16x16x32_bf16 v[108:111], v[148:151], a[244:247], v[108:111]
  ds_read_b64_tr_b16 v[174:175], v201 offset:37888
  s_waitcnt lgkmcnt(11)
  v_mfma_f32_16x16x32_bf16 v[112:115], v[152:155], a[240:243], v[112:115]
  s_add_u32 m0, s58, 139264
  ds_read_b64_tr_b16 v[176:177], v202 offset:36864
  buffer_load_dwordx4 v38, s[8:11], s91 offen offset:0 lds
  v_mfma_f32_16x16x32_bf16 v[116:119], v[152:155], a[244:247], v[116:119]
  ds_read_b64_tr_b16 v[178:179], v202 offset:37888
  s_waitcnt lgkmcnt(11)
  v_mfma_f32_16x16x32_bf16 v[120:123], v[156:159], a[240:243], v[120:123]
  ds_read_b64_tr_b16 v[180:181], v203 offset:36864
  v_mfma_f32_16x16x32_bf16 v[124:127], v[156:159], a[244:247], v[124:127]
  ds_read_b64_tr_b16 v[182:183], v203 offset:37888
  s_waitcnt lgkmcnt(11)
  v_mfma_f32_16x16x32_bf16 v[128:131], v[160:163], a[240:243], v[128:131]
  s_add_u32 m0, s58, 143232
  ds_read_b64_tr_b16 v[184:185], v204 offset:36864
  buffer_load_dwordx4 v38, s[8:11], s91 offen offset:128 lds
  s_add_u32 s91, s91, 114688
  v_mfma_f32_16x16x32_bf16 v[132:135], v[160:163], a[244:247], v[132:135]
  ds_read_b64_tr_b16 v[186:187], v204 offset:37888
  s_waitcnt lgkmcnt(11)
  v_mfma_f32_16x16x32_bf16 v[136:139], v[164:167], a[240:243], v[136:139]
  ds_read_b64_tr_b16 v[188:189], v205 offset:36864
  v_mfma_f32_16x16x32_bf16 v[140:143], v[164:167], a[244:247], v[140:143]
  ds_read_b64_tr_b16 v[190:191], v205 offset:37888
  s_waitcnt lgkmcnt(12)
  v_mfma_f32_16x16x32_bf16 v[48:51], v[196:199], a[248:251], v[48:51]
  s_add_u32 m0, s58, 147456
  v_mfma_f32_16x16x32_bf16 v[52:55], v[196:199], a[252:255], v[52:55]
  buffer_load_dwordx4 v38, s[8:11], s91 offen offset:0 lds
  s_waitcnt lgkmcnt(10)
  v_mfma_f32_16x16x32_bf16 v[96:99], v[168:171], a[248:251], v[96:99]
  v_mfma_f32_16x16x32_bf16 v[100:103], v[168:171], a[252:255], v[100:103]
  s_waitcnt lgkmcnt(8)
  v_mfma_f32_16x16x32_bf16 v[104:107], v[172:175], a[248:251], v[104:107]
  v_mfma_f32_16x16x32_bf16 v[108:111], v[172:175], a[252:255], v[108:111]
  s_add_u32 m0, s58, 151424
  s_waitcnt lgkmcnt(6)
  v_mfma_f32_16x16x32_bf16 v[112:115], v[176:179], a[248:251], v[112:115]
  buffer_load_dwordx4 v38, s[8:11], s91 offen offset:128 lds
  s_add_u32 s91, s91, 114688
  v_mfma_f32_16x16x32_bf16 v[116:119], v[176:179], a[252:255], v[116:119]
  s_waitcnt lgkmcnt(4)
  v_mfma_f32_16x16x32_bf16 v[120:123], v[180:183], a[248:251], v[120:123]
  v_mfma_f32_16x16x32_bf16 v[124:127], v[180:183], a[252:255], v[124:127]
  s_waitcnt lgkmcnt(2)
  v_mfma_f32_16x16x32_bf16 v[128:131], v[184:187], a[248:251], v[128:131]
  s_add_u32 m0, s3, 24576
  v_mfma_f32_16x16x32_bf16 v[132:135], v[184:187], a[252:255], v[132:135]
  buffer_load_dwordx4 v46, s[16:19], s72 offen offset:0 lds
  s_waitcnt lgkmcnt(0)
  v_mfma_f32_16x16x32_bf16 v[136:139], v[188:191], a[248:251], v[136:139]
  v_mfma_f32_16x16x32_bf16 v[140:143], v[188:191], a[252:255], v[140:143]
  s_barrier
  s_add_u32 m0, s3, 25600
  s_lshl_b32 s60, s53, 2
  buffer_load_dwordx4 v46, s[16:19], s73 offen offset:0 lds
  s_lshl_b32 s61, s56, 1
  s_add_u32 s60, s60, s61
  s_mul_i32 s60, s60, 168
  s_mul_i32 s61, s54, 24
  s_add_u32 s60, s60, s61
  s_mul_i32 s61, s57, 12
  s_add_u32 s60, s60, s61
  s_lshl_b32 s60, s60, 8
  s_add_u32 s98, s60, 5242880
  s_add_u32 s99, s98, 43008
  v_cvt_pk_bf16_f32 v144, v96, v97
  v_cvt_pk_bf16_f32 v145, v98, v99
  v_cvt_pk_bf16_f32 v146, v104, v105
  v_cvt_pk_bf16_f32 v147, v106, v107
  s_add_u32 m0, s3, 26624
  v_cvt_pk_bf16_f32 v148, v112, v113
  buffer_load_dwordx4 v46, s[16:19], s74 offen offset:0 lds
  v_cvt_pk_bf16_f32 v149, v114, v115
  v_cvt_pk_bf16_f32 v150, v120, v121
  v_cvt_pk_bf16_f32 v151, v122, v123
  v_cvt_pk_bf16_f32 v152, v128, v129
  v_cvt_pk_bf16_f32 v153, v130, v131
  v_cvt_pk_bf16_f32 v154, v136, v137
  v_cvt_pk_bf16_f32 v155, v138, v139
  v_cvt_pk_bf16_f32 v156, v100, v101
  v_cvt_pk_bf16_f32 v157, v102, v103
  v_cvt_pk_bf16_f32 v158, v108, v109
  s_add_u32 m0, s3, 27648
  v_cvt_pk_bf16_f32 v159, v110, v111
  buffer_load_dwordx4 v46, s[16:19], s75 offen offset:0 lds
  v_cvt_pk_bf16_f32 v160, v116, v117
  v_cvt_pk_bf16_f32 v161, v118, v119
  v_cvt_pk_bf16_f32 v162, v124, v125
  v_cvt_pk_bf16_f32 v163, v126, v127
  v_cvt_pk_bf16_f32 v164, v132, v133
  v_cvt_pk_bf16_f32 v165, v134, v135
  v_cvt_pk_bf16_f32 v166, v140, v141
  v_cvt_pk_bf16_f32 v167, v142, v143
  v_permlane32_swap_b32 v144, v146
  v_permlane32_swap_b32 v145, v147
  s_add_u32 m0, s3, 28672
  v_permlane32_swap_b32 v148, v150
  buffer_load_dwordx4 v46, s[16:19], s76 offen offset:0 lds
  v_permlane32_swap_b32 v149, v151
  v_permlane32_swap_b32 v152, v154
  v_permlane32_swap_b32 v153, v155
  v_permlane32_swap_b32 v156, v158
  v_permlane32_swap_b32 v157, v159
  v_permlane32_swap_b32 v160, v162
  s_add_u32 m0, s3, 29696
  v_permlane32_swap_b32 v161, v163
  buffer_load_dwordx4 v46, s[16:19], s77 offen offset:0 lds
  v_permlane32_swap_b32 v164, v166
  v_permlane32_swap_b32 v165, v167
  v_permlane16_swap_b32 v144, v146
  v_permlane16_swap_b32 v145, v147
  v_permlane16_swap_b32 v148, v150
  v_permlane16_swap_b32 v149, v151
  s_add_u32 m0, s3, 30720
  v_permlane16_swap_b32 v152, v154
  buffer_load_dwordx4 v46, s[16:19], s78 offen offset:0 lds
  v_permlane16_swap_b32 v153, v155
  v_permlane16_swap_b32 v156, v158
  v_permlane16_swap_b32 v157, v159
  v_permlane16_swap_b32 v160, v162
  v_permlane16_swap_b32 v161, v163
  v_permlane16_swap_b32 v164, v166
  s_add_u32 m0, s3, 31744
  v_permlane16_swap_b32 v165, v167
  buffer_load_dwordx4 v46, s[16:19], s79 offen offset:0 lds
  v_add_u32 v46, 128, v46
  v_mul_f32 v170, 1069066811, v48
  v_mul_f32 v171, 1069066811, v52
  v_exp_f32 v170, v170
  v_exp_f32 v171, v171
  v_add_f32 v170, 1.0, v170
  v_add_f32 v171, 1.0, v171
  v_rcp_f32 v170, v170
  s_add_u32 m0, s58, 0
  v_rcp_f32 v171, v171
  buffer_load_dwordx4 v38, s[8:11], s91 offen offset:0 lds
  v_sub_f32 v168, 1.0, v170
  v_sub_f32 v169, 1.0, v171
  v_mov_b32 v16, v170
  v_mov_b32 v17, v170
  v_mov_b32 v18, v171
  v_mov_b32 v19, v171
  s_lshl_b32 s60, s56, 7
  s_add_u32 s60, s60, 156672
  v_lshlrev_b32 v5, 2, v4
  v_add_u32 v5, s60, v5
  ds_write_b32 v5, v168
  s_add_u32 m0, s58, 3968
  ds_write_b32 v5, v169 offset:64
  buffer_load_dwordx4 v38, s[8:11], s91 offen offset:128 lds
  s_add_u32 s91, s91, 114688
  v_lshrrev_b32 v5, 2, v4
  v_and_b32 v6, 3, v4
  v_lshl_add_u32 v5, v5, 3, v6
  v_lshlrev_b32 v5, 1, v5
  s_lshl_b32 s60, s53, 6
  s_lshl_b32 s61, s56, 5
  s_add_u32 s60, s60, s61
  s_lshl_b32 s60, s60, 1
  buffer_load_ushort v48, v5, s[36:39], s60 offen
  buffer_load_ushort v49, v5, s[36:39], s60 offen offset:8
  s_add_u32 m0, s58, 8192
  s_nop 0
  buffer_load_dwordx4 v38, s[8:11], s91 offen offset:0 lds
  s_add_u32 m0, s58, 12160
  s_nop 0
  buffer_load_dwordx4 v38, s[8:11], s91 offen offset:128 lds
  s_add_u32 s91, s91, 114688
  s_add_u32 m0, s58, 57344
  s_nop 0
  buffer_load_dwordx4 v38, s[8:11], s91 offen offset:0 lds
  s_add_u32 m0, s58, 61312
  s_nop 0
  buffer_load_dwordx4 v38, s[8:11], s91 offen offset:128 lds
  s_add_u32 s91, s91, 114688
  s_add_u32 m0, s58, 65536
  s_nop 0
  buffer_load_dwordx4 v38, s[8:11], s91 offen offset:0 lds
  s_add_u32 m0, s58, 69504
  s_nop 0
  buffer_load_dwordx4 v38, s[8:11], s91 offen offset:128 lds
  s_add_u32 s91, s91, 114688
  s_add_u32 m0, s58, 73728
  s_nop 0
  buffer_load_dwordx4 v38, s[8:11], s91 offen offset:0 lds
  s_add_u32 m0, s58, 77696
  s_nop 0
  buffer_load_dwordx4 v38, s[8:11], s91 offen offset:128 lds
  s_add_u32 s91, s91, 114688
  s_add_u32 m0, s58, 81920
  s_nop 0
  buffer_load_dwordx4 v38, s[8:11], s91 offen offset:0 lds
  s_add_u32 m0, s58, 85888
  s_nop 0
  buffer_load_dwordx4 v38, s[8:11], s91 offen offset:128 lds
  s_add_u32 s91, s91, 114688
  s_add_u32 m0, s58, 90112
  s_nop 0
  buffer_load_dwordx4 v38, s[8:11], s91 offen offset:0 lds
  s_add_u32 m0, s58, 94080
  s_nop 0
  buffer_load_dwordx4 v38, s[8:11], s91 offen offset:128 lds
  s_add_u32 s91, s91, 114688
  s_add_u32 m0, s58, 98304
  s_nop 0
  buffer_load_dwordx4 v38, s[8:11], s91 offen offset:0 lds
  s_add_u32 m0, s58, 102272
  s_nop 0
  buffer_load_dwordx4 v38, s[8:11], s91 offen offset:128 lds
  s_add_u32 s91, s91, 114688
  s_waitcnt vmcnt(38)
  s_mov_b32 s63, 0
  s_branch L_stats_chk
L_stats:
  buffer_load_dwordx4 v[216:219], v213, s[20:23], s94 offen offset:0 sc1
  buffer_load_dwordx4 v[220:223], v213, s[20:23], s94 offen offset:512 sc1
  buffer_load_dwordx4 v[224:227], v213, s[20:23], s94 offen offset:1024 sc1
  buffer_load_dwordx4 v[228:231], v213, s[20:23], s94 offen offset:1536 sc1
  buffer_load_dwordx4 v[232:235], v213, s[20:23], s94 offen offset:2048 sc1
  buffer_load_dwordx4 v[236:239], v213, s[20:23], s94 offen offset:2560 sc1
  buffer_load_dwordx4 v[240:243], v213, s[20:23], s94 offen offset:3072 sc1
  s_waitcnt vmcnt(0)
L_stats_chk:
  v_min3_u32 v5, v217, v221, v225
  v_max3_u32 v6, v217, v221, v225
  v_min3_u32 v5, v5, v229, v233
  v_max3_u32 v6, v6, v229, v233
  v_min3_u32 v5, v5, v237, v241
  v_max3_u32 v6, v6, v237, v241
  v_min3_u32 v5, v5, v219, v223
  v_max3_u32 v6, v6, v219, v223
  v_min3_u32 v5, v5, v227, v231
  v_max3_u32 v6, v6, v227, v231
  v_min3_u32 v5, v5, v235, v239
  v_max3_u32 v6, v6, v235, v239
  v_min_u32 v5, v5, v243
  v_max_u32 v6, v6, v243
  v_xor_b32 v5, s55, v5
  v_xor_b32 v6, s55, v6
  v_or_b32 v5, v5, v6
  v_cmp_ne_u32 vcc, 0, v5
  s_nop 3
  s_cmp_eq_u64 vcc, 0
  s_cbranch_scc1 L_stats_ok
  s_add_u32 s63, s63, 1
  s_cmp_lt_u32 s63, 20000
  s_cbranch_scc1 L_stats
L_stats_ok:
  v_add_f32 v5, v216, v220
  v_add_f32 v6, v218, v222
  v_add_f32 v5, v5, v224
  v_add_f32 v6, v6, v226
  v_add_f32 v5, v5, v228
  v_add_f32 v6, v6, v230
  v_add_f32 v5, v5, v232
  v_add_f32 v6, v6, v234
  v_add_f32 v5, v5, v236
  v_add_f32 v6, v6, v238
  v_add_f32 v5, v5, v240
  v_add_f32 v6, v6, v242
  s_nop 0
  v_add_f32_dpp v5, v5, v5 row_ror:8 row_mask:0xf bank_mask:0xf
  v_add_f32_dpp v6, v6, v6 row_ror:8 row_mask:0xf bank_mask:0xf
  v_mul_f32 v5, 982665509, v5
  v_mul_f32 v6, 982665509, v6
  v_fma_f32 v6, -v5, v5, v6
  v_max_f32 v6, 0, v6
  v_add_f32 v6, 925353388, v6
  v_rsq_f32 v6, v6
  s_lshl_b32 s60, s54, 6
  v_mul_f32 v5, v5, v6
  v_sub_f32 v5, 0, v5
  v_mov_b32_dpp v216, v6 row_newbcast:0 row_mask:0xf bank_mask:0xf
  s_nop 0
  v_mov_b32_dpp v224, v5 row_newbcast:0 row_mask:0xf bank_mask:0xf
  v_mov_b32_dpp v217, v6 row_newbcast:1 row_mask:0xf bank_mask:0xf
  v_mov_b32_dpp v225, v5 row_newbcast:1 row_mask:0xf bank_mask:0xf
  v_mov_b32_dpp v218, v6 row_newbcast:2 row_mask:0xf bank_mask:0xf
  v_mov_b32_dpp v226, v5 row_newbcast:2 row_mask:0xf bank_mask:0xf
  v_mov_b32_dpp v219, v6 row_newbcast:3 row_mask:0xf bank_mask:0xf
  v_mov_b32_dpp v227, v5 row_newbcast:3 row_mask:0xf bank_mask:0xf
  v_mov_b32_dpp v220, v6 row_newbcast:4 row_mask:0xf bank_mask:0xf
  v_mov_b32_dpp v228, v5 row_newbcast:4 row_mask:0xf bank_mask:0xf
  v_mov_b32_dpp v221, v6 row_newbcast:5 row_mask:0xf bank_mask:0xf
  v_mov_b32_dpp v229, v5 row_newbcast:5 row_mask:0xf bank_mask:0xf
  v_mov_b32_dpp v222, v6 row_newbcast:6 row_mask:0xf bank_mask:0xf
  v_mov_b32_dpp v230, v5 row_newbcast:6 row_mask:0xf bank_mask:0xf
  v_mov_b32_dpp v223, v6 row_newbcast:7 row_mask:0xf bank_mask:0xf
  v_mov_b32_dpp v231, v5 row_newbcast:7 row_mask:0xf bank_mask:0xf
  v_pk_fma_f32 v[64:65], v[64:65], v[216:217], v[224:225]
  v_pk_fma_f32 v[66:67], v[66:67], v[218:219], v[226:227]
  v_pk_fma_f32 v[80:81], v[80:81], v[220:221], v[228:229]
  v_pk_fma_f32 v[82:83], v[82:83], v[222:223], v[230:231]
  v_pk_fma_f32 v[68:69], v[68:69], v[216:217], v[224:225]
  v_pk_fma_f32 v[70:71], v[70:71], v[218:219], v[226:227]
  v_pk_fma_f32 v[84:85], v[84:85], v[220:221], v[228:229]
  v_pk_fma_f32 v[86:87], v[86:87], v[222:223], v[230:231]
  v_pk_fma_f32 v[72:73], v[72:73], v[216:217], v[224:225]
  v_pk_fma_f32 v[74:75], v[74:75], v[218:219], v[226:227]
  v_pk_fma_f32 v[88:89], v[88:89], v[220:221], v[228:229]
  v_pk_fma_f32 v[90:91], v[90:91], v[222:223], v[230:231]
  v_pk_fma_f32 v[76:77], v[76:77], v[216:217], v[224:225]
  v_pk_fma_f32 v[78:79], v[78:79], v[218:219], v[226:227]
  v_pk_fma_f32 v[92:93], v[92:93], v[220:221], v[228:229]
  v_pk_fma_f32 v[94:95], v[94:95], v[222:223], v[230:231]
  v_cvt_pk_bf16_f32 v64, v64, v65
  v_cvt_pk_bf16_f32 v65, v66, v67
  v_cvt_pk_bf16_f32 v66, v80, v81
  v_cvt_pk_bf16_f32 v67, v82, v83
  v_cvt_pk_bf16_f32 v68, v68, v69
  v_cvt_pk_bf16_f32 v69, v70, v71
  v_cvt_pk_bf16_f32 v70, v84, v85
  v_cvt_pk_bf16_f32 v71, v86, v87
  v_cvt_pk_bf16_f32 v72, v72, v73
  v_cvt_pk_bf16_f32 v73, v74, v75
  v_cvt_pk_bf16_f32 v74, v88, v89
  v_cvt_pk_bf16_f32 v75, v90, v91
  v_cvt_pk_bf16_f32 v76, v76, v77
  v_cvt_pk_bf16_f32 v77, v78, v79
  v_cvt_pk_bf16_f32 v78, v92, v93
  v_cvt_pk_bf16_f32 v79, v94, v95
  s_lshl_b32 s61, s53, 1
  s_add_u32 s60, s60, s61
  s_add_u32 s60, s60, s56
  s_lshl_b32 s60, s60, 3
  s_lshl_b32 s61, s57, 2
  s_add_u32 s60, s60, s61
  s_lshl_b32 s60, s60, 10
  s_add_u32 s97, s60, 1048576
  buffer_store_dwordx4 v[64:67], v9, s[20:23], s97 offen offset:0 sc1
  buffer_store_dwordx4 v[68:71], v9, s[20:23], s97 offen offset:1024 sc1
  buffer_store_dwordx4 v[72:75], v9, s[20:23], s97 offen offset:2048 sc1
  buffer_store_dwordx4 v[76:79], v9, s[20:23], s97 offen offset:3072 sc1
  buffer_store_dwordx4 v[144:147], v9, s[20:23], s98 offen offset:0 sc1
  buffer_store_dwordx4 v[148:151], v9, s[20:23], s98 offen offset:1024 sc1
  buffer_store_dwordx4 v[152:155], v9, s[20:23], s98 offen offset:2048 sc1
  buffer_store_dwordx4 v[156:159], v9, s[20:23], s99 offen offset:0 sc1
  buffer_store_dwordx4 v[160:163], v9, s[20:23], s99 offen offset:1024 sc1
  buffer_store_dwordx4 v[164:167], v9, s[20:23], s99 offen offset:2048 sc1
  s_lshl_b32 s60, s57, 12
  s_add_u32 s60, s60, 0
  v_add_u32 v47, s60, v10
  v_add_u32 v50, s60, v11
  v_add_u32 v51, s60, v12
  v_add_u32 v52, s60, v13
  s_lshl_b32 s60, s57, 12
  s_add_u32 s60, s60, 57344
  v_add_u32 v53, s60, v10
  v_add_u32 v54, s60, v11
  v_add_u32 v55, s60, v12
  v_add_u32 v56, s60, v13
  s_lshl_b32 s60, s57, 12
  s_add_u32 s60, s60, 122880
  v_add_u32 v57, s60, v10
  v_add_u32 v58, s60, v11
  v_add_u32 v62, s60, v12
  v_add_u32 v63, s60, v13
  s_waitcnt lgkmcnt(0)
  s_waitcnt vmcnt(44)
  s_barrier
  ds_read_b64_tr_b16 v[64:65], v53 offset:49152
  ds_read_b64_tr_b16 v[66:67], v53 offset:50176
  ds_read_b64_tr_b16 v[68:69], v54 offset:49152
  ds_read_b64_tr_b16 v[70:71], v54 offset:50176
  ds_read_b64_tr_b16 v[72:73], v55 offset:49152
  ds_read_b64_tr_b16 v[74:75], v55 offset:50176
  ds_read_b64_tr_b16 v[76:77], v56 offset:49152
  ds_read_b64_tr_b16 v[78:79], v56 offset:50176
  s_waitcnt lgkmcnt(6)
  v_mfma_f32_16x16x32_bf16 v[192:195], v[64:67], a[144:147], 0
  ds_read_b64_tr_b16 v[80:81], v53 offset:57344
  v_mfma_f32_16x16x32_bf16 v[208:211], v[64:67], a[148:151], 0
  ds_read_b64_tr_b16 v[82:83], v53 offset:58368
  s_waitcnt lgkmcnt(6)
  v_mfma_f32_16x16x32_bf16 v[196:199], v[68:71], a[144:147], 0
  ds_read_b64_tr_b16 v[84:85], v54 offset:57344
  v_mfma_f32_16x16x32_bf16 v[212:215], v[68:71], a[148:151], 0
  ds_read_b64_tr_b16 v[86:87], v54 offset:58368
  s_waitcnt lgkmcnt(6)
  v_mfma_f32_16x16x32_bf16 v[200:203], v[72:75], a[144:147], 0
  ds_read_b64_tr_b16 v[88:89], v55 offset:57344
  v_mfma_f32_16x16x32_bf16 v[216:219], v[72:75], a[148:151], 0
  ds_read_b64_tr_b16 v[90:91], v55 offset:58368
  s_waitcnt lgkmcnt(6)
  v_mfma_f32_16x16x32_bf16 v[204:207], v[76:79], a[144:147], 0
  ds_read_b64_tr_b16 v[92:93], v56 offset:57344
  v_mfma_f32_16x16x32_bf16 v[220:223], v[76:79], a[148:151], 0
  ds_read_b64_tr_b16 v[94:95], v56 offset:58368
  s_waitcnt vmcnt(40)
  s_barrier
  v_lshlrev_b32 v5, 2, v4
  s_xor_b32 s60, s52, 0
  s_lshl_b32 s60, s60, 6
  s_add_u32 s60, s60, 156672
  v_add_u32 v6, s60, v5
  ds_read_b32 v20, v6
  s_xor_b32 s60, s52, 1
  s_lshl_b32 s60, s60, 6
  s_add_u32 s60, s60, 156672
  v_add_u32 v6, s60, v5
  ds_read_b32 v21, v6
  s_xor_b32 s60, s52, 2
  s_lshl_b32 s60, s60, 6
  s_add_u32 s60, s60, 156672
  v_add_u32 v6, s60, v5
  ds_read_b32 v22, v6
  s_xor_b32 s60, s52, 3
  s_lshl_b32 s60, s60, 6
  s_add_u32 s60, s60, 156672
  v_add_u32 v6, s60, v5
  ds_read_b32 v23, v6
  s_waitcnt lgkmcnt(10)
  v_mfma_f32_16x16x32_bf16 v[192:195], v[80:83], a[152:155], v[192:195]
  ds_read_b64_tr_b16 v[64:65], v57 offset:0
  v_mfma_f32_16x16x32_bf16 v[208:211], v[80:83], a[156:159], v[208:211]
  ds_read_b64_tr_b16 v[66:67], v57 offset:1024
  s_waitcnt lgkmcnt(10)
  v_mfma_f32_16x16x32_bf16 v[196:199], v[84:87], a[152:155], v[196:199]
  ds_read_b64_tr_b16 v[68:69], v58 offset:0
  v_mfma_f32_16x16x32_bf16 v[212:215], v[84:87], a[156:159], v[212:215]
  ds_read_b64_tr_b16 v[70:71], v58 offset:1024
  s_waitcnt lgkmcnt(10)
  v_mfma_f32_16x16x32_bf16 v[200:203], v[88:91], a[152:155], v[200:203]
  ds_read_b64_tr_b16 v[72:73], v62 offset:0
  v_mfma_f32_16x16x32_bf16 v[216:219], v[88:91], a[156:159], v[216:219]
  ds_read_b64_tr_b16 v[74:75], v62 offset:1024
  s_waitcnt lgkmcnt(10)
  v_mfma_f32_16x16x32_bf16 v[204:207], v[92:95], a[152:155], v[204:207]
  ds_read_b64_tr_b16 v[76:77], v63 offset:0
  v_mfma_f32_16x16x32_bf16 v[220:223], v[92:95], a[156:159], v[220:223]
  ds_read_b64_tr_b16 v[78:79], v63 offset:1024
  s_waitcnt lgkmcnt(6)
  v_mfma_f32_16x16x32_bf16 v[192:195], v[64:67], a[160:163], v[192:195]
  ds_read_b64_tr_b16 v[80:81], v57 offset:8192
  v_mfma_f32_16x16x32_bf16 v[208:211], v[64:67], a[164:167], v[208:211]
  ds_read_b64_tr_b16 v[82:83], v57 offset:9216
  s_waitcnt lgkmcnt(6)
  v_mfma_f32_16x16x32_bf16 v[196:199], v[68:71], a[160:163], v[196:199]
  ds_read_b64_tr_b16 v[84:85], v58 offset:8192
  v_mfma_f32_16x16x32_bf16 v[212:215], v[68:71], a[164:167], v[212:215]
  ds_read_b64_tr_b16 v[86:87], v58 offset:9216
  s_waitcnt lgkmcnt(6)
  v_mfma_f32_16x16x32_bf16 v[200:203], v[72:75], a[160:163], v[200:203]
  ds_read_b64_tr_b16 v[88:89], v62 offset:8192
  v_mfma_f32_16x16x32_bf16 v[216:219], v[72:75], a[164:167], v[216:219]
  ds_read_b64_tr_b16 v[90:91], v62 offset:9216
  s_waitcnt lgkmcnt(6)
  v_mfma_f32_16x16x32_bf16 v[204:207], v[76:79], a[160:163], v[204:207]
  ds_read_b64_tr_b16 v[92:93], v63 offset:8192
  v_mfma_f32_16x16x32_bf16 v[220:223], v[76:79], a[164:167], v[220:223]
  ds_read_b64_tr_b16 v[94:95], v63 offset:9216
  s_waitcnt vmcnt(36)
  s_barrier
  s_waitcnt vmcnt(28)
  ds_read_b128 a[128:131], v45 offset:24576
  ds_read_b128 a[132:135], v45 offset:26624
  ds_read_b128 a[136:139], v43 offset:24576
  ds_read_b128 a[140:143], v43 offset:26624
  ds_read_b128 a[144:147], v44 offset:24576
  ds_read_b128 a[148:151], v44 offset:26624
  ds_read_b128 a[152:155], v42 offset:24576
  s_waitcnt lgkmcnt(14)
  ds_read_b128 a[156:159], v42 offset:26624
  s_waitcnt lgkmcnt(14)
  v_mfma_f32_16x16x32_bf16 v[192:195], v[80:83], a[168:171], v[192:195]
  ds_read_b64_tr_b16 v[64:65], v57 offset:16384
  v_mfma_f32_16x16x32_bf16 v[208:211], v[80:83], a[172:175], v[208:211]
  s_waitcnt lgkmcnt(14)
  ds_read_b64_tr_b16 v[66:67], v57 offset:17408
  s_waitcnt lgkmcnt(14)
  v_mfma_f32_16x16x32_bf16 v[196:199], v[84:87], a[168:171], v[196:199]
  ds_read_b64_tr_b16 v[68:69], v58 offset:16384
  v_mfma_f32_16x16x32_bf16 v[212:215], v[84:87], a[172:175], v[212:215]
  s_waitcnt lgkmcnt(14)
  ds_read_b64_tr_b16 v[70:71], v58 offset:17408
  s_waitcnt lgkmcnt(14)
  v_mfma_f32_16x16x32_bf16 v[200:203], v[88:91], a[168:171], v[200:203]
  ds_read_b64_tr_b16 v[72:73], v62 offset:16384
  v_mfma_f32_16x16x32_bf16 v[216:219], v[88:91], a[172:175], v[216:219]
  s_waitcnt lgkmcnt(14)
  ds_read_b64_tr_b16 v[74:75], v62 offset:17408
  s_waitcnt lgkmcnt(14)
  v_mfma_f32_16x16x32_bf16 v[204:207], v[92:95], a[168:171], v[204:207]
  ds_read_b64_tr_b16 v[76:77], v63 offset:16384
  v_mfma_f32_16x16x32_bf16 v[220:223], v[92:95], a[172:175], v[220:223]
  s_waitcnt lgkmcnt(14)
  ds_read_b64_tr_b16 v[78:79], v63 offset:17408
  s_waitcnt lgkmcnt(6)
  v_mfma_f32_16x16x32_bf16 v[192:195], v[64:67], a[176:179], v[192:195]
  ds_read_b64_tr_b16 v[80:81], v57 offset:24576
  v_mfma_f32_16x16x32_bf16 v[208:211], v[64:67], a[180:183], v[208:211]
  ds_read_b64_tr_b16 v[82:83], v57 offset:25600
  s_waitcnt lgkmcnt(6)
  v_mfma_f32_16x16x32_bf16 v[196:199], v[68:71], a[176:179], v[196:199]
  ds_read_b64_tr_b16 v[84:85], v58 offset:24576
  v_mfma_f32_16x16x32_bf16 v[212:215], v[68:71], a[180:183], v[212:215]
  ds_read_b64_tr_b16 v[86:87], v58 offset:25600
  s_waitcnt lgkmcnt(6)
  v_mfma_f32_16x16x32_bf16 v[200:203], v[72:75], a[176:179], v[200:203]
  ds_read_b64_tr_b16 v[88:89], v62 offset:24576
  v_mfma_f32_16x16x32_bf16 v[216:219], v[72:75], a[180:183], v[216:219]
  ds_read_b64_tr_b16 v[90:91], v62 offset:25600
  s_waitcnt lgkmcnt(6)
  v_mfma_f32_16x16x32_bf16 v[204:207], v[76:79], a[176:179], v[204:207]
  ds_read_b64_tr_b16 v[92:93], v63 offset:24576
  v_mfma_f32_16x16x32_bf16 v[220:223], v[76:79], a[180:183], v[220:223]
  ds_read_b64_tr_b16 v[94:95], v63 offset:25600
  s_waitcnt vmcnt(22)
  s_barrier
  s_lshl_b32 s60, s2, 2
  s_add_u32 s60, s60, 20480
  v_mov_b32 v5, s60
  v_mov_b32 v6, s96
  v_cmp_eq_u32 vcc, 0, v2
  s_nop 1
  v_cndmask_b32 v5, v5, v6, vcc
  s_cmp_eq_u32 s52, 0
  s_cselect_b32 s60, 3, 1
  s_waitcnt vmcnt(6)
  s_mov_b32 exec_hi, 0
  s_mov_b32 exec_lo, s60
  buffer_store_dword v14, v5, s[20:23], 0 offen sc1
  s_mov_b64 exec, -1
  s_waitcnt lgkmcnt(6)
  v_mfma_f32_16x16x32_bf16 v[192:195], v[80:83], a[184:187], v[192:195]
  ds_read_b64_tr_b16 v[64:65], v47 offset:0
  v_mfma_f32_16x16x32_bf16 v[208:211], v[80:83], a[188:191], v[208:211]
  ds_read_b64_tr_b16 v[66:67], v47 offset:1024
  s_waitcnt lgkmcnt(6)
  v_mfma_f32_16x16x32_bf16 v[196:199], v[84:87], a[184:187], v[196:199]
  ds_read_b64_tr_b16 v[68:69], v50 offset:0
  v_mfma_f32_16x16x32_bf16 v[212:215], v[84:87], a[188:191], v[212:215]
  ds_read_b64_tr_b16 v[70:71], v50 offset:1024
  s_waitcnt lgkmcnt(6)
  v_mfma_f32_16x16x32_bf16 v[200:203], v[88:91], a[184:187], v[200:203]
  ds_read_b64_tr_b16 v[72:73], v51 offset:0
  v_mfma_f32_16x16x32_bf16 v[216:219], v[88:91], a[188:191], v[216:219]
  ds_read_b64_tr_b16 v[74:75], v51 offset:1024
  s_waitcnt lgkmcnt(6)
  v_mfma_f32_16x16x32_bf16 v[204:207], v[92:95], a[184:187], v[204:207]
  ds_read_b64_tr_b16 v[76:77], v52 offset:0
  v_mfma_f32_16x16x32_bf16 v[220:223], v[92:95], a[188:191], v[220:223]
  ds_read_b64_tr_b16 v[78:79], v52 offset:1024
  s_waitcnt lgkmcnt(6)
  v_mfma_f32_16x16x32_bf16 v[192:195], v[64:67], a[192:195], v[192:195]
  ds_read_b64_tr_b16 v[80:81], v47 offset:8192
  v_mfma_f32_16x16x32_bf16 v[208:211], v[64:67], a[196:199], v[208:211]
  ds_read_b64_tr_b16 v[82:83], v47 offset:9216
  s_waitcnt lgkmcnt(6)
  v_mfma_f32_16x16x32_bf16 v[196:199], v[68:71], a[192:195], v[196:199]
  ds_read_b64_tr_b16 v[84:85], v50 offset:8192
  v_mfma_f32_16x16x32_bf16 v[212:215], v[68:71], a[196:199], v[212:215]
  ds_read_b64_tr_b16 v[86:87], v50 offset:9216
  s_waitcnt lgkmcnt(6)
  v_mfma_f32_16x16x32_bf16 v[200:203], v[72:75], a[192:195], v[200:203]
  ds_read_b64_tr_b16 v[88:89], v51 offset:8192
  v_mfma_f32_16x16x32_bf16 v[216:219], v[72:75], a[196:199], v[216:219]
  ds_read_b64_tr_b16 v[90:91], v51 offset:9216
  s_waitcnt lgkmcnt(6)
  v_mfma_f32_16x16x32_bf16 v[204:207], v[76:79], a[192:195], v[204:207]
  ds_read_b64_tr_b16 v[92:93], v52 offset:8192
  v_mfma_f32_16x16x32_bf16 v[220:223], v[76:79], a[196:199], v[220:223]
  ds_read_b64_tr_b16 v[94:95], v52 offset:9216
  s_barrier
  s_waitcnt lgkmcnt(6)
  v_mfma_f32_16x16x32_bf16 v[192:195], v[80:83], a[200:203], v[192:195]
  ds_read_b64_tr_b16 v[64:65], v53 offset:0
  v_mfma_f32_16x16x32_bf16 v[208:211], v[80:83], a[204:207], v[208:211]
  ds_read_b64_tr_b16 v[66:67], v53 offset:1024
  s_waitcnt lgkmcnt(6)
  v_mfma_f32_16x16x32_bf16 v[196:199], v[84:87], a[200:203], v[196:199]
  ds_read_b64_tr_b16 v[68:69], v54 offset:0
  v_mfma_f32_16x16x32_bf16 v[212:215], v[84:87], a[204:207], v[212:215]
  ds_read_b64_tr_b16 v[70:71], v54 offset:1024
  s_waitcnt lgkmcnt(6)
  v_mfma_f32_16x16x32_bf16 v[200:203], v[88:91], a[200:203], v[200:203]
  ds_read_b64_tr_b16 v[72:73], v55 offset:0
  v_mfma_f32_16x16x32_bf16 v[216:219], v[88:91], a[204:207], v[216:219]
  ds_read_b64_tr_b16 v[74:75], v55 offset:1024
  s_waitcnt lgkmcnt(6)
  v_mfma_f32_16x16x32_bf16 v[204:207], v[92:95], a[200:203], v[204:207]
  ds_read_b64_tr_b16 v[76:77], v56 offset:0
  v_mfma_f32_16x16x32_bf16 v[220:223], v[92:95], a[204:207], v[220:223]
  ds_read_b64_tr_b16 v[78:79], v56 offset:1024
  s_waitcnt lgkmcnt(6)
  v_mfma_f32_16x16x32_bf16 v[192:195], v[64:67], a[208:211], v[192:195]
  ds_read_b64_tr_b16 v[80:81], v53 offset:8192
  v_mfma_f32_16x16x32_bf16 v[208:211], v[64:67], a[212:215], v[208:211]
  ds_read_b64_tr_b16 v[82:83], v53 offset:9216
  s_waitcnt lgkmcnt(6)
  v_mfma_f32_16x16x32_bf16 v[196:199], v[68:71], a[208:211], v[196:199]
  ds_read_b64_tr_b16 v[84:85], v54 offset:8192
  v_mfma_f32_16x16x32_bf16 v[212:215], v[68:71], a[212:215], v[212:215]
  ds_read_b64_tr_b16 v[86:87], v54 offset:9216
  s_waitcnt lgkmcnt(6)
  v_mfma_f32_16x16x32_bf16 v[200:203], v[72:75], a[208:211], v[200:203]
  ds_read_b64_tr_b16 v[88:89], v55 offset:8192
  v_mfma_f32_16x16x32_bf16 v[216:219], v[72:75], a[212:215], v[216:219]
  ds_read_b64_tr_b16 v[90:91], v55 offset:9216
  s_waitcnt lgkmcnt(6)
  v_mfma_f32_16x16x32_bf16 v[204:207], v[76:79], a[208:211], v[204:207]
  ds_read_b64_tr_b16 v[92:93], v56 offset:8192
  v_mfma_f32_16x16x32_bf16 v[220:223], v[76:79], a[212:215], v[220:223]
  ds_read_b64_tr_b16 v[94:95], v56 offset:9216
  s_barrier
  s_waitcnt lgkmcnt(6)
  v_mfma_f32_16x16x32_bf16 v[192:195], v[80:83], a[216:219], v[192:195]
  ds_read_b64_tr_b16 v[64:65], v53 offset:16384
  v_mfma_f32_16x16x32_bf16 v[208:211], v[80:83], a[220:223], v[208:211]
  ds_read_b64_tr_b16 v[66:67], v53 offset:17408
  s_waitcnt lgkmcnt(6)
  v_mfma_f32_16x16x32_bf16 v[196:199], v[84:87], a[216:219], v[196:199]
  ds_read_b64_tr_b16 v[68:69], v54 offset:16384
  v_mfma_f32_16x16x32_bf16 v[212:215], v[84:87], a[220:223], v[212:215]
  ds_read_b64_tr_b16 v[70:71], v54 offset:17408
  s_waitcnt lgkmcnt(6)
  v_mfma_f32_16x16x32_bf16 v[200:203], v[88:91], a[216:219], v[200:203]
  ds_read_b64_tr_b16 v[72:73], v55 offset:16384
  v_mfma_f32_16x16x32_bf16 v[216:219], v[88:91], a[220:223], v[216:219]
  ds_read_b64_tr_b16 v[74:75], v55 offset:17408
  s_waitcnt lgkmcnt(6)
  v_mfma_f32_16x16x32_bf16 v[204:207], v[92:95], a[216:219], v[204:207]
  ds_read_b64_tr_b16 v[76:77], v56 offset:16384
  v_mfma_f32_16x16x32_bf16 v[220:223], v[92:95], a[220:223], v[220:223]
  ds_read_b64_tr_b16 v[78:79], v56 offset:17408
  s_waitcnt lgkmcnt(6)
  v_mfma_f32_16x16x32_bf16 v[192:195], v[64:67], a[224:227], v[192:195]
  ds_read_b64_tr_b16 v[80:81], v53 offset:24576
  v_mfma_f32_16x16x32_bf16 v[208:211], v[64:67], a[228:231], v[208:211]
  ds_read_b64_tr_b16 v[82:83], v53 offset:25600
  s_waitcnt lgkmcnt(6)
  v_mfma_f32_16x16x32_bf16 v[196:199], v[68:71], a[224:227], v[196:199]
  ds_read_b64_tr_b16 v[84:85], v54 offset:24576
  v_mfma_f32_16x16x32_bf16 v[212:215], v[68:71], a[228:231], v[212:215]
  ds_read_b64_tr_b16 v[86:87], v54 offset:25600
  s_waitcnt lgkmcnt(6)
  v_mfma_f32_16x16x32_bf16 v[200:203], v[72:75], a[224:227], v[200:203]
  ds_read_b64_tr_b16 v[88:89], v55 offset:24576
  v_mfma_f32_16x16x32_bf16 v[216:219], v[72:75], a[228:231], v[216:219]
  ds_read_b64_tr_b16 v[90:91], v55 offset:25600
  s_waitcnt lgkmcnt(6)
  v_mfma_f32_16x16x32_bf16 v[204:207], v[76:79], a[224:227], v[204:207]
  ds_read_b64_tr_b16 v[92:93], v56 offset:24576
  v_mfma_f32_16x16x32_bf16 v[220:223], v[76:79], a[228:231], v[220:223]
  ds_read_b64_tr_b16 v[94:95], v56 offset:25600
  s_barrier
  s_waitcnt vmcnt(1)
  s_mov_b64 exec, 1
  buffer_store_dword v14, off, s[20:23], s95 sc1
  s_mov_b64 exec, -1
  s_waitcnt lgkmcnt(6)
  v_mfma_f32_16x16x32_bf16 v[192:195], v[80:83], a[232:235], v[192:195]
  ds_read_b64_tr_b16 v[64:65], v53 offset:32768
  v_mfma_f32_16x16x32_bf16 v[208:211], v[80:83], a[236:239], v[208:211]
  ds_read_b64_tr_b16 v[66:67], v53 offset:33792
  s_waitcnt lgkmcnt(6)
  v_mfma_f32_16x16x32_bf16 v[196:199], v[84:87], a[232:235], v[196:199]
  ds_read_b64_tr_b16 v[68:69], v54 offset:32768
  v_mfma_f32_16x16x32_bf16 v[212:215], v[84:87], a[236:239], v[212:215]
  ds_read_b64_tr_b16 v[70:71], v54 offset:33792
  s_waitcnt lgkmcnt(6)
  v_mfma_f32_16x16x32_bf16 v[200:203], v[88:91], a[232:235], v[200:203]
  ds_read_b64_tr_b16 v[72:73], v55 offset:32768
  v_mfma_f32_16x16x32_bf16 v[216:219], v[88:91], a[236:239], v[216:219]
  ds_read_b64_tr_b16 v[74:75], v55 offset:33792
  s_waitcnt lgkmcnt(6)
  v_mfma_f32_16x16x32_bf16 v[204:207], v[92:95], a[232:235], v[204:207]
  ds_read_b64_tr_b16 v[76:77], v56 offset:32768
  v_mfma_f32_16x16x32_bf16 v[220:223], v[92:95], a[236:239], v[220:223]
  ds_read_b64_tr_b16 v[78:79], v56 offset:33792
  s_waitcnt lgkmcnt(6)
  v_mfma_f32_16x16x32_bf16 v[192:195], v[64:67], a[240:243], v[192:195]
  ds_read_b64_tr_b16 v[80:81], v53 offset:40960
  v_mfma_f32_16x16x32_bf16 v[208:211], v[64:67], a[244:247], v[208:211]
  ds_read_b64_tr_b16 v[82:83], v53 offset:41984
  s_waitcnt lgkmcnt(6)
  v_mfma_f32_16x16x32_bf16 v[196:199], v[68:71], a[240:243], v[196:199]
  ds_read_b64_tr_b16 v[84:85], v54 offset:40960
  v_mfma_f32_16x16x32_bf16 v[212:215], v[68:71], a[244:247], v[212:215]
  ds_read_b64_tr_b16 v[86:87], v54 offset:41984
  s_waitcnt lgkmcnt(6)
  v_mfma_f32_16x16x32_bf16 v[200:203], v[72:75], a[240:243], v[200:203]
  ds_read_b64_tr_b16 v[88:89], v55 offset:40960
  v_mfma_f32_16x16x32_bf16 v[216:219], v[72:75], a[244:247], v[216:219]
  ds_read_b64_tr_b16 v[90:91], v55 offset:41984
  s_waitcnt lgkmcnt(6)
  v_mfma_f32_16x16x32_bf16 v[204:207], v[76:79], a[240:243], v[204:207]
  ds_read_b64_tr_b16 v[92:93], v56 offset:40960
  v_mfma_f32_16x16x32_bf16 v[220:223], v[76:79], a[244:247], v[220:223]
  ds_read_b64_tr_b16 v[94:95], v56 offset:41984
  s_waitcnt lgkmcnt(6)
  v_mfma_f32_16x16x32_bf16 v[192:195], v[80:83], a[248:251], v[192:195]
  v_mfma_f32_16x16x32_bf16 v[208:211], v[80:83], a[252:255], v[208:211]
  s_waitcnt lgkmcnt(4)
  v_mfma_f32_16x16x32_bf16 v[196:199], v[84:87], a[248:251], v[196:199]
  v_mfma_f32_16x16x32_bf16 v[212:215], v[84:87], a[252:255], v[212:215]
  s_waitcnt lgkmcnt(2)
  v_mfma_f32_16x16x32_bf16 v[200:203], v[88:91], a[248:251], v[200:203]
  v_mfma_f32_16x16x32_bf16 v[216:219], v[88:91], a[252:255], v[216:219]
  s_waitcnt lgkmcnt(0)
  v_mfma_f32_16x16x32_bf16 v[204:207], v[92:95], a[248:251], v[204:207]
  v_mfma_f32_16x16x32_bf16 v[220:223], v[92:95], a[252:255], v[220:223]
  s_barrier
  v_and_b32 v47, 31, v2
  v_lshlrev_b32 v47, 2, v47
  s_lshl_b32 s60, s54, 2
  s_add_u32 s60, s60, s52
  s_lshl_b32 s60, s60, 7
  s_add_u32 s97, s60, 4096
  s_lshl_b32 s60, s57, 12
  v_add_u32 v15, s60, v9
  v_xor_b32 v24, 4096, v15
  s_lshl_b32 s60, s54, 6
  s_lshl_b32 s61, s52, 4
  s_add_u32 s60, s60, s61
  s_lshl_b32 s60, s60, 13
  s_add_u32 s98, s60, 1048576
  s_add_u32 s99, s98, 8192
  v_lshlrev_b32 v5, 16, v48
  v_lshlrev_b32 v6, 16, v49
  v_mov_b32 v3, v46
  v_mov_b32 v4, v45
  v_mov_b32 v8, v44
  v_mov_b32 v10, v43
  v_mov_b32 v11, v42
  v_mov_b32 v12, v47
  v_mov_b32 v13, v5
  v_mov_b32 v25, v6
  buffer_load_dword v26, v12, s[20:23], s97 offen sc1
  v_pk_mul_f32 v[32:33], v[192:193], v[192:193]
  v_pk_mul_f32 v[34:35], v[194:195], v[194:195]
  v_pk_mul_f32 v[36:37], v[196:197], v[196:197]
  v_pk_mul_f32 v[38:39], v[198:199], v[198:199]
  v_pk_fma_f32 v[32:33], v[32:33], s[68:69], v[60:61]
  v_pk_fma_f32 v[34:35], v[34:35], s[68:69], v[60:61]
  v_pk_fma_f32 v[36:37], v[36:37], s[68:69], v[60:61]
  v_pk_fma_f32 v[38:39], v[38:39], s[68:69], v[60:61]
  v_pk_mul_f32 v[32:33], v[32:33], v[192:193]
  v_pk_mul_f32 v[34:35], v[34:35], v[194:195]
  s_add_u32 m0, s3, 0
  v_pk_mul_f32 v[36:37], v[36:37], v[196:197]
  buffer_load_dwordx4 v3, s[16:19], s72 offen offset:0 lds
  v_pk_mul_f32 v[38:39], v[38:39], v[198:199]
  v_exp_f32 v32, v32
  v_exp_f32 v33, v33
  v_exp_f32 v34, v34
  v_exp_f32 v35, v35
  v_exp_f32 v36, v36
  v_exp_f32 v37, v37
  s_add_u32 m0, s3, 1024
  v_exp_f32 v38, v38
  buffer_load_dwordx4 v3, s[16:19], s73 offen offset:0 lds
  v_exp_f32 v39, v39
  v_pk_mul_f32 v[192:193], v[192:193], v[16:17]
  v_pk_mul_f32 v[194:195], v[194:195], v[16:17]
  v_pk_mul_f32 v[196:197], v[196:197], v[16:17]
  v_pk_mul_f32 v[198:199], v[198:199], v[16:17]
  v_pk_add_f32 v[32:33], v[32:33], s[70:71]
  v_pk_add_f32 v[34:35], v[34:35], s[70:71]
  v_pk_add_f32 v[36:37], v[36:37], s[70:71]
  v_pk_add_f32 v[38:39], v[38:39], s[70:71]
  v_rcp_f32 v32, v32
  s_add_u32 m0, s3, 2048
  v_rcp_f32 v33, v33
  buffer_load_dwordx4 v3, s[16:19], s74 offen offset:0 lds
  v_rcp_f32 v34, v34
  v_rcp_f32 v35, v35
  v_rcp_f32 v36, v36
  v_rcp_f32 v37, v37
  v_rcp_f32 v38, v38
  v_rcp_f32 v39, v39
  s_add_u32 m0, s3, 3072
  v_pk_mul_f32 v[192:193], v[192:193], v[32:33]
  buffer_load_dwordx4 v3, s[16:19], s75 offen offset:0 lds
  v_pk_mul_f32 v[194:195], v[194:195], v[34:35]
  v_pk_mul_f32 v[196:197], v[196:197], v[36:37]
  v_pk_mul_f32 v[198:199], v[198:199], v[38:39]
  v_pk_mul_f32 v[32:33], v[200:201], v[200:201]
  v_pk_mul_f32 v[34:35], v[202:203], v[202:203]
  v_pk_mul_f32 v[36:37], v[204:205], v[204:205]
  v_pk_mul_f32 v[38:39], v[206:207], v[206:207]
  v_pk_fma_f32 v[32:33], v[32:33], s[68:69], v[60:61]
  v_pk_fma_f32 v[34:35], v[34:35], s[68:69], v[60:61]
  v_pk_fma_f32 v[36:37], v[36:37], s[68:69], v[60:61]
  s_add_u32 m0, s3, 4096
  v_pk_fma_f32 v[38:39], v[38:39], s[68:69], v[60:61]
  buffer_load_dwordx4 v3, s[16:19], s76 offen offset:0 lds
  v_pk_mul_f32 v[32:33], v[32:33], v[200:201]
  v_pk_mul_f32 v[34:35], v[34:35], v[202:203]
  v_pk_mul_f32 v[36:37], v[36:37], v[204:205]
  v_pk_mul_f32 v[38:39], v[38:39], v[206:207]
  v_exp_f32 v32, v32
  v_exp_f32 v33, v33
  v_exp_f32 v34, v34
  v_exp_f32 v35, v35
  s_add_u32 m0, s3, 5120
  v_exp_f32 v36, v36
  buffer_load_dwordx4 v3, s[16:19], s77 offen offset:0 lds
  v_exp_f32 v37, v37
  v_exp_f32 v38, v38
  v_exp_f32 v39, v39
  v_pk_mul_f32 v[200:201], v[200:201], v[16:17]
  v_pk_mul_f32 v[202:203], v[202:203], v[16:17]
  v_pk_mul_f32 v[204:205], v[204:205], v[16:17]
  v_pk_mul_f32 v[206:207], v[206:207], v[16:17]
  v_pk_add_f32 v[32:33], v[32:33], s[70:71]
  s_add_u32 m0, s3, 6144
  v_pk_add_f32 v[34:35], v[34:35], s[70:71]
  buffer_load_dwordx4 v3, s[16:19], s78 offen offset:0 lds
  v_pk_add_f32 v[36:37], v[36:37], s[70:71]
  v_pk_add_f32 v[38:39], v[38:39], s[70:71]
  v_rcp_f32 v32, v32
  v_rcp_f32 v33, v33
  v_rcp_f32 v34, v34
  v_rcp_f32 v35, v35
  v_rcp_f32 v36, v36
  s_add_u32 m0, s3, 7168
  v_rcp_f32 v37, v37
  buffer_load_dwordx4 v3, s[16:19], s79 offen offset:0 lds
  v_add_u32 v3, 128, v3
  v_rcp_f32 v38, v38
  v_rcp_f32 v39, v39
  v_pk_mul_f32 v[200:201], v[200:201], v[32:33]
  v_pk_mul_f32 v[202:203], v[202:203], v[34:35]
  v_pk_mul_f32 v[204:205], v[204:205], v[36:37]
  v_pk_mul_f32 v[206:207], v[206:207], v[38:39]
  v_pk_mul_f32 v[32:33], v[208:209], v[208:209]
  v_pk_mul_f32 v[34:35], v[210:211], v[210:211]
  s_add_u32 m0, s3, 32768
  v_pk_mul_f32 v[36:37], v[212:213], v[212:213]
  buffer_load_dwordx4 v3, s[16:19], s72 offen offset:0 lds
  v_pk_mul_f32 v[38:39], v[214:215], v[214:215]
  v_pk_fma_f32 v[32:33], v[32:33], s[68:69], v[60:61]
  v_pk_fma_f32 v[34:35], v[34:35], s[68:69], v[60:61]
  v_pk_fma_f32 v[36:37], v[36:37], s[68:69], v[60:61]
  v_pk_fma_f32 v[38:39], v[38:39], s[68:69], v[60:61]
  v_pk_mul_f32 v[32:33], v[32:33], v[208:209]
  v_pk_mul_f32 v[34:35], v[34:35], v[210:211]
  v_pk_mul_f32 v[36:37], v[36:37], v[212:213]
  v_pk_mul_f32 v[38:39], v[38:39], v[214:215]
  v_exp_f32 v32, v32
  s_add_u32 m0, s3, 33792
  v_exp_f32 v33, v33
  buffer_load_dwordx4 v3, s[16:19], s73 offen offset:0 lds
  v_exp_f32 v34, v34
  v_exp_f32 v35, v35
  v_exp_f32 v36, v36
  v_exp_f32 v37, v37
  v_exp_f32 v38, v38
  v_exp_f32 v39, v39
  s_add_u32 m0, s3, 34816
  v_pk_mul_f32 v[208:209], v[208:209], v[18:19]
  buffer_load_dwordx4 v3, s[16:19], s74 offen offset:0 lds
  v_pk_mul_f32 v[210:211], v[210:211], v[18:19]
  v_pk_mul_f32 v[212:213], v[212:213], v[18:19]
  v_pk_mul_f32 v[214:215], v[214:215], v[18:19]
  v_pk_add_f32 v[32:33], v[32:33], s[70:71]
  v_pk_add_f32 v[34:35], v[34:35], s[70:71]
  v_pk_add_f32 v[36:37], v[36:37], s[70:71]
  v_pk_add_f32 v[38:39], v[38:39], s[70:71]
  v_rcp_f32 v32, v32
  v_rcp_f32 v33, v33
  s_add_u32 m0, s3, 35840
  v_rcp_f32 v34, v34
  buffer_load_dwordx4 v3, s[16:19], s75 offen offset:0 lds
  v_rcp_f32 v35, v35
  v_rcp_f32 v36, v36
  v_rcp_f32 v37, v37
  v_rcp_f32 v38, v38
  v_rcp_f32 v39, v39
  v_pk_mul_f32 v[208:209], v[208:209], v[32:33]
  v_pk_mul_f32 v[210:211], v[210:211], v[34:35]
  s_add_u32 m0, s3, 36864
  v_pk_mul_f32 v[212:213], v[212:213], v[36:37]
  buffer_load_dwordx4 v3, s[16:19], s76 offen offset:0 lds
  v_pk_mul_f32 v[214:215], v[214:215], v[38:39]
  v_pk_mul_f32 v[32:33], v[216:217], v[216:217]
  v_pk_mul_f32 v[34:35], v[218:219], v[218:219]
  v_pk_mul_f32 v[36:37], v[220:221], v[220:221]
  v_pk_mul_f32 v[38:39], v[222:223], v[222:223]
  v_pk_fma_f32 v[32:33], v[32:33], s[68:69], v[60:61]
  v_pk_fma_f32 v[34:35], v[34:35], s[68:69], v[60:61]
  v_pk_fma_f32 v[36:37], v[36:37], s[68:69], v[60:61]
  v_pk_fma_f32 v[38:39], v[38:39], s[68:69], v[60:61]
  v_pk_mul_f32 v[32:33], v[32:33], v[216:217]
  s_add_u32 m0, s3, 37888
  v_pk_mul_f32 v[34:35], v[34:35], v[218:219]
  buffer_load_dwordx4 v3, s[16:19], s77 offen offset:0 lds
  v_pk_mul_f32 v[36:37], v[36:37], v[220:221]
  v_pk_mul_f32 v[38:39], v[38:39], v[222:223]
  v_exp_f32 v32, v32
  v_exp_f32 v33, v33
  v_exp_f32 v34, v34
  v_exp_f32 v35, v35
  v_exp_f32 v36, v36
  s_add_u32 m0, s3, 38912
  v_exp_f32 v37, v37
  buffer_load_dwordx4 v3, s[16:19], s78 offen offset:0 lds
  v_exp_f32 v38, v38
  v_exp_f32 v39, v39
  v_pk_mul_f32 v[216:217], v[216:217], v[18:19]
  v_pk_mul_f32 v[218:219], v[218:219], v[18:19]
  v_pk_mul_f32 v[220:221], v[220:221], v[18:19]
  v_pk_mul_f32 v[222:223], v[222:223], v[18:19]
  v_pk_add_f32 v[32:33], v[32:33], s[70:71]
  v_pk_add_f32 v[34:35], v[34:35], s[70:71]
  v_pk_add_f32 v[36:37], v[36:37], s[70:71]
  s_add_u32 m0, s3, 39936
  v_pk_add_f32 v[38:39], v[38:39], s[70:71]
  buffer_load_dwordx4 v3, s[16:19], s79 offen offset:0 lds
  v_add_u32 v3, 128, v3
  v_rcp_f32 v32, v32
  v_rcp_f32 v33, v33
  v_rcp_f32 v34, v34
  v_rcp_f32 v35, v35
  v_rcp_f32 v36, v36
  v_rcp_f32 v37, v37
  s_add_u32 m0, s3, 65536
  v_rcp_f32 v38, v38
  buffer_load_dwordx4 v3, s[16:19], s72 offen offset:0 lds
  v_rcp_f32 v39, v39
  v_pk_mul_f32 v[216:217], v[216:217], v[32:33]
  v_pk_mul_f32 v[218:219], v[218:219], v[34:35]
  v_pk_mul_f32 v[220:221], v[220:221], v[36:37]
  v_pk_mul_f32 v[222:223], v[222:223], v[38:39]
  s_add_u32 m0, s3, 66560
  s_nop 0
  buffer_load_dwordx4 v3, s[16:19], s73 offen offset:0 lds
  s_add_u32 m0, s3, 67584
  s_nop 0
  buffer_load_dwordx4 v3, s[16:19], s74 offen offset:0 lds
  s_add_u32 m0, s3, 68608
  s_nop 0
  buffer_load_dwordx4 v3, s[16:19], s75 offen offset:0 lds
  s_add_u32 m0, s3, 69632
  s_nop 0
  buffer_load_dwordx4 v3, s[16:19], s76 offen offset:0 lds
  s_add_u32 m0, s3, 70656
  s_nop 0
  buffer_load_dwordx4 v3, s[16:19], s77 offen offset:0 lds
  s_add_u32 m0, s3, 71680
  s_nop 0
  buffer_load_dwordx4 v3, s[16:19], s78 offen offset:0 lds
  s_add_u32 m0, s3, 72704
  s_nop 0
  buffer_load_dwordx4 v3, s[16:19], s79 offen offset:0 lds
  v_add_u32 v3, 128, v3
  s_mov_b32 s63, 0
  s_branch L_fz_chk
L_poll_fz:
  buffer_load_dword v26, v12, s[20:23], s97 offen sc1
  s_waitcnt vmcnt(0)
L_fz_chk:
  s_waitcnt vmcnt(24)
  v_cmp_ne_u32 vcc, s55, v26
  s_nop 3
  s_cmp_eq_u64 vcc, 0
  s_cbranch_scc1 L_ok_fz
  s_add_u32 s63, s63, 1
  s_cmp_lt_u32 s63, 20000
  s_cbranch_scc1 L_poll_fz
L_ok_fz:
  buffer_load_dwordx4 v[224:227], v15, s[20:23], s98 offen offset:0 sc1
  buffer_load_dwordx4 v[228:231], v15, s[20:23], s98 offen offset:1024 sc1
  buffer_load_dwordx4 v[232:235], v15, s[20:23], s98 offen offset:2048 sc1
  buffer_load_dwordx4 v[236:239], v15, s[20:23], s98 offen offset:3072 sc1
  buffer_load_dwordx4 v[240:243], v24, s[20:23], s98 offen offset:0 sc1
  buffer_load_dwordx4 v[244:247], v24, s[20:23], s98 offen offset:1024 sc1
  buffer_load_dwordx4 v[248:251], v24, s[20:23], s98 offen offset:2048 sc1
  buffer_load_dwordx4 v[252:255], v24, s[20:23], s98 offen offset:3072 sc1
  s_add_u32 s98, s98, 16384
  buffer_load_dwordx4 v[160:163], v15, s[20:23], s99 offen offset:0 sc1
  buffer_load_dwordx4 v[164:167], v15, s[20:23], s99 offen offset:1024 sc1
  buffer_load_dwordx4 v[168:171], v15, s[20:23], s99 offen offset:2048 sc1
  buffer_load_dwordx4 v[172:175], v15, s[20:23], s99 offen offset:3072 sc1
  buffer_load_dwordx4 v[176:179], v24, s[20:23], s99 offen offset:0 sc1
  buffer_load_dwordx4 v[180:183], v24, s[20:23], s99 offen offset:1024 sc1
  buffer_load_dwordx4 v[184:187], v24, s[20:23], s99 offen offset:2048 sc1
  buffer_load_dwordx4 v[188:191], v24, s[20:23], s99 offen offset:3072 sc1
  s_add_u32 s99, s99, 16384
  v_lshrrev_b32 v5, 5, v2
  v_bfe_u32 v6, v2, 3, 2
  v_lshl_add_u32 v7, v5, 2, v6
  v_mul_u32_u24 v16, 896, v7
  v_lshrrev_b32 v6, 1, v6
  v_lshl_or_b32 v6, v5, 1, v6
  v_lshlrev_b32 v6, 1, v6
  v_xor_b32 v6, v6, v2
  v_and_b32 v6, 7, v6
  v_lshl_add_u32 v16, v6, 4, v16
  s_mul_i32 s60, s52, 200704
  s_lshl_b32 s61, s54, 7
  s_add_u32 s100, s60, s61
  s_mul_i32 s60, s52, 28672
  s_add_u32 s101, s60, s61
  s_mul_i32 s88, s52, 12288
  s_add_u32 s88, s88, 98304
  v_bfe_u32 v27, v2, 2, 2
  v_lshrrev_b32 v28, 4, v2
  v_and_b32 v5, 1, v28
  v_lshrrev_b32 v6, 1, v27
  v_lshl_or_b32 v6, v5, 1, v6
  v_lshlrev_b32 v5, 9, v5
  v_lshl_add_u32 v5, v27, 7, v5
  v_lshrrev_b32 v7, 1, v28
  v_lshl_add_u32 v5, v7, 11, v5
  v_and_b32 v7, 3, v2
  v_lshl_add_u32 v5, v7, 3, v5
  v_xor_b32 v7, 0, v6
  v_lshl_add_u32 v17, v7, 5, v5
  v_xor_b32 v7, 1, v6
  v_lshl_add_u32 v18, v7, 5, v5
  v_xor_b32 v7, 2, v6
  v_lshl_add_u32 v19, v7, 5, v5
  v_xor_b32 v7, 3, v6
  v_lshl_add_u32 v26, v7, 5, v5
  v_add_u32 v27, s88, v17
  v_add_u32 v28, s88, v18
  v_add_u32 v29, s88, v19
  v_add_u32 v30, s88, v26
  v_mov_b32 v32, v13
  v_mov_b32 v33, v13
  v_mov_b32 v34, v13
  v_mov_b32 v35, v13
  v_mov_b32 v36, v25
  v_mov_b32 v37, v25
  v_mov_b32 v38, v25
  v_mov_b32 v39, v25
  v_mov_b32 v48, v13
  v_mov_b32 v49, v13
  v_mov_b32 v50, v13
  v_mov_b32 v51, v13
  v_mov_b32 v52, v25
  v_mov_b32 v53, v25
  v_mov_b32 v54, v25
  v_mov_b32 v55, v25
  v_mov_b32 v64, v13
  v_mov_b32 v65, v13
  v_mov_b32 v66, v13
  v_mov_b32 v67, v13
  v_mov_b32 v68, v25
  v_mov_b32 v69, v25
  v_mov_b32 v70, v25
  v_mov_b32 v71, v25
  v_mov_b32 v80, v13
  v_mov_b32 v81, v13
  v_mov_b32 v82, v13
  v_mov_b32 v83, v13
  v_mov_b32 v84, v25
  v_mov_b32 v85, v25
  v_mov_b32 v86, v25
  v_mov_b32 v87, v25
  s_waitcnt vmcnt(32)
  ds_read_b128 a[160:163], v4 offset:0
  ds_read_b128 a[164:167], v4 offset:2048
  ds_read_b128 a[168:171], v10 offset:0
  ds_read_b128 a[172:175], v10 offset:2048
  ds_read_b128 a[176:179], v8 offset:0
  ds_read_b128 a[180:183], v8 offset:2048
  ds_read_b128 a[184:187], v11 offset:0
  ds_read_b128 a[188:191], v11 offset:2048
  s_waitcnt vmcnt(24)
  ds_read_b128 a[192:195], v4 offset:32768
  ds_read_b128 a[196:199], v4 offset:34816
  ds_read_b128 a[200:203], v10 offset:32768
  ds_read_b128 a[204:207], v10 offset:34816
  ds_read_b128 a[208:211], v8 offset:32768
  ds_read_b128 a[212:215], v8 offset:34816
  ds_read_b128 a[216:219], v11 offset:32768
  s_waitcnt lgkmcnt(14)
  ds_read_b128 a[220:223], v11 offset:34816
  s_waitcnt vmcnt(8)
  v_mfma_f32_16x16x32_bf16 v[32:35], v[224:227], a[0:3], v[32:35]
  v_mfma_f32_16x16x32_bf16 v[36:39], v[224:227], a[4:7], v[36:39]
  v_mfma_f32_16x16x32_bf16 v[40:43], v[224:227], a[8:11], 0
  v_mfma_f32_16x16x32_bf16 v[44:47], v[224:227], a[12:15], 0
  buffer_load_dwordx4 a[224:227], v15, s[20:23], s98 offen offset:0 sc1
  v_mfma_f32_16x16x32_bf16 v[48:51], v[228:231], a[0:3], v[48:51]
  v_mfma_f32_16x16x32_bf16 v[52:55], v[228:231], a[4:7], v[52:55]
  v_mfma_f32_16x16x32_bf16 v[56:59], v[228:231], a[8:11], 0
  v_mfma_f32_16x16x32_bf16 v[60:63], v[228:231], a[12:15], 0
  buffer_load_dwordx4 a[228:231], v15, s[20:23], s98 offen offset:1024 sc1
  buffer_load_dwordx4 v[224:227], v15, s[20:23], s99 offen offset:0 sc1
  v_mfma_f32_16x16x32_bf16 v[64:67], v[232:235], a[0:3], v[64:67]
  v_mfma_f32_16x16x32_bf16 v[68:71], v[232:235], a[4:7], v[68:71]
  v_mfma_f32_16x16x32_bf16 v[72:75], v[232:235], a[8:11], 0
  v_mfma_f32_16x16x32_bf16 v[76:79], v[232:235], a[12:15], 0
  buffer_load_dwordx4 a[232:235], v15, s[20:23], s98 offen offset:2048 sc1
  buffer_load_dwordx4 v[228:231], v15, s[20:23], s99 offen offset:1024 sc1
  v_mfma_f32_16x16x32_bf16 v[80:83], v[236:239], a[0:3], v[80:83]
  v_mfma_f32_16x16x32_bf16 v[84:87], v[236:239], a[4:7], v[84:87]
  v_mfma_f32_16x16x32_bf16 v[88:91], v[236:239], a[8:11], 0
  v_mfma_f32_16x16x32_bf16 v[92:95], v[236:239], a[12:15], 0
  buffer_load_dwordx4 a[236:239], v15, s[20:23], s98 offen offset:3072 sc1
  buffer_load_dwordx4 v[232:235], v15, s[20:23], s99 offen offset:2048 sc1
  v_mfma_f32_16x16x32_bf16 v[96:99], v[240:243], a[0:3], 0
  v_mfma_f32_16x16x32_bf16 v[100:103], v[240:243], a[4:7], 0
  v_mfma_f32_16x16x32_bf16 v[104:107], v[240:243], a[8:11], 0
  v_mfma_f32_16x16x32_bf16 v[108:111], v[240:243], a[12:15], 0
  buffer_load_dwordx4 a[240:243], v24, s[20:23], s98 offen offset:0 sc1
  buffer_load_dwordx4 v[236:239], v15, s[20:23], s99 offen offset:3072 sc1
  v_mfma_f32_16x16x32_bf16 v[112:115], v[244:247], a[0:3], 0
  v_mfma_f32_16x16x32_bf16 v[116:119], v[244:247], a[4:7], 0
  v_mfma_f32_16x16x32_bf16 v[120:123], v[244:247], a[8:11], 0
  v_mfma_f32_16x16x32_bf16 v[124:127], v[244:247], a[12:15], 0
  buffer_load_dwordx4 a[244:247], v24, s[20:23], s98 offen offset:1024 sc1
  buffer_load_dwordx4 v[240:243], v24, s[20:23], s99 offen offset:0 sc1
  v_mfma_f32_16x16x32_bf16 v[128:131], v[248:251], a[0:3], 0
  v_mfma_f32_16x16x32_bf16 v[132:135], v[248:251], a[4:7], 0
  v_mfma_f32_16x16x32_bf16 v[136:139], v[248:251], a[8:11], 0
  v_mfma_f32_16x16x32_bf16 v[140:143], v[248:251], a[12:15], 0
  buffer_load_dwordx4 a[248:251], v24, s[20:23], s98 offen offset:2048 sc1
  buffer_load_dwordx4 v[244:247], v24, s[20:23], s99 offen offset:1024 sc1
  v_mfma_f32_16x16x32_bf16 v[144:147], v[252:255], a[0:3], 0
  v_mfma_f32_16x16x32_bf16 v[148:151], v[252:255], a[4:7], 0
  v_mfma_f32_16x16x32_bf16 v[152:155], v[252:255], a[8:11], 0
  v_mfma_f32_16x16x32_bf16 v[156:159], v[252:255], a[12:15], 0
  buffer_load_dwordx4 a[252:255], v24, s[20:23], s98 offen offset:3072 sc1
  s_add_u32 s98, s98, 16384
  buffer_load_dwordx4 v[248:251], v24, s[20:23], s99 offen offset:2048 sc1
  s_waitcnt vmcnt(15)
  v_mfma_f32_16x16x32_bf16 v[32:35], v[160:163], a[16:19], v[32:35]
  v_mfma_f32_16x16x32_bf16 v[36:39], v[160:163], a[20:23], v[36:39]
  v_mfma_f32_16x16x32_bf16 v[40:43], v[160:163], a[24:27], v[40:43]
  v_mfma_f32_16x16x32_bf16 v[44:47], v[160:163], a[28:31], v[44:47]
  buffer_load_dwordx4 v[252:255], v24, s[20:23], s99 offen offset:3072 sc1
  s_add_u32 s99, s99, 16384
  v_mfma_f32_16x16x32_bf16 v[48:51], v[164:167], a[16:19], v[48:51]
  v_mfma_f32_16x16x32_bf16 v[52:55], v[164:167], a[20:23], v[52:55]
  v_mfma_f32_16x16x32_bf16 v[56:59], v[164:167], a[24:27], v[56:59]
  v_mfma_f32_16x16x32_bf16 v[60:63], v[164:167], a[28:31], v[60:63]
  buffer_load_dwordx4 v[160:163], v15, s[20:23], s98 offen offset:0 sc1
  v_mfma_f32_16x16x32_bf16 v[64:67], v[168:171], a[16:19], v[64:67]
  v_mfma_f32_16x16x32_bf16 v[68:71], v[168:171], a[20:23], v[68:71]
  v_mfma_f32_16x16x32_bf16 v[72:75], v[168:171], a[24:27], v[72:75]
  v_mfma_f32_16x16x32_bf16 v[76:79], v[168:171], a[28:31], v[76:79]
  buffer_load_dwordx4 v[164:167], v15, s[20:23], s98 offen offset:1024 sc1
  v_mfma_f32_16x16x32_bf16 v[80:83], v[172:175], a[16:19], v[80:83]
  v_mfma_f32_16x16x32_bf16 v[84:87], v[172:175], a[20:23], v[84:87]
  v_mfma_f32_16x16x32_bf16 v[88:91], v[172:175], a[24:27], v[88:91]
  v_mfma_f32_16x16x32_bf16 v[92:95], v[172:175], a[28:31], v[92:95]
  buffer_load_dwordx4 v[168:171], v15, s[20:23], s98 offen offset:2048 sc1
  v_mfma_f32_16x16x32_bf16 v[96:99], v[176:179], a[16:19], v[96:99]
  v_mfma_f32_16x16x32_bf16 v[100:103], v[176:179], a[20:23], v[100:103]
  v_mfma_f32_16x16x32_bf16 v[104:107], v[176:179], a[24:27], v[104:107]
  v_mfma_f32_16x16x32_bf16 v[108:111], v[176:179], a[28:31], v[108:111]
  buffer_load_dwordx4 v[172:175], v15, s[20:23], s98 offen offset:3072 sc1
  v_mfma_f32_16x16x32_bf16 v[112:115], v[180:183], a[16:19], v[112:115]
  v_mfma_f32_16x16x32_bf16 v[116:119], v[180:183], a[20:23], v[116:119]
  v_mfma_f32_16x16x32_bf16 v[120:123], v[180:183], a[24:27], v[120:123]
  v_mfma_f32_16x16x32_bf16 v[124:127], v[180:183], a[28:31], v[124:127]
  buffer_load_dwordx4 v[176:179], v24, s[20:23], s98 offen offset:0 sc1
  v_mfma_f32_16x16x32_bf16 v[128:131], v[184:187], a[16:19], v[128:131]
  v_mfma_f32_16x16x32_bf16 v[132:135], v[184:187], a[20:23], v[132:135]
  v_mfma_f32_16x16x32_bf16 v[136:139], v[184:187], a[24:27], v[136:139]
  v_mfma_f32_16x16x32_bf16 v[140:143], v[184:187], a[28:31], v[140:143]
  buffer_load_dwordx4 v[180:183], v24, s[20:23], s98 offen offset:1024 sc1
  v_mfma_f32_16x16x32_bf16 v[144:147], v[188:191], a[16:19], v[144:147]
  v_mfma_f32_16x16x32_bf16 v[148:151], v[188:191], a[20:23], v[148:151]
  v_mfma_f32_16x16x32_bf16 v[152:155], v[188:191], a[24:27], v[152:155]
  v_mfma_f32_16x16x32_bf16 v[156:159], v[188:191], a[28:31], v[156:159]
  buffer_load_dwordx4 v[184:187], v24, s[20:23], s98 offen offset:2048 sc1
  s_waitcnt vmcnt(9)
  v_mfma_f32_16x16x32_bf16 v[32:35], a[224:227], a[32:35], v[32:35]
  v_mfma_f32_16x16x32_bf16 v[36:39], a[224:227], a[36:39], v[36:39]
  v_mfma_f32_16x16x32_bf16 v[40:43], a[224:227], a[40:43], v[40:43]
  v_mfma_f32_16x16x32_bf16 v[44:47], a[224:227], a[44:47], v[44:47]
  buffer_load_dwordx4 v[188:191], v24, s[20:23], s98 offen offset:3072 sc1
  s_add_u32 s98, s98, 16384
  v_add_u32 v4, 49152, v4
  v_add_u32 v8, 49152, v8
  v_add_u32 v10, 49152, v10
  v_add_u32 v11, 49152, v11
  s_waitcnt lgkmcnt(14)
  ds_read_b128 a[0:3], v4 offset:16384
  s_waitcnt lgkmcnt(14)
  ds_read_b128 a[4:7], v4 offset:18432
  s_waitcnt lgkmcnt(14)
  ds_read_b128 a[8:11], v10 offset:16384
  s_waitcnt lgkmcnt(14)
  ds_read_b128 a[12:15], v10 offset:18432
  s_waitcnt lgkmcnt(14)
  ds_read_b128 a[16:19], v8 offset:16384
  s_waitcnt lgkmcnt(14)
  ds_read_b128 a[20:23], v8 offset:18432
  s_waitcnt lgkmcnt(14)
  ds_read_b128 a[24:27], v11 offset:16384
  s_waitcnt lgkmcnt(14)
  ds_read_b128 a[28:31], v11 offset:18432
  v_mfma_f32_16x16x32_bf16 v[48:51], a[228:231], a[32:35], v[48:51]
  v_mfma_f32_16x16x32_bf16 v[52:55], a[228:231], a[36:39], v[52:55]
  v_mfma_f32_16x16x32_bf16 v[56:59], a[228:231], a[40:43], v[56:59]
  v_mfma_f32_16x16x32_bf16 v[60:63], a[228:231], a[44:47], v[60:63]
  buffer_load_dwordx4 a[224:227], v15, s[20:23], s99 offen offset:0 sc1
  v_mfma_f32_16x16x32_bf16 v[64:67], a[232:235], a[32:35], v[64:67]
  v_mfma_f32_16x16x32_bf16 v[68:71], a[232:235], a[36:39], v[68:71]
  v_mfma_f32_16x16x32_bf16 v[72:75], a[232:235], a[40:43], v[72:75]
  v_mfma_f32_16x16x32_bf16 v[76:79], a[232:235], a[44:47], v[76:79]
  buffer_load_dwordx4 a[228:231], v15, s[20:23], s99 offen offset:1024 sc1
  v_mfma_f32_16x16x32_bf16 v[80:83], a[236:239], a[32:35], v[80:83]
  v_mfma_f32_16x16x32_bf16 v[84:87], a[236:239], a[36:39], v[84:87]
  v_mfma_f32_16x16x32_bf16 v[88:91], a[236:239], a[40:43], v[88:91]
  v_mfma_f32_16x16x32_bf16 v[92:95], a[236:239], a[44:47], v[92:95]
  buffer_load_dwordx4 a[232:235], v15, s[20:23], s99 offen offset:2048 sc1
  v_mfma_f32_16x16x32_bf16 v[96:99], a[240:243], a[32:35], v[96:99]
  v_mfma_f32_16x16x32_bf16 v[100:103], a[240:243], a[36:39], v[100:103]
  v_mfma_f32_16x16x32_bf16 v[104:107], a[240:243], a[40:43], v[104:107]
  v_mfma_f32_16x16x32_bf16 v[108:111], a[240:243], a[44:47], v[108:111]
  buffer_load_dwordx4 a[236:239], v15, s[20:23], s99 offen offset:3072 sc1
  v_mfma_f32_16x16x32_bf16 v[112:115], a[244:247], a[32:35], v[112:115]
  v_mfma_f32_16x16x32_bf16 v[116:119], a[244:247], a[36:39], v[116:119]
  v_mfma_f32_16x16x32_bf16 v[120:123], a[244:247], a[40:43], v[120:123]
  v_mfma_f32_16x16x32_bf16 v[124:127], a[244:247], a[44:47], v[124:127]
  buffer_load_dwordx4 a[240:243], v24, s[20:23], s99 offen offset:0 sc1
  v_mfma_f32_16x16x32_bf16 v[128:131], a[248:251], a[32:35], v[128:131]
  v_mfma_f32_16x16x32_bf16 v[132:135], a[248:251], a[36:39], v[132:135]
  v_mfma_f32_16x16x32_bf16 v[136:139], a[248:251], a[40:43], v[136:139]
  v_mfma_f32_16x16x32_bf16 v[140:143], a[248:251], a[44:47], v[140:143]
  buffer_load_dwordx4 a[244:247], v24, s[20:23], s99 offen offset:1024 sc1
  v_mfma_f32_16x16x32_bf16 v[144:147], a[252:255], a[32:35], v[144:147]
  v_mfma_f32_16x16x32_bf16 v[148:151], a[252:255], a[36:39], v[148:151]
  v_mfma_f32_16x16x32_bf16 v[152:155], a[252:255], a[40:43], v[152:155]
  v_mfma_f32_16x16x32_bf16 v[156:159], a[252:255], a[44:47], v[156:159]
  buffer_load_dwordx4 a[248:251], v24, s[20:23], s99 offen offset:2048 sc1
  s_waitcnt vmcnt(15)
  v_mfma_f32_16x16x32_bf16 v[32:35], v[224:227], a[48:51], v[32:35]
  v_mfma_f32_16x16x32_bf16 v[36:39], v[224:227], a[52:55], v[36:39]
  v_mfma_f32_16x16x32_bf16 v[40:43], v[224:227], a[56:59], v[40:43]
  v_mfma_f32_16x16x32_bf16 v[44:47], v[224:227], a[60:63], v[44:47]
  buffer_load_dwordx4 a[252:255], v24, s[20:23], s99 offen offset:3072 sc1
  s_add_u32 s99, s99, 16384
  v_mfma_f32_16x16x32_bf16 v[48:51], v[228:231], a[48:51], v[48:51]
  v_mfma_f32_16x16x32_bf16 v[52:55], v[228:231], a[52:55], v[52:55]
  v_mfma_f32_16x16x32_bf16 v[56:59], v[228:231], a[56:59], v[56:59]
  v_mfma_f32_16x16x32_bf16 v[60:63], v[228:231], a[60:63], v[60:63]
  buffer_load_dwordx4 v[224:227], v15, s[20:23], s98 offen offset:0 sc1
  v_mfma_f32_16x16x32_bf16 v[64:67], v[232:235], a[48:51], v[64:67]
  v_mfma_f32_16x16x32_bf16 v[68:71], v[232:235], a[52:55], v[68:71]
  v_mfma_f32_16x16x32_bf16 v[72:75], v[232:235], a[56:59], v[72:75]
  v_mfma_f32_16x16x32_bf16 v[76:79], v[232:235], a[60:63], v[76:79]
  buffer_load_dwordx4 v[228:231], v15, s[20:23], s98 offen offset:1024 sc1
  v_mfma_f32_16x16x32_bf16 v[80:83], v[236:239], a[48:51], v[80:83]
  v_mfma_f32_16x16x32_bf16 v[84:87], v[236:239], a[52:55], v[84:87]
  v_mfma_f32_16x16x32_bf16 v[88:91], v[236:239], a[56:59], v[88:91]
  v_mfma_f32_16x16x32_bf16 v[92:95], v[236:239], a[60:63], v[92:95]
  buffer_load_dwordx4 v[232:235], v15, s[20:23], s98 offen offset:2048 sc1
  v_mfma_f32_16x16x32_bf16 v[96:99], v[240:243], a[48:51], v[96:99]
  v_mfma_f32_16x16x32_bf16 v[100:103], v[240:243], a[52:55], v[100:103]
  v_mfma_f32_16x16x32_bf16 v[104:107], v[240:243], a[56:59], v[104:107]
  v_mfma_f32_16x16x32_bf16 v[108:111], v[240:243], a[60:63], v[108:111]
  buffer_load_dwordx4 v[236:239], v15, s[20:23], s98 offen offset:3072 sc1
  v_mfma_f32_16x16x32_bf16 v[112:115], v[244:247], a[48:51], v[112:115]
  v_mfma_f32_16x16x32_bf16 v[116:119], v[244:247], a[52:55], v[116:119]
  v_mfma_f32_16x16x32_bf16 v[120:123], v[244:247], a[56:59], v[120:123]
  v_mfma_f32_16x16x32_bf16 v[124:127], v[244:247], a[60:63], v[124:127]
  buffer_load_dwordx4 v[240:243], v24, s[20:23], s98 offen offset:0 sc1
  v_mfma_f32_16x16x32_bf16 v[128:131], v[248:251], a[48:51], v[128:131]
  v_mfma_f32_16x16x32_bf16 v[132:135], v[248:251], a[52:55], v[132:135]
  v_mfma_f32_16x16x32_bf16 v[136:139], v[248:251], a[56:59], v[136:139]
  v_mfma_f32_16x16x32_bf16 v[140:143], v[248:251], a[60:63], v[140:143]
  buffer_load_dwordx4 v[244:247], v24, s[20:23], s98 offen offset:1024 sc1
  v_mfma_f32_16x16x32_bf16 v[144:147], v[252:255], a[48:51], v[144:147]
  v_mfma_f32_16x16x32_bf16 v[148:151], v[252:255], a[52:55], v[148:151]
  v_mfma_f32_16x16x32_bf16 v[152:155], v[252:255], a[56:59], v[152:155]
  v_mfma_f32_16x16x32_bf16 v[156:159], v[252:255], a[60:63], v[156:159]
  buffer_load_dwordx4 v[248:251], v24, s[20:23], s98 offen offset:2048 sc1
  s_waitcnt vmcnt(15)
  s_waitcnt lgkmcnt(0)
  v_mfma_f32_16x16x32_bf16 v[32:35], v[160:163], a[64:67], v[32:35]
  v_mfma_f32_16x16x32_bf16 v[36:39], v[160:163], a[68:71], v[36:39]
  s_xor_b32 s60, s52, 1
  v_mfma_f32_16x16x32_bf16 v[40:43], v[160:163], a[72:75], v[40:43]
  v_mfma_f32_16x16x32_bf16 v[44:47], v[160:163], a[76:79], v[44:47]
  buffer_load_dwordx4 v[252:255], v24, s[20:23], s98 offen offset:3072 sc1
  s_add_u32 s98, s98, 16384
  v_mfma_f32_16x16x32_bf16 v[48:51], v[164:167], a[64:67], v[48:51]
  v_mfma_f32_16x16x32_bf16 v[52:55], v[164:167], a[68:71], v[52:55]
  s_mul_i32 s60, s60, 24576
  v_mfma_f32_16x16x32_bf16 v[56:59], v[164:167], a[72:75], v[56:59]
  v_mfma_f32_16x16x32_bf16 v[60:63], v[164:167], a[76:79], v[60:63]
  buffer_load_dwordx4 v[160:163], v15, s[20:23], s99 offen offset:0 sc1
  v_mfma_f32_16x16x32_bf16 v[64:67], v[168:171], a[64:67], v[64:67]
  v_mfma_f32_16x16x32_bf16 v[68:71], v[168:171], a[68:71], v[68:71]
  s_add_u32 s60, s60, 0
  v_mfma_f32_16x16x32_bf16 v[72:75], v[168:171], a[72:75], v[72:75]
  v_mfma_f32_16x16x32_bf16 v[76:79], v[168:171], a[76:79], v[76:79]
  buffer_load_dwordx4 v[164:167], v15, s[20:23], s99 offen offset:1024 sc1
  v_mfma_f32_16x16x32_bf16 v[80:83], v[172:175], a[64:67], v[80:83]
  v_mfma_f32_16x16x32_bf16 v[84:87], v[172:175], a[68:71], v[84:87]
  v_add_u32 v3, s60, v9
  v_mfma_f32_16x16x32_bf16 v[88:91], v[172:175], a[72:75], v[88:91]
  v_mfma_f32_16x16x32_bf16 v[92:95], v[172:175], a[76:79], v[92:95]
  buffer_load_dwordx4 v[168:171], v15, s[20:23], s99 offen offset:2048 sc1
  v_mfma_f32_16x16x32_bf16 v[96:99], v[176:179], a[64:67], v[96:99]
  v_mfma_f32_16x16x32_bf16 v[100:103], v[176:179], a[68:71], v[100:103]
  s_xor_b32 s60, s52, 2
  v_mfma_f32_16x16x32_bf16 v[104:107], v[176:179], a[72:75], v[104:107]
  v_mfma_f32_16x16x32_bf16 v[108:111], v[176:179], a[76:79], v[108:111]
  buffer_load_dwordx4 v[172:175], v15, s[20:23], s99 offen offset:3072 sc1
  v_mfma_f32_16x16x32_bf16 v[112:115], v[180:183], a[64:67], v[112:115]
  v_mfma_f32_16x16x32_bf16 v[116:119], v[180:183], a[68:71], v[116:119]
  s_mul_i32 s60, s60, 24576
  v_mfma_f32_16x16x32_bf16 v[120:123], v[180:183], a[72:75], v[120:123]
  v_mfma_f32_16x16x32_bf16 v[124:127], v[180:183], a[76:79], v[124:127]
  buffer_load_dwordx4 v[176:179], v24, s[20:23], s99 offen offset:0 sc1
  v_mfma_f32_16x16x32_bf16 v[128:131], v[184:187], a[64:67], v[128:131]
  v_mfma_f32_16x16x32_bf16 v[132:135], v[184:187], a[68:71], v[132:135]
  s_add_u32 s60, s60, 8192
  v_mfma_f32_16x16x32_bf16 v[136:139], v[184:187], a[72:75], v[136:139]
  v_mfma_f32_16x16x32_bf16 v[140:143], v[184:187], a[76:79], v[140:143]
  buffer_load_dwordx4 v[180:183], v24, s[20:23], s99 offen offset:1024 sc1
  v_mfma_f32_16x16x32_bf16 v[144:147], v[188:191], a[64:67], v[144:147]
  v_mfma_f32_16x16x32_bf16 v[148:151], v[188:191], a[68:71], v[148:151]
  v_add_u32 v4, s60, v9
  v_mfma_f32_16x16x32_bf16 v[152:155], v[188:191], a[72:75], v[152:155]
  v_mfma_f32_16x16x32_bf16 v[156:159], v[188:191], a[76:79], v[156:159]
  buffer_load_dwordx4 v[184:187], v24, s[20:23], s99 offen offset:2048 sc1
  s_waitcnt vmcnt(15)
  v_mfma_f32_16x16x32_bf16 v[32:35], a[224:227], a[80:83], v[32:35]
  v_mfma_f32_16x16x32_bf16 v[36:39], a[224:227], a[84:87], v[36:39]
  s_xor_b32 s60, s52, 3
  v_mfma_f32_16x16x32_bf16 v[40:43], a[224:227], a[88:91], v[40:43]
  v_mfma_f32_16x16x32_bf16 v[44:47], a[224:227], a[92:95], v[44:47]
  buffer_load_dwordx4 v[188:191], v24, s[20:23], s99 offen offset:3072 sc1
  s_add_u32 s99, s99, 16384
  v_mfma_f32_16x16x32_bf16 v[48:51], a[228:231], a[80:83], v[48:51]
  v_mfma_f32_16x16x32_bf16 v[52:55], a[228:231], a[84:87], v[52:55]
  s_mul_i32 s60, s60, 24576
  v_mfma_f32_16x16x32_bf16 v[56:59], a[228:231], a[88:91], v[56:59]
  v_mfma_f32_16x16x32_bf16 v[60:63], a[228:231], a[92:95], v[60:63]
  buffer_load_dwordx4 a[224:227], v15, s[20:23], s98 offen offset:0 sc1
  v_mfma_f32_16x16x32_bf16 v[64:67], a[232:235], a[80:83], v[64:67]
  v_mfma_f32_16x16x32_bf16 v[68:71], a[232:235], a[84:87], v[68:71]
  s_add_u32 s60, s60, 16384
  v_mfma_f32_16x16x32_bf16 v[72:75], a[232:235], a[88:91], v[72:75]
  v_mfma_f32_16x16x32_bf16 v[76:79], a[232:235], a[92:95], v[76:79]
  buffer_load_dwordx4 a[228:231], v15, s[20:23], s98 offen offset:1024 sc1
  v_mfma_f32_16x16x32_bf16 v[80:83], a[236:239], a[80:83], v[80:83]
  v_mfma_f32_16x16x32_bf16 v[84:87], a[236:239], a[84:87], v[84:87]
  v_add_u32 v8, s60, v9
  v_mfma_f32_16x16x32_bf16 v[88:91], a[236:239], a[88:91], v[88:91]
  v_mfma_f32_16x16x32_bf16 v[92:95], a[236:239], a[92:95], v[92:95]
  buffer_load_dwordx4 a[232:235], v15, s[20:23], s98 offen offset:2048 sc1
  v_mfma_f32_16x16x32_bf16 v[96:99], a[240:243], a[80:83], v[96:99]
  v_mfma_f32_16x16x32_bf16 v[100:103], a[240:243], a[84:87], v[100:103]
  s_mul_i32 s60, s52, 24576
  v_mfma_f32_16x16x32_bf16 v[104:107], a[240:243], a[88:91], v[104:107]
  v_mfma_f32_16x16x32_bf16 v[108:111], a[240:243], a[92:95], v[108:111]
  buffer_load_dwordx4 a[236:239], v15, s[20:23], s98 offen offset:3072 sc1
  v_mfma_f32_16x16x32_bf16 v[112:115], a[244:247], a[80:83], v[112:115]
  v_mfma_f32_16x16x32_bf16 v[116:119], a[244:247], a[84:87], v[116:119]
  v_add_u32 v10, s60, v9
  v_mfma_f32_16x16x32_bf16 v[120:123], a[244:247], a[88:91], v[120:123]
  v_mfma_f32_16x16x32_bf16 v[124:127], a[244:247], a[92:95], v[124:127]
  buffer_load_dwordx4 a[240:243], v24, s[20:23], s98 offen offset:0 sc1
  v_mfma_f32_16x16x32_bf16 v[128:131], a[248:251], a[80:83], v[128:131]
  v_mfma_f32_16x16x32_bf16 v[132:135], a[248:251], a[84:87], v[132:135]
  v_mfma_f32_16x16x32_bf16 v[136:139], a[248:251], a[88:91], v[136:139]
  v_mfma_f32_16x16x32_bf16 v[140:143], a[248:251], a[92:95], v[140:143]
  buffer_load_dwordx4 a[244:247], v24, s[20:23], s98 offen offset:1024 sc1
  v_mfma_f32_16x16x32_bf16 v[144:147], a[252:255], a[80:83], v[144:147]
  v_mfma_f32_16x16x32_bf16 v[148:151], a[252:255], a[84:87], v[148:151]
  v_mfma_f32_16x16x32_bf16 v[152:155], a[252:255], a[88:91], v[152:155]
  v_mfma_f32_16x16x32_bf16 v[156:159], a[252:255], a[92:95], v[156:159]
  buffer_load_dwordx4 a[248:251], v24, s[20:23], s98 offen offset:2048 sc1
  s_waitcnt vmcnt(15)
  v_mfma_f32_16x16x32_bf16 v[32:35], v[224:227], a[96:99], v[32:35]
  v_mfma_f32_16x16x32_bf16 v[36:39], v[224:227], a[100:103], v[36:39]
  v_mfma_f32_16x16x32_bf16 v[40:43], v[224:227], a[104:107], v[40:43]
  v_mfma_f32_16x16x32_bf16 v[44:47], v[224:227], a[108:111], v[44:47]
  buffer_load_dwordx4 a[252:255], v24, s[20:23], s98 offen offset:3072 sc1
  s_add_u32 s98, s98, 16384
  v_mfma_f32_16x16x32_bf16 v[48:51], v[228:231], a[96:99], v[48:51]
  v_mfma_f32_16x16x32_bf16 v[52:55], v[228:231], a[100:103], v[52:55]
  v_mfma_f32_16x16x32_bf16 v[56:59], v[228:231], a[104:107], v[56:59]
  v_mfma_f32_16x16x32_bf16 v[60:63], v[228:231], a[108:111], v[60:63]
  buffer_load_dwordx4 v[224:227], v15, s[20:23], s99 offen offset:0 sc1
  v_mfma_f32_16x16x32_bf16 v[64:67], v[232:235], a[96:99], v[64:67]
  v_mfma_f32_16x16x32_bf16 v[68:71], v[232:235], a[100:103], v[68:71]
  v_mfma_f32_16x16x32_bf16 v[72:75], v[232:235], a[104:107], v[72:75]
  v_mfma_f32_16x16x32_bf16 v[76:79], v[232:235], a[108:111], v[76:79]
  buffer_load_dwordx4 v[228:231], v15, s[20:23], s99 offen offset:1024 sc1
  v_mfma_f32_16x16x32_bf16 v[80:83], v[236:239], a[96:99], v[80:83]
  v_mfma_f32_16x16x32_bf16 v[84:87], v[236:239], a[100:103], v[84:87]
  v_mfma_f32_16x16x32_bf16 v[88:91], v[236:239], a[104:107], v[88:91]
  v_mfma_f32_16x16x32_bf16 v[92:95], v[236:239], a[108:111], v[92:95]
  buffer_load_dwordx4 v[232:235], v15, s[20:23], s99 offen offset:2048 sc1
  v_mfma_f32_16x16x32_bf16 v[96:99], v[240:243], a[96:99], v[96:99]
  v_mfma_f32_16x16x32_bf16 v[100:103], v[240:243], a[100:103], v[100:103]
  v_mfma_f32_16x16x32_bf16 v[104:107], v[240:243], a[104:107], v[104:107]
  v_mfma_f32_16x16x32_bf16 v[108:111], v[240:243], a[108:111], v[108:111]
  buffer_load_dwordx4 v[236:239], v15, s[20:23], s99 offen offset:3072 sc1
  v_mfma_f32_16x16x32_bf16 v[112:115], v[244:247], a[96:99], v[112:115]
  v_mfma_f32_16x16x32_bf16 v[116:119], v[244:247], a[100:103], v[116:119]
  v_mfma_f32_16x16x32_bf16 v[120:123], v[244:247], a[104:107], v[120:123]
  v_mfma_f32_16x16x32_bf16 v[124:127], v[244:247], a[108:111], v[124:127]
  buffer_load_dwordx4 v[240:243], v24, s[20:23], s99 offen offset:0 sc1
  v_mfma_f32_16x16x32_bf16 v[128:131], v[248:251], a[96:99], v[128:131]
  v_mfma_f32_16x16x32_bf16 v[132:135], v[248:251], a[100:103], v[132:135]
  v_mfma_f32_16x16x32_bf16 v[136:139], v[248:251], a[104:107], v[136:139]
  v_mfma_f32_16x16x32_bf16 v[140:143], v[248:251], a[108:111], v[140:143]
  buffer_load_dwordx4 v[244:247], v24, s[20:23], s99 offen offset:1024 sc1
  v_mfma_f32_16x16x32_bf16 v[144:147], v[252:255], a[96:99], v[144:147]
  v_mfma_f32_16x16x32_bf16 v[148:151], v[252:255], a[100:103], v[148:151]
  v_mfma_f32_16x16x32_bf16 v[152:155], v[252:255], a[104:107], v[152:155]
  v_mfma_f32_16x16x32_bf16 v[156:159], v[252:255], a[108:111], v[156:159]
  buffer_load_dwordx4 v[248:251], v24, s[20:23], s99 offen offset:2048 sc1
  s_waitcnt vmcnt(15)
  v_mfma_f32_16x16x32_bf16 v[32:35], v[160:163], a[112:115], v[32:35]
  v_mfma_f32_16x16x32_bf16 v[36:39], v[160:163], a[116:119], v[36:39]
  v_mfma_f32_16x16x32_bf16 v[40:43], v[160:163], a[120:123], v[40:43]
  v_mfma_f32_16x16x32_bf16 v[44:47], v[160:163], a[124:127], v[44:47]
  buffer_load_dwordx4 v[252:255], v24, s[20:23], s99 offen offset:3072 sc1
  s_add_u32 s99, s99, 16384
  v_mfma_f32_16x16x32_bf16 v[48:51], v[164:167], a[112:115], v[48:51]
  v_mfma_f32_16x16x32_bf16 v[52:55], v[164:167], a[116:119], v[52:55]
  v_mfma_f32_16x16x32_bf16 v[56:59], v[164:167], a[120:123], v[56:59]
  v_mfma_f32_16x16x32_bf16 v[60:63], v[164:167], a[124:127], v[60:63]
  buffer_load_dwordx4 v[160:163], v15, s[20:23], s98 offen offset:0 sc1
  v_mfma_f32_16x16x32_bf16 v[64:67], v[168:171], a[112:115], v[64:67]
  v_mfma_f32_16x16x32_bf16 v[68:71], v[168:171], a[116:119], v[68:71]
  v_mfma_f32_16x16x32_bf16 v[72:75], v[168:171], a[120:123], v[72:75]
  v_mfma_f32_16x16x32_bf16 v[76:79], v[168:171], a[124:127], v[76:79]
  buffer_load_dwordx4 v[164:167], v15, s[20:23], s98 offen offset:1024 sc1
  v_mfma_f32_16x16x32_bf16 v[80:83], v[172:175], a[112:115], v[80:83]
  v_mfma_f32_16x16x32_bf16 v[84:87], v[172:175], a[116:119], v[84:87]
  v_mfma_f32_16x16x32_bf16 v[88:91], v[172:175], a[120:123], v[88:91]
  v_mfma_f32_16x16x32_bf16 v[92:95], v[172:175], a[124:127], v[92:95]
  buffer_load_dwordx4 v[168:171], v15, s[20:23], s98 offen offset:2048 sc1
  v_mfma_f32_16x16x32_bf16 v[96:99], v[176:179], a[112:115], v[96:99]
  v_mfma_f32_16x16x32_bf16 v[100:103], v[176:179], a[116:119], v[100:103]
  v_mfma_f32_16x16x32_bf16 v[104:107], v[176:179], a[120:123], v[104:107]
  v_mfma_f32_16x16x32_bf16 v[108:111], v[176:179], a[124:127], v[108:111]
  buffer_load_dwordx4 v[172:175], v15, s[20:23], s98 offen offset:3072 sc1
  v_mfma_f32_16x16x32_bf16 v[112:115], v[180:183], a[112:115], v[112:115]
  v_mfma_f32_16x16x32_bf16 v[116:119], v[180:183], a[116:119], v[116:119]
  v_mfma_f32_16x16x32_bf16 v[120:123], v[180:183], a[120:123], v[120:123]
  v_mfma_f32_16x16x32_bf16 v[124:127], v[180:183], a[124:127], v[124:127]
  buffer_load_dwordx4 v[176:179], v24, s[20:23], s98 offen offset:0 sc1
  v_mfma_f32_16x16x32_bf16 v[128:131], v[184:187], a[112:115], v[128:131]
  v_mfma_f32_16x16x32_bf16 v[132:135], v[184:187], a[116:119], v[132:135]
  v_mfma_f32_16x16x32_bf16 v[136:139], v[184:187], a[120:123], v[136:139]
  v_mfma_f32_16x16x32_bf16 v[140:143], v[184:187], a[124:127], v[140:143]
  buffer_load_dwordx4 v[180:183], v24, s[20:23], s98 offen offset:1024 sc1
  v_mfma_f32_16x16x32_bf16 v[144:147], v[188:191], a[112:115], v[144:147]
  v_mfma_f32_16x16x32_bf16 v[148:151], v[188:191], a[116:119], v[148:151]
  v_mfma_f32_16x16x32_bf16 v[152:155], v[188:191], a[120:123], v[152:155]
  v_mfma_f32_16x16x32_bf16 v[156:159], v[188:191], a[124:127], v[156:159]
  buffer_load_dwordx4 v[184:187], v24, s[20:23], s98 offen offset:2048 sc1
  s_waitcnt vmcnt(15)
  v_mfma_f32_16x16x32_bf16 v[32:35], a[224:227], a[128:131], v[32:35]
  v_mfma_f32_16x16x32_bf16 v[36:39], a[224:227], a[132:135], v[36:39]
  v_mfma_f32_16x16x32_bf16 v[40:43], a[224:227], a[136:139], v[40:43]
  v_mfma_f32_16x16x32_bf16 v[44:47], a[224:227], a[140:143], v[44:47]
  buffer_load_dwordx4 v[188:191], v24, s[20:23], s98 offen offset:3072 sc1
  s_add_u32 s98, s98, 16384
  v_mfma_f32_16x16x32_bf16 v[48:51], a[228:231], a[128:131], v[48:51]
  v_mfma_f32_16x16x32_bf16 v[52:55], a[228:231], a[132:135], v[52:55]
  v_mfma_f32_16x16x32_bf16 v[56:59], a[228:231], a[136:139], v[56:59]
  v_mfma_f32_16x16x32_bf16 v[60:63], a[228:231], a[140:143], v[60:63]
  buffer_load_dwordx4 a[224:227], v15, s[20:23], s99 offen offset:0 sc1
  v_mfma_f32_16x16x32_bf16 v[64:67], a[232:235], a[128:131], v[64:67]
  v_mfma_f32_16x16x32_bf16 v[68:71], a[232:235], a[132:135], v[68:71]
  v_mfma_f32_16x16x32_bf16 v[72:75], a[232:235], a[136:139], v[72:75]
  v_mfma_f32_16x16x32_bf16 v[76:79], a[232:235], a[140:143], v[76:79]
  buffer_load_dwordx4 a[228:231], v15, s[20:23], s99 offen offset:1024 sc1
  v_mfma_f32_16x16x32_bf16 v[80:83], a[236:239], a[128:131], v[80:83]
  v_mfma_f32_16x16x32_bf16 v[84:87], a[236:239], a[132:135], v[84:87]
  v_mfma_f32_16x16x32_bf16 v[88:91], a[236:239], a[136:139], v[88:91]
  v_mfma_f32_16x16x32_bf16 v[92:95], a[236:239], a[140:143], v[92:95]
  buffer_load_dwordx4 a[232:235], v15, s[20:23], s99 offen offset:2048 sc1
  v_mfma_f32_16x16x32_bf16 v[96:99], a[240:243], a[128:131], v[96:99]
  v_mfma_f32_16x16x32_bf16 v[100:103], a[240:243], a[132:135], v[100:103]
  v_mfma_f32_16x16x32_bf16 v[104:107], a[240:243], a[136:139], v[104:107]
  v_mfma_f32_16x16x32_bf16 v[108:111], a[240:243], a[140:143], v[108:111]
  buffer_load_dwordx4 a[236:239], v15, s[20:23], s99 offen offset:3072 sc1
  v_mfma_f32_16x16x32_bf16 v[112:115], a[244:247], a[128:131], v[112:115]
  v_mfma_f32_16x16x32_bf16 v[116:119], a[244:247], a[132:135], v[116:119]
  v_mfma_f32_16x16x32_bf16 v[120:123], a[244:247], a[136:139], v[120:123]
  v_mfma_f32_16x16x32_bf16 v[124:127], a[244:247], a[140:143], v[124:127]
  buffer_load_dwordx4 a[240:243], v24, s[20:23], s99 offen offset:0 sc1
  v_mfma_f32_16x16x32_bf16 v[128:131], a[248:251], a[128:131], v[128:131]
  v_mfma_f32_16x16x32_bf16 v[132:135], a[248:251], a[132:135], v[132:135]
  v_mfma_f32_16x16x32_bf16 v[136:139], a[248:251], a[136:139], v[136:139]
  v_mfma_f32_16x16x32_bf16 v[140:143], a[248:251], a[140:143], v[140:143]
  buffer_load_dwordx4 a[244:247], v24, s[20:23], s99 offen offset:1024 sc1
  v_mfma_f32_16x16x32_bf16 v[144:147], a[252:255], a[128:131], v[144:147]
  v_mfma_f32_16x16x32_bf16 v[148:151], a[252:255], a[132:135], v[148:151]
  v_mfma_f32_16x16x32_bf16 v[152:155], a[252:255], a[136:139], v[152:155]
  v_mfma_f32_16x16x32_bf16 v[156:159], a[252:255], a[140:143], v[156:159]
  buffer_load_dwordx4 a[248:251], v24, s[20:23], s99 offen offset:2048 sc1
  s_waitcnt vmcnt(15)
  v_mfma_f32_16x16x32_bf16 v[32:35], v[224:227], a[144:147], v[32:35]
  v_mfma_f32_16x16x32_bf16 v[36:39], v[224:227], a[148:151], v[36:39]
  v_mfma_f32_16x16x32_bf16 v[40:43], v[224:227], a[152:155], v[40:43]
  v_mfma_f32_16x16x32_bf16 v[44:47], v[224:227], a[156:159], v[44:47]
  buffer_load_dwordx4 a[252:255], v24, s[20:23], s99 offen offset:3072 sc1
  s_add_u32 s99, s99, 16384
  v_mfma_f32_16x16x32_bf16 v[48:51], v[228:231], a[144:147], v[48:51]
  v_mfma_f32_16x16x32_bf16 v[52:55], v[228:231], a[148:151], v[52:55]
  v_mfma_f32_16x16x32_bf16 v[56:59], v[228:231], a[152:155], v[56:59]
  v_mfma_f32_16x16x32_bf16 v[60:63], v[228:231], a[156:159], v[60:63]
  buffer_load_dwordx4 v[224:227], v15, s[20:23], s98 offen offset:0 sc1
  v_mfma_f32_16x16x32_bf16 v[64:67], v[232:235], a[144:147], v[64:67]
  v_mfma_f32_16x16x32_bf16 v[68:71], v[232:235], a[148:151], v[68:71]
  v_mfma_f32_16x16x32_bf16 v[72:75], v[232:235], a[152:155], v[72:75]
  v_mfma_f32_16x16x32_bf16 v[76:79], v[232:235], a[156:159], v[76:79]
  buffer_load_dwordx4 v[228:231], v15, s[20:23], s98 offen offset:1024 sc1
  v_mfma_f32_16x16x32_bf16 v[80:83], v[236:239], a[144:147], v[80:83]
  v_mfma_f32_16x16x32_bf16 v[84:87], v[236:239], a[148:151], v[84:87]
  v_mfma_f32_16x16x32_bf16 v[88:91], v[236:239], a[152:155], v[88:91]
  v_mfma_f32_16x16x32_bf16 v[92:95], v[236:239], a[156:159], v[92:95]
  buffer_load_dwordx4 v[232:235], v15, s[20:23], s98 offen offset:2048 sc1
  v_mfma_f32_16x16x32_bf16 v[96:99], v[240:243], a[144:147], v[96:99]
  v_mfma_f32_16x16x32_bf16 v[100:103], v[240:243], a[148:151], v[100:103]
  v_mfma_f32_16x16x32_bf16 v[104:107], v[240:243], a[152:155], v[104:107]
  v_mfma_f32_16x16x32_bf16 v[108:111], v[240:243], a[156:159], v[108:111]
  buffer_load_dwordx4 v[236:239], v15, s[20:23], s98 offen offset:3072 sc1
  v_mfma_f32_16x16x32_bf16 v[112:115], v[244:247], a[144:147], v[112:115]
  v_mfma_f32_16x16x32_bf16 v[116:119], v[244:247], a[148:151], v[116:119]
  v_mfma_f32_16x16x32_bf16 v[120:123], v[244:247], a[152:155], v[120:123]
  v_mfma_f32_16x16x32_bf16 v[124:127], v[244:247], a[156:159], v[124:127]
  buffer_load_dwordx4 v[240:243], v24, s[20:23], s98 offen offset:0 sc1
  v_mfma_f32_16x16x32_bf16 v[128:131], v[248:251], a[144:147], v[128:131]
  v_mfma_f32_16x16x32_bf16 v[132:135], v[248:251], a[148:151], v[132:135]
  v_mfma_f32_16x16x32_bf16 v[136:139], v[248:251], a[152:155], v[136:139]
  v_mfma_f32_16x16x32_bf16 v[140:143], v[248:251], a[156:159], v[140:143]
  buffer_load_dwordx4 v[244:247], v24, s[20:23], s98 offen offset:1024 sc1
  v_mfma_f32_16x16x32_bf16 v[144:147], v[252:255], a[144:147], v[144:147]
  v_mfma_f32_16x16x32_bf16 v[148:151], v[252:255], a[148:151], v[148:151]
  v_mfma_f32_16x16x32_bf16 v[152:155], v[252:255], a[152:155], v[152:155]
  v_mfma_f32_16x16x32_bf16 v[156:159], v[252:255], a[156:159], v[156:159]
  buffer_load_dwordx4 v[248:251], v24, s[20:23], s98 offen offset:2048 sc1
  s_waitcnt vmcnt(15)
  v_mfma_f32_16x16x32_bf16 v[32:35], v[160:163], a[160:163], v[32:35]
  v_mfma_f32_16x16x32_bf16 v[36:39], v[160:163], a[164:167], v[36:39]
  v_mfma_f32_16x16x32_bf16 v[40:43], v[160:163], a[168:171], v[40:43]
  v_mfma_f32_16x16x32_bf16 v[44:47], v[160:163], a[172:175], v[44:47]
  buffer_load_dwordx4 v[252:255], v24, s[20:23], s98 offen offset:3072 sc1
  s_add_u32 s98, s98, 16384
  v_mfma_f32_16x16x32_bf16 v[48:51], v[164:167], a[160:163], v[48:51]
  v_mfma_f32_16x16x32_bf16 v[52:55], v[164:167], a[164:167], v[52:55]
  v_mfma_f32_16x16x32_bf16 v[56:59], v[164:167], a[168:171], v[56:59]
  v_mfma_f32_16x16x32_bf16 v[60:63], v[164:167], a[172:175], v[60:63]
  buffer_load_dwordx4 v[160:163], v15, s[20:23], s99 offen offset:0 sc1
  v_mfma_f32_16x16x32_bf16 v[64:67], v[168:171], a[160:163], v[64:67]
  v_mfma_f32_16x16x32_bf16 v[68:71], v[168:171], a[164:167], v[68:71]
  v_mfma_f32_16x16x32_bf16 v[72:75], v[168:171], a[168:171], v[72:75]
  v_mfma_f32_16x16x32_bf16 v[76:79], v[168:171], a[172:175], v[76:79]
  buffer_load_dwordx4 v[164:167], v15, s[20:23], s99 offen offset:1024 sc1
  v_mfma_f32_16x16x32_bf16 v[80:83], v[172:175], a[160:163], v[80:83]
  v_mfma_f32_16x16x32_bf16 v[84:87], v[172:175], a[164:167], v[84:87]
  v_mfma_f32_16x16x32_bf16 v[88:91], v[172:175], a[168:171], v[88:91]
  v_mfma_f32_16x16x32_bf16 v[92:95], v[172:175], a[172:175], v[92:95]
  buffer_load_dwordx4 v[168:171], v15, s[20:23], s99 offen offset:2048 sc1
  v_mfma_f32_16x16x32_bf16 v[96:99], v[176:179], a[160:163], v[96:99]
  v_mfma_f32_16x16x32_bf16 v[100:103], v[176:179], a[164:167], v[100:103]
  v_mfma_f32_16x16x32_bf16 v[104:107], v[176:179], a[168:171], v[104:107]
  v_mfma_f32_16x16x32_bf16 v[108:111], v[176:179], a[172:175], v[108:111]
  buffer_load_dwordx4 v[172:175], v15, s[20:23], s99 offen offset:3072 sc1
  v_mfma_f32_16x16x32_bf16 v[112:115], v[180:183], a[160:163], v[112:115]
  v_mfma_f32_16x16x32_bf16 v[116:119], v[180:183], a[164:167], v[116:119]
  v_mfma_f32_16x16x32_bf16 v[120:123], v[180:183], a[168:171], v[120:123]
  v_mfma_f32_16x16x32_bf16 v[124:127], v[180:183], a[172:175], v[124:127]
  buffer_load_dwordx4 v[176:179], v24, s[20:23], s99 offen offset:0 sc1
  v_mfma_f32_16x16x32_bf16 v[128:131], v[184:187], a[160:163], v[128:131]
  v_mfma_f32_16x16x32_bf16 v[132:135], v[184:187], a[164:167], v[132:135]
  v_mfma_f32_16x16x32_bf16 v[136:139], v[184:187], a[168:171], v[136:139]
  v_mfma_f32_16x16x32_bf16 v[140:143], v[184:187], a[172:175], v[140:143]
  buffer_load_dwordx4 v[180:183], v24, s[20:23], s99 offen offset:1024 sc1
  v_mfma_f32_16x16x32_bf16 v[144:147], v[188:191], a[160:163], v[144:147]
  v_mfma_f32_16x16x32_bf16 v[148:151], v[188:191], a[164:167], v[148:151]
  v_mfma_f32_16x16x32_bf16 v[152:155], v[188:191], a[168:171], v[152:155]
  v_mfma_f32_16x16x32_bf16 v[156:159], v[188:191], a[172:175], v[156:159]
  buffer_load_dwordx4 v[184:187], v24, s[20:23], s99 offen offset:2048 sc1
  s_waitcnt vmcnt(15)
  v_mfma_f32_16x16x32_bf16 v[32:35], a[224:227], a[176:179], v[32:35]
  v_mfma_f32_16x16x32_bf16 v[36:39], a[224:227], a[180:183], v[36:39]
  v_mfma_f32_16x16x32_bf16 v[40:43], a[224:227], a[184:187], v[40:43]
  v_mfma_f32_16x16x32_bf16 v[44:47], a[224:227], a[188:191], v[44:47]
  buffer_load_dwordx4 v[188:191], v24, s[20:23], s99 offen offset:3072 sc1
  s_add_u32 s99, s99, 16384
  v_mfma_f32_16x16x32_bf16 v[48:51], a[228:231], a[176:179], v[48:51]
  v_mfma_f32_16x16x32_bf16 v[52:55], a[228:231], a[180:183], v[52:55]
  v_mfma_f32_16x16x32_bf16 v[56:59], a[228:231], a[184:187], v[56:59]
  v_mfma_f32_16x16x32_bf16 v[60:63], a[228:231], a[188:191], v[60:63]
  buffer_load_dwordx4 a[224:227], v15, s[20:23], s98 offen offset:0 sc1
  v_mfma_f32_16x16x32_bf16 v[64:67], a[232:235], a[176:179], v[64:67]
  v_mfma_f32_16x16x32_bf16 v[68:71], a[232:235], a[180:183], v[68:71]
  v_mfma_f32_16x16x32_bf16 v[72:75], a[232:235], a[184:187], v[72:75]
  v_mfma_f32_16x16x32_bf16 v[76:79], a[232:235], a[188:191], v[76:79]
  buffer_load_dwordx4 a[228:231], v15, s[20:23], s98 offen offset:1024 sc1
  v_mfma_f32_16x16x32_bf16 v[80:83], a[236:239], a[176:179], v[80:83]
  v_mfma_f32_16x16x32_bf16 v[84:87], a[236:239], a[180:183], v[84:87]
  v_mfma_f32_16x16x32_bf16 v[88:91], a[236:239], a[184:187], v[88:91]
  v_mfma_f32_16x16x32_bf16 v[92:95], a[236:239], a[188:191], v[92:95]
  buffer_load_dwordx4 a[232:235], v15, s[20:23], s98 offen offset:2048 sc1
  v_mfma_f32_16x16x32_bf16 v[96:99], a[240:243], a[176:179], v[96:99]
  v_mfma_f32_16x16x32_bf16 v[100:103], a[240:243], a[180:183], v[100:103]
  v_mfma_f32_16x16x32_bf16 v[104:107], a[240:243], a[184:187], v[104:107]
  v_mfma_f32_16x16x32_bf16 v[108:111], a[240:243], a[188:191], v[108:111]
  buffer_load_dwordx4 a[236:239], v15, s[20:23], s98 offen offset:3072 sc1
  v_mfma_f32_16x16x32_bf16 v[112:115], a[244:247], a[176:179], v[112:115]
  v_mfma_f32_16x16x32_bf16 v[116:119], a[244:247], a[180:183], v[116:119]
  v_mfma_f32_16x16x32_bf16 v[120:123], a[244:247], a[184:187], v[120:123]
  v_mfma_f32_16x16x32_bf16 v[124:127], a[244:247], a[188:191], v[124:127]
  buffer_load_dwordx4 a[240:243], v24, s[20:23], s98 offen offset:0 sc1
  v_mfma_f32_16x16x32_bf16 v[128:131], a[248:251], a[176:179], v[128:131]
  v_mfma_f32_16x16x32_bf16 v[132:135], a[248:251], a[180:183], v[132:135]
  v_mfma_f32_16x16x32_bf16 v[136:139], a[248:251], a[184:187], v[136:139]
  v_mfma_f32_16x16x32_bf16 v[140:143], a[248:251], a[188:191], v[140:143]
  buffer_load_dwordx4 a[244:247], v24, s[20:23], s98 offen offset:1024 sc1
  v_mfma_f32_16x16x32_bf16 v[144:147], a[252:255], a[176:179], v[144:147]
  v_mfma_f32_16x16x32_bf16 v[148:151], a[252:255], a[180:183], v[148:151]
  v_mfma_f32_16x16x32_bf16 v[152:155], a[252:255], a[184:187], v[152:155]
  v_mfma_f32_16x16x32_bf16 v[156:159], a[252:255], a[188:191], v[156:159]
  buffer_load_dwordx4 a[248:251], v24, s[20:23], s98 offen offset:2048 sc1
  s_barrier
  s_waitcnt vmcnt(15)
  v_mfma_f32_16x16x32_bf16 v[32:35], v[224:227], a[192:195], v[32:35]
  v_mfma_f32_16x16x32_bf16 v[36:39], v[224:227], a[196:199], v[36:39]
  v_mfma_f32_16x16x32_bf16 v[40:43], v[224:227], a[200:203], v[40:43]
  v_mfma_f32_16x16x32_bf16 v[44:47], v[224:227], a[204:207], v[44:47]
  buffer_load_dwordx4 a[252:255], v24, s[20:23], s98 offen offset:3072 sc1
  s_add_u32 s98, s98, 16384
  v_mfma_f32_16x16x32_bf16 v[48:51], v[228:231], a[192:195], v[48:51]
  v_mfma_f32_16x16x32_bf16 v[52:55], v[228:231], a[196:199], v[52:55]
  v_mfma_f32_16x16x32_bf16 v[56:59], v[228:231], a[200:203], v[56:59]
  v_mfma_f32_16x16x32_bf16 v[60:63], v[228:231], a[204:207], v[60:63]
  buffer_load_dwordx4 v[224:227], v15, s[20:23], s99 offen offset:0 sc1
  v_mfma_f32_16x16x32_bf16 v[64:67], v[232:235], a[192:195], v[64:67]
  v_mfma_f32_16x16x32_bf16 v[68:71], v[232:235], a[196:199], v[68:71]
  v_mfma_f32_16x16x32_bf16 v[72:75], v[232:235], a[200:203], v[72:75]
  v_mfma_f32_16x16x32_bf16 v[76:79], v[232:235], a[204:207], v[76:79]
  buffer_load_dwordx4 v[228:231], v15, s[20:23], s99 offen offset:1024 sc1
  v_mfma_f32_16x16x32_bf16 v[80:83], v[236:239], a[192:195], v[80:83]
  v_mfma_f32_16x16x32_bf16 v[84:87], v[236:239], a[196:199], v[84:87]
  v_mfma_f32_16x16x32_bf16 v[88:91], v[236:239], a[200:203], v[88:91]
  v_mfma_f32_16x16x32_bf16 v[92:95], v[236:239], a[204:207], v[92:95]
  buffer_load_dwordx4 v[232:235], v15, s[20:23], s99 offen offset:2048 sc1
  v_mfma_f32_16x16x32_bf16 v[96:99], v[240:243], a[192:195], v[96:99]
  v_mfma_f32_16x16x32_bf16 v[100:103], v[240:243], a[196:199], v[100:103]
  v_mfma_f32_16x16x32_bf16 v[104:107], v[240:243], a[200:203], v[104:107]
  v_mfma_f32_16x16x32_bf16 v[108:111], v[240:243], a[204:207], v[108:111]
  buffer_load_dwordx4 v[236:239], v15, s[20:23], s99 offen offset:3072 sc1
  v_mfma_f32_16x16x32_bf16 v[112:115], v[244:247], a[192:195], v[112:115]
  v_mfma_f32_16x16x32_bf16 v[116:119], v[244:247], a[196:199], v[116:119]
  v_mfma_f32_16x16x32_bf16 v[120:123], v[244:247], a[200:203], v[120:123]
  v_mfma_f32_16x16x32_bf16 v[124:127], v[244:247], a[204:207], v[124:127]
  buffer_load_dwordx4 v[240:243], v24, s[20:23], s99 offen offset:0 sc1
  v_mfma_f32_16x16x32_bf16 v[128:131], v[248:251], a[192:195], v[128:131]
  v_mfma_f32_16x16x32_bf16 v[132:135], v[248:251], a[196:199], v[132:135]
  v_mfma_f32_16x16x32_bf16 v[136:139], v[248:251], a[200:203], v[136:139]
  v_mfma_f32_16x16x32_bf16 v[140:143], v[248:251], a[204:207], v[140:143]
  buffer_load_dwordx4 v[244:247], v24, s[20:23], s99 offen offset:1024 sc1
  v_mfma_f32_16x16x32_bf16 v[144:147], v[252:255], a[192:195], v[144:147]
  v_mfma_f32_16x16x32_bf16 v[148:151], v[252:255], a[196:199], v[148:151]
  v_mfma_f32_16x16x32_bf16 v[152:155], v[252:255], a[200:203], v[152:155]
  v_mfma_f32_16x16x32_bf16 v[156:159], v[252:255], a[204:207], v[156:159]
  buffer_load_dwordx4 v[248:251], v24, s[20:23], s99 offen offset:2048 sc1
  s_waitcnt vmcnt(15)
  v_mfma_f32_16x16x32_bf16 v[32:35], v[160:163], a[208:211], v[32:35]
  v_mfma_f32_16x16x32_bf16 v[36:39], v[160:163], a[212:215], v[36:39]
  v_mfma_f32_16x16x32_bf16 v[40:43], v[160:163], a[216:219], v[40:43]
  v_mfma_f32_16x16x32_bf16 v[44:47], v[160:163], a[220:223], v[44:47]
  buffer_load_dwordx4 v[252:255], v24, s[20:23], s99 offen offset:3072 sc1
  s_add_u32 s99, s99, 16384
  v_mfma_f32_16x16x32_bf16 v[48:51], v[164:167], a[208:211], v[48:51]
  v_mfma_f32_16x16x32_bf16 v[52:55], v[164:167], a[212:215], v[52:55]
  v_mfma_f32_16x16x32_bf16 v[56:59], v[164:167], a[216:219], v[56:59]
  v_mfma_f32_16x16x32_bf16 v[60:63], v[164:167], a[220:223], v[60:63]
  v_mfma_f32_16x16x32_bf16 v[64:67], v[168:171], a[208:211], v[64:67]
  v_mfma_f32_16x16x32_bf16 v[68:71], v[168:171], a[212:215], v[68:71]
  v_mfma_f32_16x16x32_bf16 v[72:75], v[168:171], a[216:219], v[72:75]
  v_mfma_f32_16x16x32_bf16 v[76:79], v[168:171], a[220:223], v[76:79]
  v_mfma_f32_16x16x32_bf16 v[80:83], v[172:175], a[208:211], v[80:83]
  v_mfma_f32_16x16x32_bf16 v[84:87], v[172:175], a[212:215], v[84:87]
  v_mfma_f32_16x16x32_bf16 v[88:91], v[172:175], a[216:219], v[88:91]
  v_mfma_f32_16x16x32_bf16 v[92:95], v[172:175], a[220:223], v[92:95]
  v_mfma_f32_16x16x32_bf16 v[96:99], v[176:179], a[208:211], v[96:99]
  v_mfma_f32_16x16x32_bf16 v[100:103], v[176:179], a[212:215], v[100:103]
  v_mfma_f32_16x16x32_bf16 v[104:107], v[176:179], a[216:219], v[104:107]
  v_mfma_f32_16x16x32_bf16 v[108:111], v[176:179], a[220:223], v[108:111]
  v_mfma_f32_16x16x32_bf16 v[112:115], v[180:183], a[208:211], v[112:115]
  v_mfma_f32_16x16x32_bf16 v[116:119], v[180:183], a[212:215], v[116:119]
  v_mfma_f32_16x16x32_bf16 v[120:123], v[180:183], a[216:219], v[120:123]
  v_mfma_f32_16x16x32_bf16 v[124:127], v[180:183], a[220:223], v[124:127]
  v_mfma_f32_16x16x32_bf16 v[128:131], v[184:187], a[208:211], v[128:131]
  v_mfma_f32_16x16x32_bf16 v[132:135], v[184:187], a[212:215], v[132:135]
  v_mfma_f32_16x16x32_bf16 v[136:139], v[184:187], a[216:219], v[136:139]
  v_mfma_f32_16x16x32_bf16 v[140:143], v[184:187], a[220:223], v[140:143]
  v_mfma_f32_16x16x32_bf16 v[144:147], v[188:191], a[208:211], v[144:147]
  v_mfma_f32_16x16x32_bf16 v[148:151], v[188:191], a[212:215], v[148:151]
  v_mfma_f32_16x16x32_bf16 v[152:155], v[188:191], a[216:219], v[152:155]
  v_mfma_f32_16x16x32_bf16 v[156:159], v[188:191], a[220:223], v[156:159]
  s_waitcnt vmcnt(8)
  v_mfma_f32_16x16x32_bf16 v[32:35], a[224:227], a[0:3], v[32:35]
  v_mfma_f32_16x16x32_bf16 v[36:39], a[224:227], a[4:7], v[36:39]
  v_mfma_f32_16x16x32_bf16 v[40:43], a[224:227], a[8:11], v[40:43]
  v_mfma_f32_16x16x32_bf16 v[44:47], a[224:227], a[12:15], v[44:47]
  s_add_u32 s89, s101, 0
  s_add_u32 m0, s88, 0
  s_nop 0
  buffer_load_dwordx4 v16, s[24:27], s89 offen lds
  v_mfma_f32_16x16x32_bf16 v[48:51], a[228:231], a[0:3], v[48:51]
  v_mfma_f32_16x16x32_bf16 v[52:55], a[228:231], a[4:7], v[52:55]
  v_mfma_f32_16x16x32_bf16 v[56:59], a[228:231], a[8:11], v[56:59]
  v_mfma_f32_16x16x32_bf16 v[60:63], a[228:231], a[12:15], v[60:63]
  s_add_u32 s89, s101, 14336
  s_add_u32 m0, s88, 1024
  s_nop 0
  buffer_load_dwordx4 v16, s[24:27], s89 offen lds
  v_mfma_f32_16x16x32_bf16 v[64:67], a[232:235], a[0:3], v[64:67]
  v_mfma_f32_16x16x32_bf16 v[68:71], a[232:235], a[4:7], v[68:71]
  v_mfma_f32_16x16x32_bf16 v[72:75], a[232:235], a[8:11], v[72:75]
  v_mfma_f32_16x16x32_bf16 v[76:79], a[232:235], a[12:15], v[76:79]
  s_add_u32 s89, s101, 7168
  s_add_u32 m0, s88, 2048
  s_nop 0
  buffer_load_dwordx4 v16, s[24:27], s89 offen lds
  v_mfma_f32_16x16x32_bf16 v[80:83], a[236:239], a[0:3], v[80:83]
  v_mfma_f32_16x16x32_bf16 v[84:87], a[236:239], a[4:7], v[84:87]
  v_mfma_f32_16x16x32_bf16 v[88:91], a[236:239], a[8:11], v[88:91]
  v_mfma_f32_16x16x32_bf16 v[92:95], a[236:239], a[12:15], v[92:95]
  s_add_u32 s89, s101, 21504
  s_add_u32 m0, s88, 3072
  s_nop 0
  buffer_load_dwordx4 v16, s[24:27], s89 offen lds
  v_mfma_f32_16x16x32_bf16 v[96:99], a[240:243], a[0:3], v[96:99]
  v_mfma_f32_16x16x32_bf16 v[100:103], a[240:243], a[4:7], v[100:103]
  v_mfma_f32_16x16x32_bf16 v[104:107], a[240:243], a[8:11], v[104:107]
  v_mfma_f32_16x16x32_bf16 v[108:111], a[240:243], a[12:15], v[108:111]
  s_add_u32 s89, s101, 114688
  s_add_u32 m0, s88, 4096
  s_nop 0
  buffer_load_dwordx4 v16, s[24:27], s89 offen lds
  v_mfma_f32_16x16x32_bf16 v[112:115], a[244:247], a[0:3], v[112:115]
  v_mfma_f32_16x16x32_bf16 v[116:119], a[244:247], a[4:7], v[116:119]
  v_mfma_f32_16x16x32_bf16 v[120:123], a[244:247], a[8:11], v[120:123]
  v_mfma_f32_16x16x32_bf16 v[124:127], a[244:247], a[12:15], v[124:127]
  s_add_u32 s89, s101, 129024
  s_add_u32 m0, s88, 5120
  s_nop 0
  buffer_load_dwordx4 v16, s[24:27], s89 offen lds
  v_mfma_f32_16x16x32_bf16 v[128:131], a[248:251], a[0:3], v[128:131]
  v_mfma_f32_16x16x32_bf16 v[132:135], a[248:251], a[4:7], v[132:135]
  v_mfma_f32_16x16x32_bf16 v[136:139], a[248:251], a[8:11], v[136:139]
  v_mfma_f32_16x16x32_bf16 v[140:143], a[248:251], a[12:15], v[140:143]
  s_add_u32 s89, s101, 121856
  s_add_u32 m0, s88, 6144
  s_nop 0
  buffer_load_dwordx4 v16, s[24:27], s89 offen lds
  v_mfma_f32_16x16x32_bf16 v[144:147], a[252:255], a[0:3], v[144:147]
  v_mfma_f32_16x16x32_bf16 v[148:151], a[252:255], a[4:7], v[148:151]
  v_mfma_f32_16x16x32_bf16 v[152:155], a[252:255], a[8:11], v[152:155]
  v_mfma_f32_16x16x32_bf16 v[156:159], a[252:255], a[12:15], v[156:159]
  s_add_u32 s89, s101, 136192
  s_add_u32 m0, s88, 7168
  s_nop 0
  buffer_load_dwordx4 v16, s[24:27], s89 offen lds
  s_waitcnt vmcnt(8)
  v_mfma_f32_16x16x32_bf16 v[96:99], v[240:243], a[16:19], v[96:99]
  v_mfma_f32_16x16x32_bf16 v[100:103], v[240:243], a[20:23], v[100:103]
  v_mfma_f32_16x16x32_bf16 v[104:107], v[240:243], a[24:27], v[104:107]
  v_mfma_f32_16x16x32_bf16 v[108:111], v[240:243], a[28:31], v[108:111]
  s_add_u32 s89, s101, 229376
  s_add_u32 m0, s88, 8192
  s_nop 0
  buffer_load_dwordx4 v16, s[24:27], s89 offen lds
  v_mfma_f32_16x16x32_bf16 v[112:115], v[244:247], a[16:19], v[112:115]
  v_mfma_f32_16x16x32_bf16 v[116:119], v[244:247], a[20:23], v[116:119]
  v_mfma_f32_16x16x32_bf16 v[120:123], v[244:247], a[24:27], v[120:123]
  ds_write_b128 v3, v[96:99] offset:0
  v_mfma_f32_16x16x32_bf16 v[124:127], v[244:247], a[28:31], v[124:127]
  s_add_u32 s89, s101, 243712
  s_add_u32 m0, s88, 9216
  s_nop 0
  buffer_load_dwordx4 v16, s[24:27], s89 offen lds
  v_mfma_f32_16x16x32_bf16 v[128:131], v[248:251], a[16:19], v[128:131]
  ds_write_b128 v3, v[100:103] offset:1024
  v_mfma_f32_16x16x32_bf16 v[132:135], v[248:251], a[20:23], v[132:135]
  v_mfma_f32_16x16x32_bf16 v[136:139], v[248:251], a[24:27], v[136:139]
  ds_write_b128 v8, v[104:107] offset:0
  v_mfma_f32_16x16x32_bf16 v[140:143], v[248:251], a[28:31], v[140:143]
  s_add_u32 s89, s101, 236544
  s_add_u32 m0, s88, 10240
  s_nop 0
  buffer_load_dwordx4 v16, s[24:27], s89 offen lds
  v_mfma_f32_16x16x32_bf16 v[144:147], v[252:255], a[16:19], v[144:147]
  ds_write_b128 v8, v[108:111] offset:1024
  v_mfma_f32_16x16x32_bf16 v[148:151], v[252:255], a[20:23], v[148:151]
  v_mfma_f32_16x16x32_bf16 v[152:155], v[252:255], a[24:27], v[152:155]
  ds_write_b128 v3, v[112:115] offset:2048
  v_mfma_f32_16x16x32_bf16 v[156:159], v[252:255], a[28:31], v[156:159]
  s_add_u32 s89, s101, 250880
  s_add_u32 m0, s88, 11264
  s_nop 0
  buffer_load_dwordx4 v16, s[24:27], s89 offen lds
  v_mfma_f32_16x16x32_bf16 v[40:43], v[224:227], a[24:27], v[40:43]
  ds_write_b128 v3, v[116:119] offset:3072
  v_mfma_f32_16x16x32_bf16 v[44:47], v[224:227], a[28:31], v[44:47]
  v_mfma_f32_16x16x32_bf16 v[56:59], v[228:231], a[24:27], v[56:59]
  ds_write_b128 v8, v[120:123] offset:2048
  v_mfma_f32_16x16x32_bf16 v[60:63], v[228:231], a[28:31], v[60:63]
  v_mfma_f32_16x16x32_bf16 v[72:75], v[232:235], a[24:27], v[72:75]
  ds_write_b128 v8, v[124:127] offset:3072
  v_mfma_f32_16x16x32_bf16 v[76:79], v[232:235], a[28:31], v[76:79]
  v_mfma_f32_16x16x32_bf16 v[88:91], v[236:239], a[24:27], v[88:91]
  ds_write_b128 v3, v[128:131] offset:4096
  v_mfma_f32_16x16x32_bf16 v[92:95], v[236:239], a[28:31], v[92:95]
  v_mfma_f32_16x16x32_bf16 v[32:35], v[224:227], a[16:19], v[32:35]
  ds_write_b128 v3, v[132:135] offset:5120
  v_mfma_f32_16x16x32_bf16 v[36:39], v[224:227], a[20:23], v[36:39]
  v_mfma_f32_16x16x32_bf16 v[48:51], v[228:231], a[16:19], v[48:51]
  ds_write_b128 v8, v[136:139] offset:4096
  v_mfma_f32_16x16x32_bf16 v[52:55], v[228:231], a[20:23], v[52:55]
  v_mfma_f32_16x16x32_bf16 v[64:67], v[232:235], a[16:19], v[64:67]
  ds_write_b128 v8, v[140:143] offset:5120
  v_mfma_f32_16x16x32_bf16 v[68:71], v[232:235], a[20:23], v[68:71]
  v_mfma_f32_16x16x32_bf16 v[80:83], v[236:239], a[16:19], v[80:83]
  ds_write_b128 v3, v[144:147] offset:6144
  v_mfma_f32_16x16x32_bf16 v[84:87], v[236:239], a[20:23], v[84:87]
  ds_write_b128 v3, v[148:151] offset:7168
  ds_write_b128 v8, v[152:155] offset:6144
  s_waitcnt lgkmcnt(14)
  ds_write_b128 v8, v[156:159] offset:7168
  s_waitcnt lgkmcnt(14)
  ds_write_b128 v4, v[40:43] offset:0
  s_waitcnt lgkmcnt(14)
  ds_write_b128 v4, v[44:47] offset:1024
  s_waitcnt lgkmcnt(14)
  ds_write_b128 v4, v[56:59] offset:2048
  s_waitcnt lgkmcnt(14)
  ds_write_b128 v4, v[60:63] offset:3072
  s_waitcnt lgkmcnt(14)
  ds_write_b128 v4, v[72:75] offset:4096
  s_waitcnt lgkmcnt(14)
  ds_write_b128 v4, v[76:79] offset:5120
  s_waitcnt lgkmcnt(14)
  ds_write_b128 v4, v[88:91] offset:6144
  s_waitcnt lgkmcnt(14)
  ds_write_b128 v4, v[92:95] offset:7168
  s_mov_b32 s62, 20480
  buffer_load_dwordx4 a[240:243], v9, s[20:23], s62 offen sc1
  s_waitcnt vmcnt(9)
  s_waitcnt lgkmcnt(14)
  ds_read_b64_tr_b16 a[112:113], v27 offset:0
  s_waitcnt lgkmcnt(14)
  ds_read_b64_tr_b16 a[114:115], v27 offset:1024
  s_waitcnt lgkmcnt(14)
  ds_read_b64_tr_b16 a[116:117], v28 offset:0
  s_waitcnt lgkmcnt(14)
  ds_read_b64_tr_b16 a[118:119], v28 offset:1024
  s_waitcnt lgkmcnt(14)
  ds_read_b64_tr_b16 a[120:121], v29 offset:0
  s_waitcnt lgkmcnt(14)
  ds_read_b64_tr_b16 a[122:123], v29 offset:1024
  s_waitcnt lgkmcnt(14)
  ds_read_b64_tr_b16 a[124:125], v30 offset:0
  s_waitcnt lgkmcnt(14)
  ds_read_b64_tr_b16 a[126:127], v30 offset:1024
  s_waitcnt vmcnt(5)
  s_waitcnt lgkmcnt(14)
  ds_read_b64_tr_b16 a[128:129], v27 offset:4096
  s_waitcnt lgkmcnt(14)
  ds_read_b64_tr_b16 a[130:131], v27 offset:5120
  s_waitcnt lgkmcnt(14)
  ds_read_b64_tr_b16 a[132:133], v28 offset:4096
  s_waitcnt lgkmcnt(14)
  ds_read_b64_tr_b16 a[134:135], v28 offset:5120
  s_waitcnt lgkmcnt(14)
  ds_read_b64_tr_b16 a[136:137], v29 offset:4096
  s_waitcnt lgkmcnt(14)
  ds_read_b64_tr_b16 a[138:139], v29 offset:5120
  s_waitcnt lgkmcnt(14)
  ds_read_b64_tr_b16 a[140:141], v30 offset:4096
  s_waitcnt lgkmcnt(14)
  ds_read_b64_tr_b16 a[142:143], v30 offset:5120
  s_waitcnt vmcnt(1)
  s_waitcnt lgkmcnt(14)
  ds_read_b64_tr_b16 a[144:145], v27 offset:8192
  s_waitcnt lgkmcnt(14)
  ds_read_b64_tr_b16 a[146:147], v27 offset:9216
  s_waitcnt lgkmcnt(14)
  ds_read_b64_tr_b16 a[148:149], v28 offset:8192
  s_waitcnt lgkmcnt(14)
  ds_read_b64_tr_b16 a[150:151], v28 offset:9216
  s_waitcnt lgkmcnt(14)
  ds_read_b64_tr_b16 a[152:153], v29 offset:8192
  s_waitcnt lgkmcnt(14)
  ds_read_b64_tr_b16 a[154:155], v29 offset:9216
  s_waitcnt lgkmcnt(14)
  ds_read_b64_tr_b16 a[156:157], v30 offset:8192
  s_waitcnt lgkmcnt(14)
  ds_read_b64_tr_b16 a[158:159], v30 offset:9216
  s_waitcnt lgkmcnt(8)
  s_waitcnt lgkmcnt(0)
  s_lshl_b32 s60, s53, 2
  s_add_u32 s89, s101, 344064
  s_add_u32 m0, s88, 0
  s_lshl_b32 s61, s56, 1
  buffer_load_dwordx4 v16, s[24:27], s89 offen lds
  s_add_u32 s60, s60, s61
  s_mul_i32 s60, s60, 28
  s_lshl_b32 s61, s54, 2
  s_add_u32 s60, s60, s61
  s_lshl_b32 s61, s57, 1
  s_add_u32 s60, s60, s61
  s_lshl_b32 s60, s60, 10
  s_add_u32 s98, s60, 13631488
  s_add_u32 s99, s98, 28672
  s_barrier
  s_add_u32 s89, s101, 358400
  s_add_u32 m0, s88, 1024
  ds_read_b128 v[160:163], v10 offset:0
  buffer_load_dwordx4 v16, s[24:27], s89 offen lds
  ds_read_b128 v[164:167], v10 offset:1024
  ds_read_b128 v[168:171], v10 offset:2048
  ds_read_b128 v[172:175], v10 offset:3072
  ds_read_b128 v[176:179], v10 offset:4096
  s_add_u32 s89, s101, 351232
  s_add_u32 m0, s88, 2048
  ds_read_b128 v[180:183], v10 offset:5120
  buffer_load_dwordx4 v16, s[24:27], s89 offen lds
  ds_read_b128 v[184:187], v10 offset:6144
  ds_read_b128 v[188:191], v10 offset:7168
  ds_read_b128 v[224:227], v10 offset:8192
  ds_read_b128 v[228:231], v10 offset:9216
  s_add_u32 s89, s101, 365568
  s_add_u32 m0, s88, 3072
  ds_read_b128 v[232:235], v10 offset:10240
  buffer_load_dwordx4 v16, s[24:27], s89 offen lds
  ds_read_b128 v[236:239], v10 offset:11264
  ds_read_b128 v[240:243], v10 offset:12288
  ds_read_b128 v[244:247], v10 offset:13312
  ds_read_b128 v[248:251], v10 offset:14336
  s_add_u32 s89, s100, 0
  s_add_u32 m0, s88, 4096
  s_waitcnt lgkmcnt(14)
  ds_read_b128 v[252:255], v10 offset:15360
  buffer_load_dwordx4 v16, s[28:31], s89 offen lds
  v_pk_add_f32 v[32:33], v[32:33], v[160:161]
  v_pk_add_f32 v[34:35], v[34:35], v[162:163]
  s_waitcnt lgkmcnt(14)
  v_pk_add_f32 v[36:37], v[36:37], v[164:165]
  v_pk_add_f32 v[38:39], v[38:39], v[166:167]
  s_waitcnt lgkmcnt(13)
  v_pk_add_f32 v[48:49], v[48:49], v[168:169]
  v_pk_add_f32 v[50:51], v[50:51], v[170:171]
  s_waitcnt lgkmcnt(12)
  v_pk_add_f32 v[52:53], v[52:53], v[172:173]
  v_pk_add_f32 v[54:55], v[54:55], v[174:175]
  s_waitcnt lgkmcnt(11)
  v_pk_add_f32 v[64:65], v[64:65], v[176:177]
  v_pk_add_f32 v[66:67], v[66:67], v[178:179]
  s_add_u32 s89, s100, 14336
  s_add_u32 m0, s88, 5120
  s_waitcnt lgkmcnt(10)
  v_pk_add_f32 v[68:69], v[68:69], v[180:181]
  buffer_load_dwordx4 v16, s[28:31], s89 offen lds
  v_pk_add_f32 v[70:71], v[70:71], v[182:183]
  s_waitcnt lgkmcnt(9)
  v_pk_add_f32 v[80:81], v[80:81], v[184:185]
  v_pk_add_f32 v[82:83], v[82:83], v[186:187]
  s_waitcnt lgkmcnt(8)
  v_pk_add_f32 v[84:85], v[84:85], v[188:189]
  v_pk_add_f32 v[86:87], v[86:87], v[190:191]
  ds_read_b128 v[160:163], v10 offset:16384
  ds_read_b128 v[164:167], v10 offset:17408
  s_add_u32 s89, s100, 7168
  s_add_u32 m0, s88, 6144
  ds_read_b128 v[168:171], v10 offset:18432
  buffer_load_dwordx4 v16, s[28:31], s89 offen lds
  ds_read_b128 v[172:175], v10 offset:19456
  ds_read_b128 v[176:179], v10 offset:20480
  ds_read_b128 v[180:183], v10 offset:21504
  ds_read_b128 v[184:187], v10 offset:22528
  s_add_u32 s89, s100, 21504
  s_add_u32 m0, s88, 7168
  s_waitcnt lgkmcnt(14)
  ds_read_b128 v[188:191], v10 offset:23552
  buffer_load_dwordx4 v16, s[28:31], s89 offen lds
  v_pk_add_f32 v[32:33], v[32:33], v[224:225]
  v_pk_add_f32 v[34:35], v[34:35], v[226:227]
  s_waitcnt lgkmcnt(14)
  v_pk_add_f32 v[36:37], v[36:37], v[228:229]
  v_pk_add_f32 v[38:39], v[38:39], v[230:231]
  s_waitcnt lgkmcnt(13)
  v_pk_add_f32 v[48:49], v[48:49], v[232:233]
  v_pk_add_f32 v[50:51], v[50:51], v[234:235]
  s_waitcnt lgkmcnt(12)
  v_pk_add_f32 v[52:53], v[52:53], v[236:237]
  v_pk_add_f32 v[54:55], v[54:55], v[238:239]
  s_waitcnt lgkmcnt(11)
  v_pk_add_f32 v[64:65], v[64:65], v[240:241]
  v_pk_add_f32 v[66:67], v[66:67], v[242:243]
  s_add_u32 s89, s100, 28672
  s_add_u32 m0, s88, 8192
  s_waitcnt lgkmcnt(10)
  v_pk_add_f32 v[68:69], v[68:69], v[244:245]
  buffer_load_dwordx4 v16, s[28:31], s89 offen lds
  v_pk_add_f32 v[70:71], v[70:71], v[246:247]
  s_waitcnt lgkmcnt(9)
  v_pk_add_f32 v[80:81], v[80:81], v[248:249]
  v_pk_add_f32 v[82:83], v[82:83], v[250:251]
  s_waitcnt lgkmcnt(8)
  v_pk_add_f32 v[84:85], v[84:85], v[252:253]
  v_pk_add_f32 v[86:87], v[86:87], v[254:255]
  s_waitcnt lgkmcnt(7)
  v_pk_add_f32 v[32:33], v[32:33], v[160:161]
  v_pk_add_f32 v[34:35], v[34:35], v[162:163]
  s_waitcnt lgkmcnt(6)
  v_pk_add_f32 v[36:37], v[36:37], v[164:165]
  v_pk_add_f32 v[38:39], v[38:39], v[166:167]
  s_waitcnt lgkmcnt(5)
  v_pk_add_f32 v[48:49], v[48:49], v[168:169]
  s_add_u32 s89, s100, 43008
  s_add_u32 m0, s88, 9216
  v_pk_add_f32 v[50:51], v[50:51], v[170:171]
  buffer_load_dwordx4 v16, s[28:31], s89 offen lds
  s_waitcnt lgkmcnt(4)
  v_pk_add_f32 v[52:53], v[52:53], v[172:173]
  v_pk_add_f32 v[54:55], v[54:55], v[174:175]
  s_waitcnt lgkmcnt(3)
  v_pk_add_f32 v[64:65], v[64:65], v[176:177]
  v_pk_add_f32 v[66:67], v[66:67], v[178:179]
  s_waitcnt lgkmcnt(2)
  v_pk_add_f32 v[68:69], v[68:69], v[180:181]
  v_pk_add_f32 v[70:71], v[70:71], v[182:183]
  s_waitcnt lgkmcnt(1)
  v_pk_add_f32 v[80:81], v[80:81], v[184:185]
  v_pk_add_f32 v[82:83], v[82:83], v[186:187]
  s_waitcnt lgkmcnt(0)
  v_pk_add_f32 v[84:85], v[84:85], v[188:189]
  v_pk_add_f32 v[86:87], v[86:87], v[190:191]
  s_add_u32 s89, s100, 35840
  s_add_u32 m0, s88, 10240
  s_mul_i32 s87, s52, 24576
  buffer_load_dwordx4 v16, s[28:31], s89 offen lds
  v_add_u32 v17, s87, v17
  v_add_u32 v18, s87, v18
  v_add_u32 v19, s87, v19
  v_add_u32 v26, s87, v26
  v_pk_mul_f32 v[32:33], v[32:33], v[192:193]
  v_pk_mul_f32 v[34:35], v[34:35], v[194:195]
  v_pk_mul_f32 v[36:37], v[36:37], v[208:209]
  v_pk_mul_f32 v[38:39], v[38:39], v[210:211]
  v_pk_mul_f32 v[48:49], v[48:49], v[196:197]
  v_pk_mul_f32 v[50:51], v[50:51], v[198:199]
  s_add_u32 s89, s100, 50176
  s_add_u32 m0, s88, 11264
  v_pk_mul_f32 v[52:53], v[52:53], v[212:213]
  buffer_load_dwordx4 v16, s[28:31], s89 offen lds
  v_pk_mul_f32 v[54:55], v[54:55], v[214:215]
  v_pk_mul_f32 v[64:65], v[64:65], v[200:201]
  v_pk_mul_f32 v[66:67], v[66:67], v[202:203]
  v_pk_mul_f32 v[68:69], v[68:69], v[216:217]
  v_pk_mul_f32 v[70:71], v[70:71], v[218:219]
  v_pk_mul_f32 v[80:81], v[80:81], v[204:205]
  v_pk_mul_f32 v[82:83], v[82:83], v[206:207]
  v_pk_mul_f32 v[84:85], v[84:85], v[220:221]
  v_pk_mul_f32 v[86:87], v[86:87], v[222:223]
  v_cvt_pk_bf16_f32 v224, v32, v33
  s_add_u32 s89, s100, 57344
  s_add_u32 m0, s87, 0
  v_cvt_pk_bf16_f32 v225, v34, v35
  buffer_load_dwordx4 v16, s[28:31], s89 offen lds
  v_cvt_pk_bf16_f32 v232, v36, v37
  v_cvt_pk_bf16_f32 v233, v38, v39
  v_cvt_pk_bf16_f32 v226, v48, v49
  v_cvt_pk_bf16_f32 v227, v50, v51
  v_cvt_pk_bf16_f32 v234, v52, v53
  v_cvt_pk_bf16_f32 v235, v54, v55
  v_cvt_pk_bf16_f32 v228, v64, v65
  v_cvt_pk_bf16_f32 v229, v66, v67
  v_cvt_pk_bf16_f32 v236, v68, v69
  v_cvt_pk_bf16_f32 v237, v70, v71
  s_add_u32 s89, s100, 71680
  s_add_u32 m0, s87, 1024
  v_cvt_pk_bf16_f32 v230, v80, v81
  buffer_load_dwordx4 v16, s[28:31], s89 offen lds
  v_cvt_pk_bf16_f32 v231, v82, v83
  v_cvt_pk_bf16_f32 v238, v84, v85
  v_cvt_pk_bf16_f32 v239, v86, v87
  buffer_store_dwordx4 v[224:227], v9, s[20:23], s98 offen offset:0 sc1
  buffer_store_dwordx4 v[228:231], v9, s[20:23], s98 offen offset:1024 sc1
  buffer_store_dwordx4 v[232:235], v9, s[20:23], s99 offen offset:0 sc1
  buffer_store_dwordx4 v[236:239], v9, s[20:23], s99 offen offset:1024 sc1
  v_lshrrev_b32 v3, 4, v2
  v_and_b32 v4, 15, v2
  s_add_u32 s89, s100, 64512
  s_add_u32 m0, s87, 2048
  s_nop 0
  buffer_load_dwordx4 v16, s[28:31], s89 offen lds
  s_add_u32 s89, s100, 78848
  s_add_u32 m0, s87, 3072
  s_nop 0
  buffer_load_dwordx4 v16, s[28:31], s89 offen lds
  s_add_u32 s89, s100, 86016
  s_add_u32 m0, s87, 4096
  s_nop 0
  buffer_load_dwordx4 v16, s[28:31], s89 offen lds
  s_add_u32 s89, s100, 100352
  s_add_u32 m0, s87, 5120
  s_nop 0
  buffer_load_dwordx4 v16, s[28:31], s89 offen lds
  s_add_u32 s89, s100, 93184
  s_add_u32 m0, s87, 6144
  s_nop 0
  buffer_load_dwordx4 v16, s[28:31], s89 offen lds
  s_add_u32 s89, s100, 107520
  s_add_u32 m0, s87, 7168
  s_nop 0
  buffer_load_dwordx4 v16, s[28:31], s89 offen lds
  s_add_u32 s89, s100, 114688
  s_add_u32 m0, s87, 8192
  s_nop 0
  buffer_load_dwordx4 v16, s[28:31], s89 offen lds
  s_add_u32 s89, s100, 129024
  s_add_u32 m0, s87, 9216
  s_nop 0
  buffer_load_dwordx4 v16, s[28:31], s89 offen lds
  s_add_u32 s89, s100, 121856
  s_add_u32 m0, s87, 10240
  s_nop 0
  buffer_load_dwordx4 v16, s[28:31], s89 offen lds
  s_add_u32 s89, s100, 136192
  s_add_u32 m0, s87, 11264
  s_nop 0
  buffer_load_dwordx4 v16, s[28:31], s89 offen lds
  s_add_u32 s89, s100, 143360
  s_add_u32 m0, s87, 12288
  s_nop 0
  buffer_load_dwordx4 v16, s[28:31], s89 offen lds
  s_add_u32 s89, s100, 157696
  s_add_u32 m0, s87, 13312
  s_nop 0
  buffer_load_dwordx4 v16, s[28:31], s89 offen lds
  s_xor_b32 s60, s52, 0
  s_mul_i32 s61, s60, 28672
  v_add_u32 v208, s61, v9
  s_mul_i32 s61, s60, 14336
  v_add_u32 v212, s61, v9
  s_xor_b32 s60, s52, 1
  s_mul_i32 s61, s60, 28672
  v_add_u32 v209, s61, v9
  s_mul_i32 s61, s60, 14336
  v_add_u32 v213, s61, v9
  s_xor_b32 s60, s52, 2
  s_mul_i32 s61, s60, 28672
  v_add_u32 v210, s61, v9
  s_add_u32 s89, s100, 150528
  s_add_u32 m0, s87, 14336
  s_mul_i32 s61, s60, 14336
  buffer_load_dwordx4 v16, s[28:31], s89 offen lds
  v_add_u32 v214, s61, v9
  s_xor_b32 s60, s52, 3
  s_mul_i32 s61, s60, 28672
  v_add_u32 v211, s61, v9
  s_mul_i32 s61, s60, 14336
  v_add_u32 v215, s61, v9
  s_mul_i32 s60, s53, 114688
  s_mul_i32 s61, s52, 7168
  s_add_u32 s60, s60, s61
  s_add_u32 s94, s60, 13631488
  s_add_u32 s95, s94, 4096
  s_lshl_b32 s60, s53, 7
  s_add_u32 s98, s60, 16384
  s_add_u32 s97, s60, 12288
  s_add_u32 s89, s100, 164864
  s_add_u32 m0, s87, 15360
  s_lshl_b32 s61, s54, 4
  buffer_load_dwordx4 v16, s[28:31], s89 offen lds
  s_add_u32 s96, s98, s61
  s_lshl_b32 s61, s52, 2
  s_add_u32 s96, s96, s61
  v_min_u32 v216, 27, v2
  v_lshlrev_b32 v216, 2, v216
  v_and_b32 v217, 3, v2
  v_lshlrev_b32 v217, 2, v217
  s_mul_i32 s60, s53, 57344
  s_add_u32 s60, s60, s58
  s_add_u32 s90, s60, 11534336
  s_add_u32 s91, s90, 4096
  s_add_u32 s92, s90, 8192
  s_add_u32 s93, s90, 12288
  s_add_u32 s89, s100, 172032
  s_add_u32 m0, s87, 16384
  s_cmp_ge_u32 s52, 2
  s_cselect_b32 s93, 0x7ffff000, s93
  v_mov_b32 v220, v20
  v_mov_b32 v221, v20
  v_mov_b32 v222, v21
  buffer_load_dwordx4 v16, s[28:31], s89 offen lds
  v_mov_b32 v223, v21
  v_mov_b32 v224, v22
  v_mov_b32 v225, v22
  v_mov_b32 v226, v23
  v_mov_b32 v227, v23
  s_xor_b32 s60, s52, 1
  s_mul_i32 s60, s60, 12288
  s_add_u32 s60, s60, 0
  v_add_u32 v219, s60, v9
  s_xor_b32 s60, s52, 2
  s_mul_i32 s60, s60, 12288
  s_add_u32 s60, s60, 4096
  s_add_u32 s89, s100, 186368
  s_add_u32 m0, s87, 17408
  v_add_u32 v228, s60, v9
  buffer_load_dwordx4 v16, s[28:31], s89 offen lds
  s_xor_b32 s60, s52, 3
  s_mul_i32 s60, s60, 12288
  s_add_u32 s60, s60, 8192
  v_add_u32 v229, s60, v9
  s_mul_i32 s60, s52, 12288
  v_add_u32 v230, s60, v9
  s_lshl_b32 s60, s53, 6
  s_lshl_b32 s61, s56, 5
  s_add_u32 s60, s60, s61
  s_lshl_b32 s61, s57, 2
  s_add_u32 s60, s60, s61
  s_mul_i32 s60, s60, 896
  s_lshl_b32 s61, s54, 7
  s_add_u32 s99, s60, s61
  s_add_u32 s89, s100, 179200
  s_add_u32 m0, s87, 18432
  v_and_b32 v5, 7, v4
  buffer_load_dwordx4 v16, s[28:31], s89 offen lds
  v_lshrrev_b32 v6, 2, v5
  v_and_b32 v5, 3, v5
  v_lshl_add_u32 v5, v6, 3, v5
  v_mul_u32_u24 v5, 896, v5
  v_lshl_add_u32 v5, v3, 4, v5
  v_lshrrev_b32 v6, 3, v4
  v_lshl_add_u32 v231, v6, 6, v5
  v_xor_b32 v6, 1, v6
  v_lshl_add_u32 v232, v6, 6, v5
  v_add_u32 v232, 14336, v232
  s_add_u32 s89, s100, 193536
  s_add_u32 m0, s87, 19456
  s_nop 0
  buffer_load_dwordx4 v16, s[28:31], s89 offen lds
  s_waitcnt vmcnt(36)
  v_accvgpr_read_b32 v236, a240
  v_accvgpr_read_b32 v237, a241
  v_accvgpr_read_b32 v238, a242
  v_accvgpr_read_b32 v239, a243
  s_or_b32 s60, s2, s52
  s_cmp_lg_u32 s60, 0
  s_cbranch_scc1 L_noep
  s_mov_b32 s63, 0
  s_mov_b32 s62, 20480
  s_branch L_cnt_chk
L_cnt:
  buffer_load_dwordx4 v[236:239], v9, s[20:23], s62 offen sc1
  s_waitcnt vmcnt(0)
L_cnt_chk:
  v_min3_u32 v5, v236, v237, v238
  v_max3_u32 v6, v236, v237, v238
  v_min_u32 v5, v5, v239
  v_max_u32 v6, v6, v239
  v_xor_b32 v5, s55, v5
  v_xor_b32 v6, s55, v6
  v_or_b32 v5, v5, v6
  v_cmp_ne_u32 vcc, 0, v5
  s_nop 3
  s_cmp_eq_u64 vcc, 0
  s_cbranch_scc1 L_cnt_ok
  s_add_u32 s63, s63, 1
  s_cmp_lt_u32 s63, 20000
  s_cbranch_scc1 L_cnt
L_cnt_ok:
  s_mov_b32 s61, 3
  s_branch L_ep_done
L_noep:
  s_mov_b32 s61, 1
L_ep_done:
  v_mov_b32 v5, s96
  v_cmp_eq_u32 vcc, 1, v2
  s_nop 1
  v_cndmask_b32_e64 v5, v5, 0, vcc
  s_waitcnt vmcnt(18)
  s_mov_b32 exec_hi, 0
  s_mov_b32 exec_lo, s61
  buffer_store_dword v14, v5, s[20:23], 0 offen sc1
  s_mov_b64 exec, -1
  buffer_load_dword v218, v217, s[20:23], s97 offen sc1
  ds_read_b64_tr_b16 a[160:161], v27 offset:0
  ds_read_b64_tr_b16 a[162:163], v27 offset:1024
  ds_read_b64_tr_b16 a[164:165], v28 offset:0
  ds_read_b64_tr_b16 a[166:167], v28 offset:1024
  ds_read_b64_tr_b16 a[168:169], v29 offset:0
  ds_read_b64_tr_b16 a[170:171], v29 offset:1024
  ds_read_b64_tr_b16 a[172:173], v30 offset:0
  ds_read_b64_tr_b16 a[174:175], v30 offset:1024
  ds_read_b64_tr_b16 a[0:1], v27 offset:4096
  ds_read_b64_tr_b16 a[2:3], v27 offset:5120
  ds_read_b64_tr_b16 a[4:5], v28 offset:4096
  ds_read_b64_tr_b16 a[6:7], v28 offset:5120
  ds_read_b64_tr_b16 a[8:9], v29 offset:4096
  ds_read_b64_tr_b16 a[10:11], v29 offset:5120
  ds_read_b64_tr_b16 a[12:13], v30 offset:4096
  s_waitcnt lgkmcnt(14)
  ds_read_b64_tr_b16 a[14:15], v30 offset:5120
  s_waitcnt lgkmcnt(14)
  ds_read_b64_tr_b16 a[16:17], v27 offset:8192
  s_waitcnt lgkmcnt(14)
  ds_read_b64_tr_b16 a[18:19], v27 offset:9216
  s_waitcnt lgkmcnt(14)
  ds_read_b64_tr_b16 a[20:21], v28 offset:8192
  s_waitcnt lgkmcnt(14)
  ds_read_b64_tr_b16 a[22:23], v28 offset:9216
  s_waitcnt lgkmcnt(14)
  ds_read_b64_tr_b16 a[24:25], v29 offset:8192
  s_waitcnt lgkmcnt(14)
  ds_read_b64_tr_b16 a[26:27], v29 offset:9216
  s_waitcnt lgkmcnt(14)
  ds_read_b64_tr_b16 a[28:29], v30 offset:8192
  s_waitcnt lgkmcnt(14)
  ds_read_b64_tr_b16 a[30:31], v30 offset:9216
  s_waitcnt vmcnt(18)
  s_waitcnt lgkmcnt(14)
  ds_read_b64_tr_b16 a[32:33], v17 offset:0
  s_waitcnt lgkmcnt(14)
  ds_read_b64_tr_b16 a[34:35], v17 offset:1024
  s_waitcnt lgkmcnt(14)
  ds_read_b64_tr_b16 a[36:37], v18 offset:0
  s_waitcnt lgkmcnt(14)
  ds_read_b64_tr_b16 a[38:39], v18 offset:1024
  s_waitcnt lgkmcnt(14)
  ds_read_b64_tr_b16 a[40:41], v19 offset:0
  s_waitcnt lgkmcnt(14)
  ds_read_b64_tr_b16 a[42:43], v19 offset:1024
  s_waitcnt lgkmcnt(14)
  ds_read_b64_tr_b16 a[44:45], v26 offset:0
  s_waitcnt lgkmcnt(14)
  ds_read_b64_tr_b16 a[46:47], v26 offset:1024
  s_waitcnt vmcnt(14)
  s_waitcnt lgkmcnt(14)
  ds_read_b64_tr_b16 a[48:49], v17 offset:4096
  s_waitcnt lgkmcnt(14)
  ds_read_b64_tr_b16 a[50:51], v17 offset:5120
  s_waitcnt lgkmcnt(14)
  ds_read_b64_tr_b16 a[52:53], v18 offset:4096
  s_waitcnt lgkmcnt(14)
  ds_read_b64_tr_b16 a[54:55], v18 offset:5120
  s_waitcnt lgkmcnt(14)
  ds_read_b64_tr_b16 a[56:57], v19 offset:4096
  s_waitcnt lgkmcnt(14)
  ds_read_b64_tr_b16 a[58:59], v19 offset:5120
  s_waitcnt lgkmcnt(14)
  ds_read_b64_tr_b16 a[60:61], v26 offset:4096
  s_waitcnt lgkmcnt(14)
  ds_read_b64_tr_b16 a[62:63], v26 offset:5120
  s_waitcnt vmcnt(10)
  s_waitcnt lgkmcnt(14)
  ds_read_b64_tr_b16 a[64:65], v17 offset:8192
  s_waitcnt lgkmcnt(14)
  ds_read_b64_tr_b16 a[66:67], v17 offset:9216
  s_waitcnt lgkmcnt(14)
  ds_read_b64_tr_b16 a[68:69], v18 offset:8192
  s_waitcnt lgkmcnt(14)
  ds_read_b64_tr_b16 a[70:71], v18 offset:9216
  s_waitcnt lgkmcnt(14)
  ds_read_b64_tr_b16 a[72:73], v19 offset:8192
  s_waitcnt lgkmcnt(14)
  ds_read_b64_tr_b16 a[74:75], v19 offset:9216
  s_waitcnt lgkmcnt(14)
  ds_read_b64_tr_b16 a[76:77], v26 offset:8192
  s_waitcnt lgkmcnt(14)
  ds_read_b64_tr_b16 a[78:79], v26 offset:9216
  s_waitcnt vmcnt(6)
  s_waitcnt lgkmcnt(14)
  ds_read_b64_tr_b16 a[80:81], v17 offset:12288
  s_waitcnt lgkmcnt(14)
  ds_read_b64_tr_b16 a[82:83], v17 offset:13312
  s_waitcnt lgkmcnt(14)
  ds_read_b64_tr_b16 a[84:85], v18 offset:12288
  s_waitcnt lgkmcnt(14)
  ds_read_b64_tr_b16 a[86:87], v18 offset:13312
  s_waitcnt lgkmcnt(14)
  ds_read_b64_tr_b16 a[88:89], v19 offset:12288
  s_waitcnt lgkmcnt(14)
  ds_read_b64_tr_b16 a[90:91], v19 offset:13312
  s_waitcnt lgkmcnt(14)
  ds_read_b64_tr_b16 a[92:93], v26 offset:12288
  s_waitcnt lgkmcnt(14)
  ds_read_b64_tr_b16 a[94:95], v26 offset:13312
  s_waitcnt vmcnt(2)
  s_waitcnt lgkmcnt(14)
  ds_read_b64_tr_b16 a[96:97], v17 offset:16384
  s_waitcnt lgkmcnt(14)
  ds_read_b64_tr_b16 a[98:99], v17 offset:17408
  s_waitcnt lgkmcnt(14)
  ds_read_b64_tr_b16 a[100:101], v18 offset:16384
  s_waitcnt lgkmcnt(14)
  ds_read_b64_tr_b16 a[102:103], v18 offset:17408
  s_waitcnt lgkmcnt(14)
  ds_read_b64_tr_b16 a[104:105], v19 offset:16384
  s_waitcnt lgkmcnt(14)
  ds_read_b64_tr_b16 a[106:107], v19 offset:17408
  s_waitcnt lgkmcnt(14)
  ds_read_b64_tr_b16 a[108:109], v26 offset:16384
  s_waitcnt lgkmcnt(14)
  ds_read_b64_tr_b16 a[110:111], v26 offset:17408
  s_mov_b32 s63, 0
  s_branch L_fo_chk
L_poll_fo:
  buffer_load_dword v218, v217, s[20:23], s97 offen sc1
  s_waitcnt vmcnt(0)
L_fo_chk:
  s_waitcnt vmcnt(0)
  v_cmp_ne_u32 vcc, s55, v218
  s_nop 3
  s_cmp_eq_u64 vcc, 0
  s_cbranch_scc1 L_ok_fo
  s_add_u32 s63, s63, 1
  s_cmp_lt_u32 s63, 20000
  s_cbranch_scc1 L_poll_fo
L_ok_fo:
  buffer_load_dwordx4 a[176:179], v212, s[20:23], s90 offen sc1
  buffer_load_dwordx4 a[180:183], v213, s[20:23], s90 offen sc1
  buffer_load_dwordx4 a[184:187], v214, s[20:23], s90 offen sc1
  buffer_load_dwordx4 a[188:191], v215, s[20:23], s90 offen sc1
  buffer_load_dwordx4 a[192:195], v212, s[20:23], s91 offen sc1
  buffer_load_dwordx4 a[196:199], v213, s[20:23], s91 offen sc1
  buffer_load_dwordx4 a[200:203], v214, s[20:23], s91 offen sc1
  buffer_load_dwordx4 a[204:207], v215, s[20:23], s91 offen sc1
  buffer_load_dwordx4 a[208:211], v212, s[20:23], s92 offen sc1
  buffer_load_dwordx4 a[212:215], v213, s[20:23], s92 offen sc1
  buffer_load_dwordx4 a[216:219], v214, s[20:23], s92 offen sc1
  buffer_load_dwordx4 a[220:223], v215, s[20:23], s92 offen sc1
  buffer_load_dwordx4 a[224:227], v212, s[20:23], s93 offen sc1
  buffer_load_dwordx4 a[228:231], v213, s[20:23], s93 offen sc1
  buffer_load_dwordx4 a[232:235], v214, s[20:23], s93 offen sc1
  buffer_load_dwordx4 a[236:239], v215, s[20:23], s93 offen sc1
  buffer_load_dword v218, v216, s[20:23], s98 offen sc1
  s_waitcnt vmcnt(15)
  v_mfma_f32_16x16x32_bf16 v[36:39], a[112:115], a[180:183], 0
  v_mfma_f32_16x16x32_bf16 v[52:55], a[116:119], a[180:183], 0
  v_mfma_f32_16x16x32_bf16 v[68:71], a[120:123], a[180:183], 0
  v_mfma_f32_16x16x32_bf16 v[84:87], a[124:127], a[180:183], 0
  s_waitcnt vmcnt(14)
  v_mfma_f32_16x16x32_bf16 v[40:43], a[112:115], a[184:187], 0
  v_mfma_f32_16x16x32_bf16 v[56:59], a[116:119], a[184:187], 0
  v_mfma_f32_16x16x32_bf16 v[72:75], a[120:123], a[184:187], 0
  v_mfma_f32_16x16x32_bf16 v[88:91], a[124:127], a[184:187], 0
  s_waitcnt vmcnt(13)
  v_mfma_f32_16x16x32_bf16 v[44:47], a[112:115], a[188:191], 0
  v_mfma_f32_16x16x32_bf16 v[60:63], a[116:119], a[188:191], 0
  v_mfma_f32_16x16x32_bf16 v[76:79], a[120:123], a[188:191], 0
  v_mfma_f32_16x16x32_bf16 v[92:95], a[124:127], a[188:191], 0
  v_mfma_f32_16x16x32_bf16 v[32:35], a[112:115], a[176:179], 0
  v_mfma_f32_16x16x32_bf16 v[48:51], a[116:119], a[176:179], 0
  v_mfma_f32_16x16x32_bf16 v[64:67], a[120:123], a[176:179], 0
  v_mfma_f32_16x16x32_bf16 v[80:83], a[124:127], a[176:179], 0
  s_waitcnt vmcnt(11)
  v_mfma_f32_16x16x32_bf16 v[36:39], a[128:131], a[196:199], v[36:39]
  v_mfma_f32_16x16x32_bf16 v[52:55], a[132:135], a[196:199], v[52:55]
  v_mfma_f32_16x16x32_bf16 v[68:71], a[136:139], a[196:199], v[68:71]
  v_mfma_f32_16x16x32_bf16 v[84:87], a[140:143], a[196:199], v[84:87]
  s_waitcnt vmcnt(10)
  v_mfma_f32_16x16x32_bf16 v[40:43], a[128:131], a[200:203], v[40:43]
  v_mfma_f32_16x16x32_bf16 v[56:59], a[132:135], a[200:203], v[56:59]
  v_mfma_f32_16x16x32_bf16 v[72:75], a[136:139], a[200:203], v[72:75]
  v_mfma_f32_16x16x32_bf16 v[88:91], a[140:143], a[200:203], v[88:91]
  s_waitcnt vmcnt(9)
  v_mfma_f32_16x16x32_bf16 v[44:47], a[128:131], a[204:207], v[44:47]
  v_mfma_f32_16x16x32_bf16 v[60:63], a[132:135], a[204:207], v[60:63]
  v_mfma_f32_16x16x32_bf16 v[76:79], a[136:139], a[204:207], v[76:79]
  v_mfma_f32_16x16x32_bf16 v[92:95], a[140:143], a[204:207], v[92:95]
  v_mfma_f32_16x16x32_bf16 v[32:35], a[128:131], a[192:195], v[32:35]
  v_mfma_f32_16x16x32_bf16 v[48:51], a[132:135], a[192:195], v[48:51]
  v_mfma_f32_16x16x32_bf16 v[64:67], a[136:139], a[192:195], v[64:67]
  v_mfma_f32_16x16x32_bf16 v[80:83], a[140:143], a[192:195], v[80:83]
  s_waitcnt vmcnt(7)
  v_mfma_f32_16x16x32_bf16 v[36:39], a[144:147], a[212:215], v[36:39]
  v_mfma_f32_16x16x32_bf16 v[52:55], a[148:151], a[212:215], v[52:55]
  v_mfma_f32_16x16x32_bf16 v[68:71], a[152:155], a[212:215], v[68:71]
  v_mfma_f32_16x16x32_bf16 v[84:87], a[156:159], a[212:215], v[84:87]
  s_waitcnt vmcnt(6)
  v_mfma_f32_16x16x32_bf16 v[40:43], a[144:147], a[216:219], v[40:43]
  v_mfma_f32_16x16x32_bf16 v[56:59], a[148:151], a[216:219], v[56:59]
  v_mfma_f32_16x16x32_bf16 v[72:75], a[152:155], a[216:219], v[72:75]
  v_mfma_f32_16x16x32_bf16 v[88:91], a[156:159], a[216:219], v[88:91]
  s_waitcnt vmcnt(5)
  v_mfma_f32_16x16x32_bf16 v[44:47], a[144:147], a[220:223], v[44:47]
  v_mfma_f32_16x16x32_bf16 v[60:63], a[148:151], a[220:223], v[60:63]
  v_mfma_f32_16x16x32_bf16 v[76:79], a[152:155], a[220:223], v[76:79]
  v_mfma_f32_16x16x32_bf16 v[92:95], a[156:159], a[220:223], v[92:95]
  v_mfma_f32_16x16x32_bf16 v[32:35], a[144:147], a[208:211], v[32:35]
  v_mfma_f32_16x16x32_bf16 v[48:51], a[148:151], a[208:211], v[48:51]
  v_mfma_f32_16x16x32_bf16 v[64:67], a[152:155], a[208:211], v[64:67]
  v_mfma_f32_16x16x32_bf16 v[80:83], a[156:159], a[208:211], v[80:83]
  s_waitcnt vmcnt(3)
  v_mfma_f32_16x16x32_bf16 v[36:39], a[160:163], a[228:231], v[36:39]
  v_mfma_f32_16x16x32_bf16 v[52:55], a[164:167], a[228:231], v[52:55]
  v_mfma_f32_16x16x32_bf16 v[68:71], a[168:171], a[228:231], v[68:71]
  v_mfma_f32_16x16x32_bf16 v[84:87], a[172:175], a[228:231], v[84:87]
  s_waitcnt vmcnt(2)
  v_mfma_f32_16x16x32_bf16 v[40:43], a[160:163], a[232:235], v[40:43]
  v_mfma_f32_16x16x32_bf16 v[56:59], a[164:167], a[232:235], v[56:59]
  v_mfma_f32_16x16x32_bf16 v[72:75], a[168:171], a[232:235], v[72:75]
  v_mfma_f32_16x16x32_bf16 v[88:91], a[172:175], a[232:235], v[88:91]
  s_waitcnt vmcnt(1)
  v_mfma_f32_16x16x32_bf16 v[44:47], a[160:163], a[236:239], v[44:47]
  v_mfma_f32_16x16x32_bf16 v[60:63], a[164:167], a[236:239], v[60:63]
  v_mfma_f32_16x16x32_bf16 v[76:79], a[168:171], a[236:239], v[76:79]
  v_mfma_f32_16x16x32_bf16 v[92:95], a[172:175], a[236:239], v[92:95]
  v_mfma_f32_16x16x32_bf16 v[32:35], a[160:163], a[224:227], v[32:35]
  v_mfma_f32_16x16x32_bf16 v[48:51], a[164:167], a[224:227], v[48:51]
  v_mfma_f32_16x16x32_bf16 v[64:67], a[168:171], a[224:227], v[64:67]
  v_mfma_f32_16x16x32_bf16 v[80:83], a[172:175], a[224:227], v[80:83]
  s_mov_b32 s63, 0
  s_branch L_fp_chk
L_poll_fp:
  buffer_load_dword v218, v216, s[20:23], s98 offen sc1
  s_waitcnt vmcnt(0)
L_fp_chk:
  s_waitcnt vmcnt(0)
  v_cmp_ne_u32 vcc, s55, v218
  s_nop 3
  s_cmp_eq_u64 vcc, 0
  s_cbranch_scc1 L_ok_fp
  s_add_u32 s63, s63, 1
  s_cmp_lt_u32 s63, 20000
  s_cbranch_scc1 L_poll_fp
L_ok_fp:
  buffer_load_dwordx4 v[96:99], v208, s[20:23], s94 offen offset:0 sc1
  buffer_load_dwordx4 v[100:103], v209, s[20:23], s94 offen offset:0 sc1
  buffer_load_dwordx4 v[104:107], v210, s[20:23], s94 offen offset:0 sc1
  buffer_load_dwordx4 v[108:111], v211, s[20:23], s94 offen offset:0 sc1
  buffer_load_dwordx4 v[112:115], v208, s[20:23], s94 offen offset:1024 sc1
  buffer_load_dwordx4 v[116:119], v209, s[20:23], s94 offen offset:1024 sc1
  buffer_load_dwordx4 v[120:123], v210, s[20:23], s94 offen offset:1024 sc1
  buffer_load_dwordx4 v[124:127], v211, s[20:23], s94 offen offset:1024 sc1
  buffer_load_dwordx4 v[128:131], v208, s[20:23], s94 offen offset:2048 sc1
  buffer_load_dwordx4 v[132:135], v209, s[20:23], s94 offen offset:2048 sc1
  buffer_load_dwordx4 v[136:139], v210, s[20:23], s94 offen offset:2048 sc1
  buffer_load_dwordx4 v[140:143], v211, s[20:23], s94 offen offset:2048 sc1
  v_pk_mul_f32 v[32:33], v[32:33], v[220:221]
  v_pk_mul_f32 v[34:35], v[34:35], v[220:221]
  v_pk_mul_f32 v[48:49], v[48:49], v[220:221]
  v_pk_mul_f32 v[50:51], v[50:51], v[220:221]
  v_pk_mul_f32 v[64:65], v[64:65], v[220:221]
  v_pk_mul_f32 v[66:67], v[66:67], v[220:221]
  v_pk_mul_f32 v[80:81], v[80:81], v[220:221]
  v_pk_mul_f32 v[82:83], v[82:83], v[220:221]
  v_pk_mul_f32 v[36:37], v[36:37], v[222:223]
  v_pk_mul_f32 v[38:39], v[38:39], v[222:223]
  v_pk_mul_f32 v[52:53], v[52:53], v[222:223]
  v_pk_mul_f32 v[54:55], v[54:55], v[222:223]
  v_pk_mul_f32 v[68:69], v[68:69], v[222:223]
  v_pk_mul_f32 v[70:71], v[70:71], v[222:223]
  v_pk_mul_f32 v[84:85], v[84:85], v[222:223]
  v_pk_mul_f32 v[86:87], v[86:87], v[222:223]
  v_pk_mul_f32 v[40:41], v[40:41], v[224:225]
  v_pk_mul_f32 v[42:43], v[42:43], v[224:225]
  v_pk_mul_f32 v[56:57], v[56:57], v[224:225]
  v_pk_mul_f32 v[58:59], v[58:59], v[224:225]
  v_pk_mul_f32 v[72:73], v[72:73], v[224:225]
  v_pk_mul_f32 v[74:75], v[74:75], v[224:225]
  v_pk_mul_f32 v[88:89], v[88:89], v[224:225]
  v_pk_mul_f32 v[90:91], v[90:91], v[224:225]
  v_pk_mul_f32 v[44:45], v[44:45], v[226:227]
  v_pk_mul_f32 v[46:47], v[46:47], v[226:227]
  v_pk_mul_f32 v[60:61], v[60:61], v[226:227]
  v_pk_mul_f32 v[62:63], v[62:63], v[226:227]
  v_pk_mul_f32 v[76:77], v[76:77], v[226:227]
  v_pk_mul_f32 v[78:79], v[78:79], v[226:227]
  v_pk_mul_f32 v[92:93], v[92:93], v[226:227]
  v_pk_mul_f32 v[94:95], v[94:95], v[226:227]
  s_waitcnt vmcnt(11)
  v_mfma_f32_16x16x32_bf16 v[32:35], a[0:3], v[96:99], v[32:35]
  v_mfma_f32_16x16x32_bf16 v[48:51], a[4:7], v[96:99], v[48:51]
  v_mfma_f32_16x16x32_bf16 v[64:67], a[8:11], v[96:99], v[64:67]
  v_mfma_f32_16x16x32_bf16 v[80:83], a[12:15], v[96:99], v[80:83]
  buffer_load_dwordx4 v[144:147], v208, s[20:23], s94 offen offset:3072 sc1
  s_waitcnt vmcnt(11)
  v_mfma_f32_16x16x32_bf16 v[36:39], a[0:3], v[100:103], v[36:39]
  v_mfma_f32_16x16x32_bf16 v[52:55], a[4:7], v[100:103], v[52:55]
  v_mfma_f32_16x16x32_bf16 v[68:71], a[8:11], v[100:103], v[68:71]
  v_mfma_f32_16x16x32_bf16 v[84:87], a[12:15], v[100:103], v[84:87]
  buffer_load_dwordx4 v[148:151], v209, s[20:23], s94 offen offset:3072 sc1
  s_waitcnt vmcnt(11)
  v_mfma_f32_16x16x32_bf16 v[40:43], a[0:3], v[104:107], v[40:43]
  v_mfma_f32_16x16x32_bf16 v[56:59], a[4:7], v[104:107], v[56:59]
  v_mfma_f32_16x16x32_bf16 v[72:75], a[8:11], v[104:107], v[72:75]
  v_mfma_f32_16x16x32_bf16 v[88:91], a[12:15], v[104:107], v[88:91]
  buffer_load_dwordx4 v[152:155], v210, s[20:23], s94 offen offset:3072 sc1
  s_waitcnt vmcnt(11)
  v_mfma_f32_16x16x32_bf16 v[44:47], a[0:3], v[108:111], v[44:47]
  v_mfma_f32_16x16x32_bf16 v[60:63], a[4:7], v[108:111], v[60:63]
  v_mfma_f32_16x16x32_bf16 v[76:79], a[8:11], v[108:111], v[76:79]
  v_mfma_f32_16x16x32_bf16 v[92:95], a[12:15], v[108:111], v[92:95]
  buffer_load_dwordx4 v[156:159], v211, s[20:23], s94 offen offset:3072 sc1
  s_waitcnt vmcnt(11)
  v_mfma_f32_16x16x32_bf16 v[32:35], a[16:19], v[112:115], v[32:35]
  v_mfma_f32_16x16x32_bf16 v[48:51], a[20:23], v[112:115], v[48:51]
  v_mfma_f32_16x16x32_bf16 v[64:67], a[24:27], v[112:115], v[64:67]
  v_mfma_f32_16x16x32_bf16 v[80:83], a[28:31], v[112:115], v[80:83]
  buffer_load_dwordx4 v[160:163], v208, s[20:23], s95 offen offset:0 sc1
  s_waitcnt vmcnt(11)
  v_mfma_f32_16x16x32_bf16 v[36:39], a[16:19], v[116:119], v[36:39]
  v_mfma_f32_16x16x32_bf16 v[52:55], a[20:23], v[116:119], v[52:55]
  v_mfma_f32_16x16x32_bf16 v[68:71], a[24:27], v[116:119], v[68:71]
  v_mfma_f32_16x16x32_bf16 v[84:87], a[28:31], v[116:119], v[84:87]
  buffer_load_dwordx4 v[164:167], v209, s[20:23], s95 offen offset:0 sc1
  s_waitcnt vmcnt(11)
  v_mfma_f32_16x16x32_bf16 v[40:43], a[16:19], v[120:123], v[40:43]
  v_mfma_f32_16x16x32_bf16 v[56:59], a[20:23], v[120:123], v[56:59]
  v_mfma_f32_16x16x32_bf16 v[72:75], a[24:27], v[120:123], v[72:75]
  v_mfma_f32_16x16x32_bf16 v[88:91], a[28:31], v[120:123], v[88:91]
  buffer_load_dwordx4 v[168:171], v210, s[20:23], s95 offen offset:0 sc1
  s_waitcnt vmcnt(11)
  v_mfma_f32_16x16x32_bf16 v[44:47], a[16:19], v[124:127], v[44:47]
  v_mfma_f32_16x16x32_bf16 v[60:63], a[20:23], v[124:127], v[60:63]
  v_mfma_f32_16x16x32_bf16 v[76:79], a[24:27], v[124:127], v[76:79]
  v_mfma_f32_16x16x32_bf16 v[92:95], a[28:31], v[124:127], v[92:95]
  buffer_load_dwordx4 v[172:175], v211, s[20:23], s95 offen offset:0 sc1
  s_waitcnt vmcnt(11)
  v_mfma_f32_16x16x32_bf16 v[32:35], a[32:35], v[128:131], v[32:35]
  v_mfma_f32_16x16x32_bf16 v[48:51], a[36:39], v[128:131], v[48:51]
  v_mfma_f32_16x16x32_bf16 v[64:67], a[40:43], v[128:131], v[64:67]
  v_mfma_f32_16x16x32_bf16 v[80:83], a[44:47], v[128:131], v[80:83]
  buffer_load_dwordx4 v[176:179], v208, s[20:23], s95 offen offset:1024 sc1
  s_waitcnt vmcnt(11)
  v_mfma_f32_16x16x32_bf16 v[36:39], a[32:35], v[132:135], v[36:39]
  v_mfma_f32_16x16x32_bf16 v[52:55], a[36:39], v[132:135], v[52:55]
  v_mfma_f32_16x16x32_bf16 v[68:71], a[40:43], v[132:135], v[68:71]
  v_mfma_f32_16x16x32_bf16 v[84:87], a[44:47], v[132:135], v[84:87]
  buffer_load_dwordx4 v[180:183], v209, s[20:23], s95 offen offset:1024 sc1
  s_waitcnt vmcnt(11)
  v_mfma_f32_16x16x32_bf16 v[40:43], a[32:35], v[136:139], v[40:43]
  v_mfma_f32_16x16x32_bf16 v[56:59], a[36:39], v[136:139], v[56:59]
  v_mfma_f32_16x16x32_bf16 v[72:75], a[40:43], v[136:139], v[72:75]
  v_mfma_f32_16x16x32_bf16 v[88:91], a[44:47], v[136:139], v[88:91]
  buffer_load_dwordx4 v[184:187], v210, s[20:23], s95 offen offset:1024 sc1
  s_waitcnt vmcnt(11)
  v_mfma_f32_16x16x32_bf16 v[44:47], a[32:35], v[140:143], v[44:47]
  v_mfma_f32_16x16x32_bf16 v[60:63], a[36:39], v[140:143], v[60:63]
  v_mfma_f32_16x16x32_bf16 v[76:79], a[40:43], v[140:143], v[76:79]
  v_mfma_f32_16x16x32_bf16 v[92:95], a[44:47], v[140:143], v[92:95]
  buffer_load_dwordx4 v[188:191], v211, s[20:23], s95 offen offset:1024 sc1
  s_waitcnt vmcnt(11)
  v_mfma_f32_16x16x32_bf16 v[32:35], a[48:51], v[144:147], v[32:35]
  v_mfma_f32_16x16x32_bf16 v[48:51], a[52:55], v[144:147], v[48:51]
  v_mfma_f32_16x16x32_bf16 v[64:67], a[56:59], v[144:147], v[64:67]
  v_mfma_f32_16x16x32_bf16 v[80:83], a[60:63], v[144:147], v[80:83]
  buffer_load_dwordx4 v[192:195], v208, s[20:23], s95 offen offset:2048 sc1
  s_waitcnt vmcnt(11)
  v_mfma_f32_16x16x32_bf16 v[36:39], a[48:51], v[148:151], v[36:39]
  v_mfma_f32_16x16x32_bf16 v[52:55], a[52:55], v[148:151], v[52:55]
  v_mfma_f32_16x16x32_bf16 v[68:71], a[56:59], v[148:151], v[68:71]
  v_mfma_f32_16x16x32_bf16 v[84:87], a[60:63], v[148:151], v[84:87]
  buffer_load_dwordx4 v[196:199], v209, s[20:23], s95 offen offset:2048 sc1
  s_waitcnt vmcnt(11)
  v_mfma_f32_16x16x32_bf16 v[40:43], a[48:51], v[152:155], v[40:43]
  v_mfma_f32_16x16x32_bf16 v[56:59], a[52:55], v[152:155], v[56:59]
  v_mfma_f32_16x16x32_bf16 v[72:75], a[56:59], v[152:155], v[72:75]
  v_mfma_f32_16x16x32_bf16 v[88:91], a[60:63], v[152:155], v[88:91]
  buffer_load_dwordx4 v[200:203], v210, s[20:23], s95 offen offset:2048 sc1
  s_waitcnt vmcnt(11)
  v_mfma_f32_16x16x32_bf16 v[44:47], a[48:51], v[156:159], v[44:47]
  v_mfma_f32_16x16x32_bf16 v[60:63], a[52:55], v[156:159], v[60:63]
  v_mfma_f32_16x16x32_bf16 v[76:79], a[56:59], v[156:159], v[76:79]
  v_mfma_f32_16x16x32_bf16 v[92:95], a[60:63], v[156:159], v[92:95]
  buffer_load_dwordx4 v[204:207], v211, s[20:23], s95 offen offset:2048 sc1
  s_waitcnt vmcnt(11)
  v_mfma_f32_16x16x32_bf16 v[32:35], a[64:67], v[160:163], v[32:35]
  v_mfma_f32_16x16x32_bf16 v[48:51], a[68:71], v[160:163], v[48:51]
  v_mfma_f32_16x16x32_bf16 v[64:67], a[72:75], v[160:163], v[64:67]
  v_mfma_f32_16x16x32_bf16 v[80:83], a[76:79], v[160:163], v[80:83]
  s_waitcnt vmcnt(10)
  v_mfma_f32_16x16x32_bf16 v[36:39], a[64:67], v[164:167], v[36:39]
  v_mfma_f32_16x16x32_bf16 v[52:55], a[68:71], v[164:167], v[52:55]
  v_mfma_f32_16x16x32_bf16 v[68:71], a[72:75], v[164:167], v[68:71]
  v_mfma_f32_16x16x32_bf16 v[84:87], a[76:79], v[164:167], v[84:87]
  s_waitcnt vmcnt(9)
  v_mfma_f32_16x16x32_bf16 v[40:43], a[64:67], v[168:171], v[40:43]
  v_mfma_f32_16x16x32_bf16 v[56:59], a[68:71], v[168:171], v[56:59]
  v_mfma_f32_16x16x32_bf16 v[72:75], a[72:75], v[168:171], v[72:75]
  v_mfma_f32_16x16x32_bf16 v[88:91], a[76:79], v[168:171], v[88:91]
  s_waitcnt vmcnt(8)
  v_mfma_f32_16x16x32_bf16 v[44:47], a[64:67], v[172:175], v[44:47]
  v_mfma_f32_16x16x32_bf16 v[60:63], a[68:71], v[172:175], v[60:63]
  v_mfma_f32_16x16x32_bf16 v[76:79], a[72:75], v[172:175], v[76:79]
  v_mfma_f32_16x16x32_bf16 v[92:95], a[76:79], v[172:175], v[92:95]
  s_waitcnt vmcnt(7) lgkmcnt(14)
  v_mfma_f32_16x16x32_bf16 v[32:35], a[80:83], v[176:179], v[32:35]
  s_waitcnt lgkmcnt(12)
  v_mfma_f32_16x16x32_bf16 v[48:51], a[84:87], v[176:179], v[48:51]
  s_waitcnt lgkmcnt(10)
  v_mfma_f32_16x16x32_bf16 v[64:67], a[88:91], v[176:179], v[64:67]
  s_waitcnt lgkmcnt(8)
  v_mfma_f32_16x16x32_bf16 v[80:83], a[92:95], v[176:179], v[80:83]
  s_waitcnt vmcnt(6)
  v_mfma_f32_16x16x32_bf16 v[36:39], a[80:83], v[180:183], v[36:39]
  v_mfma_f32_16x16x32_bf16 v[52:55], a[84:87], v[180:183], v[52:55]
  v_mfma_f32_16x16x32_bf16 v[68:71], a[88:91], v[180:183], v[68:71]
  v_mfma_f32_16x16x32_bf16 v[84:87], a[92:95], v[180:183], v[84:87]
  s_waitcnt vmcnt(5)
  v_mfma_f32_16x16x32_bf16 v[40:43], a[80:83], v[184:187], v[40:43]
  v_mfma_f32_16x16x32_bf16 v[56:59], a[84:87], v[184:187], v[56:59]
  v_mfma_f32_16x16x32_bf16 v[72:75], a[88:91], v[184:187], v[72:75]
  v_mfma_f32_16x16x32_bf16 v[88:91], a[92:95], v[184:187], v[88:91]
  s_waitcnt vmcnt(4)
  v_mfma_f32_16x16x32_bf16 v[44:47], a[80:83], v[188:191], v[44:47]
  v_mfma_f32_16x16x32_bf16 v[60:63], a[84:87], v[188:191], v[60:63]
  v_mfma_f32_16x16x32_bf16 v[76:79], a[88:91], v[188:191], v[76:79]
  v_mfma_f32_16x16x32_bf16 v[92:95], a[92:95], v[188:191], v[92:95]
  s_waitcnt vmcnt(2) lgkmcnt(6)
  v_mfma_f32_16x16x32_bf16 v[36:39], a[96:99], v[196:199], v[36:39]
  s_waitcnt lgkmcnt(4)
  v_mfma_f32_16x16x32_bf16 v[52:55], a[100:103], v[196:199], v[52:55]
  s_waitcnt lgkmcnt(2)
  v_mfma_f32_16x16x32_bf16 v[68:71], a[104:107], v[196:199], v[68:71]
  s_waitcnt lgkmcnt(0)
  v_mfma_f32_16x16x32_bf16 v[84:87], a[108:111], v[196:199], v[84:87]
  s_waitcnt vmcnt(1)
  v_mfma_f32_16x16x32_bf16 v[40:43], a[96:99], v[200:203], v[40:43]
  v_mfma_f32_16x16x32_bf16 v[56:59], a[100:103], v[200:203], v[56:59]
  ds_write_b128 v219, v[36:39] offset:0
  v_mfma_f32_16x16x32_bf16 v[72:75], a[104:107], v[200:203], v[72:75]
  v_mfma_f32_16x16x32_bf16 v[88:91], a[108:111], v[200:203], v[88:91]
  ds_write_b128 v219, v[52:55] offset:1024
  s_waitcnt vmcnt(0)
  v_mfma_f32_16x16x32_bf16 v[44:47], a[96:99], v[204:207], v[44:47]
  v_mfma_f32_16x16x32_bf16 v[60:63], a[100:103], v[204:207], v[60:63]
  ds_write_b128 v219, v[68:71] offset:2048
  v_mfma_f32_16x16x32_bf16 v[76:79], a[104:107], v[204:207], v[76:79]
  v_mfma_f32_16x16x32_bf16 v[92:95], a[108:111], v[204:207], v[92:95]
  ds_write_b128 v219, v[84:87] offset:3072
  v_mfma_f32_16x16x32_bf16 v[32:35], a[96:99], v[192:195], v[32:35]
  v_mfma_f32_16x16x32_bf16 v[48:51], a[100:103], v[192:195], v[48:51]
  ds_write_b128 v228, v[40:43] offset:0
  v_mfma_f32_16x16x32_bf16 v[64:67], a[104:107], v[192:195], v[64:67]
  v_mfma_f32_16x16x32_bf16 v[80:83], a[108:111], v[192:195], v[80:83]
  ds_write_b128 v228, v[56:59] offset:1024
  ds_write_b128 v228, v[72:75] offset:2048
  ds_write_b128 v228, v[88:91] offset:3072
  ds_write_b128 v229, v[44:47] offset:0
  ds_write_b128 v229, v[60:63] offset:1024
  ds_write_b128 v229, v[76:79] offset:2048
  ds_write_b128 v229, v[92:95] offset:3072
  s_waitcnt lgkmcnt(0)
  s_barrier
  ds_read_b128 v[96:99], v230 offset:0
  ds_read_b128 v[100:103], v230 offset:1024
  ds_read_b128 v[104:107], v230 offset:2048
  ds_read_b128 v[108:111], v230 offset:3072
  ds_read_b128 v[112:115], v230 offset:4096
  ds_read_b128 v[116:119], v230 offset:5120
  ds_read_b128 v[120:123], v230 offset:6144
  ds_read_b128 v[124:127], v230 offset:7168
  ds_read_b128 v[128:131], v230 offset:8192
  ds_read_b128 v[132:135], v230 offset:9216
  ds_read_b128 v[136:139], v230 offset:10240
  ds_read_b128 v[140:143], v230 offset:11264
  s_waitcnt lgkmcnt(11)
  v_pk_add_f32 v[32:33], v[32:33], v[96:97]
  v_pk_add_f32 v[34:35], v[34:35], v[98:99]
  s_waitcnt lgkmcnt(10)
  v_pk_add_f32 v[48:49], v[48:49], v[100:101]
  v_pk_add_f32 v[50:51], v[50:51], v[102:103]
  s_waitcnt lgkmcnt(9)
  v_pk_add_f32 v[64:65], v[64:65], v[104:105]
  v_pk_add_f32 v[66:67], v[66:67], v[106:107]
  s_waitcnt lgkmcnt(8)
  v_pk_add_f32 v[80:81], v[80:81], v[108:109]
  v_pk_add_f32 v[82:83], v[82:83], v[110:111]
  s_waitcnt lgkmcnt(7)
  v_pk_add_f32 v[32:33], v[32:33], v[112:113]
  v_pk_add_f32 v[34:35], v[34:35], v[114:115]
  s_waitcnt lgkmcnt(6)
  v_pk_add_f32 v[48:49], v[48:49], v[116:117]
  v_pk_add_f32 v[50:51], v[50:51], v[118:119]
  s_waitcnt lgkmcnt(5)
  v_pk_add_f32 v[64:65], v[64:65], v[120:121]
  v_pk_add_f32 v[66:67], v[66:67], v[122:123]
  s_waitcnt lgkmcnt(4)
  v_pk_add_f32 v[80:81], v[80:81], v[124:125]
  v_pk_add_f32 v[82:83], v[82:83], v[126:127]
  s_waitcnt lgkmcnt(3)
  v_pk_add_f32 v[32:33], v[32:33], v[128:129]
  v_pk_add_f32 v[34:35], v[34:35], v[130:131]
  s_waitcnt lgkmcnt(2)
  v_pk_add_f32 v[48:49], v[48:49], v[132:133]
  v_pk_add_f32 v[50:51], v[50:51], v[134:135]
  s_waitcnt lgkmcnt(1)
  v_pk_add_f32 v[64:65], v[64:65], v[136:137]
  v_pk_add_f32 v[66:67], v[66:67], v[138:139]
  s_waitcnt lgkmcnt(0)
  v_pk_add_f32 v[80:81], v[80:81], v[140:141]
  v_pk_add_f32 v[82:83], v[82:83], v[142:143]
  v_cvt_pk_bf16_f32 v144, v32, v33
  v_cvt_pk_bf16_f32 v145, v34, v35
  v_cvt_pk_bf16_f32 v146, v48, v49
  v_cvt_pk_bf16_f32 v147, v50, v51
  v_cvt_pk_bf16_f32 v148, v64, v65
  v_cvt_pk_bf16_f32 v149, v66, v67
  v_cvt_pk_bf16_f32 v150, v80, v81
  v_cvt_pk_bf16_f32 v151, v82, v83
  v_permlane32_swap_b32 v144, v146
  v_permlane32_swap_b32 v145, v147
  v_permlane32_swap_b32 v148, v150
  v_permlane32_swap_b32 v149, v151
  v_permlane16_swap_b32 v144, v146
  v_permlane16_swap_b32 v145, v147
  v_permlane16_swap_b32 v148, v150
  v_permlane16_swap_b32 v149, v151
  s_nop 0
  v_mov_b32_dpp v152, v148 row_ror:8 row_mask:0xf bank_mask:0xf
  v_mov_b32_dpp v153, v149 row_ror:8 row_mask:0xf bank_mask:0xf
  v_mov_b32_dpp v154, v150 row_ror:8 row_mask:0xf bank_mask:0xf
  v_mov_b32_dpp v155, v151 row_ror:8 row_mask:0xf bank_mask:0xf
  v_cmp_gt_u32 vcc, 8, v4
  s_nop 1
  v_cndmask_b32 v156, v152, v144, vcc
  v_cndmask_b32 v160, v144, v152, vcc
  v_cndmask_b32 v157, v153, v145, vcc
  v_cndmask_b32 v161, v145, v153, vcc
  v_cndmask_b32 v158, v154, v146, vcc
  v_cndmask_b32 v162, v146, v154, vcc
  v_cndmask_b32 v159, v155, v147, vcc
  v_cndmask_b32 v163, v147, v155, vcc
  buffer_store_dwordx4 v[156:159], v231, s[32:35], s99 offen nt
  buffer_store_dwordx4 v[160:163], v232, s[32:35], s99 offen nt
  s_endpgm
L_spare:
  s_load_dword s55, s[86:87], 0
  s_mov_b32 s16, s74
  s_and_b32 s17, s75, 0xffff
  s_mov_b32 s18, 8388608
  s_mov_b32 s19, 0x20000
  s_mov_b32 s24, s68
  s_and_b32 s25, s69, 0xffff
  s_mov_b32 s26, 401408
  s_mov_b32 s27, 0x20000
  s_mov_b32 s28, s78
  s_and_b32 s29, s79, 0xffff
  s_mov_b32 s30, 802816
  s_mov_b32 s31, 0x20000
  s_lshl_b32 s60, s53, 7
  v_mov_b32 v48, 4096
  v_cmp_eq_u32 vcc, 1, v2
  v_mov_b32 v5, 8192
  s_nop 0
  v_cndmask_b32 v48, v48, v5, vcc
  v_cmp_eq_u32 vcc, 2, v2
  v_mov_b32 v5, 12288
  s_nop 0
  v_cndmask_b32 v48, v48, v5, vcc
  v_cmp_eq_u32 vcc, 3, v2
  v_mov_b32 v5, 16384
  s_nop 0
  v_cndmask_b32 v48, v48, v5, vcc
  v_cmp_eq_u32 vcc, 4, v2
  v_mov_b32 v5, 20480
  s_nop 0
  v_cndmask_b32 v48, v48, v5, vcc
  s_mov_b32 exec_lo, 31
  s_mov_b32 exec_hi, 0
  buffer_load_dword v49, v48, s[20:23], s60 offen sc1
  s_mov_b64 exec, -1
  s_mov_b32 s12, s66
  s_and_b32 s13, s67, 0xffff
  s_mov_b32 s14, 1204224
  s_mov_b32 s15, 0x20000
  s_mov_b32 s8, s72
  s_and_b32 s9, s73, 0xffff
  s_mov_b32 s10, 1605632
  s_mov_b32 s11, 0x20000
  v_lshlrev_b32 v50, 4, v2
  s_lshl_b32 s89, s53, 2
  s_add_u32 s89, s89, s52
  s_mul_i32 s60, s89, 16384
  s_mov_b32 s61, 4
L_pf_i:
  buffer_load_dwordx4 v[52:55], v50, s[8:11], s60 offen offset:0
  buffer_load_dwordx4 v[56:59], v50, s[8:11], s60 offen offset:1024
  buffer_load_dwordx4 v[60:63], v50, s[8:11], s60 offen offset:2048
  buffer_load_dwordx4 v[64:67], v50, s[8:11], s60 offen offset:3072
  s_add_u32 s60, s60, 4096
  s_waitcnt vmcnt(60)
  s_sub_u32 s61, s61, 1
  s_cmp_lg_u32 s61, 0
  s_cbranch_scc1 L_pf_i
  s_mul_i32 s60, s89, 12288
  s_mov_b32 s61, 3
L_pf_q:
  buffer_load_dwordx4 v[52:55], v50, s[12:15], s60 offen offset:0
  buffer_load_dwordx4 v[56:59], v50, s[12:15], s60 offen offset:1024
  buffer_load_dwordx4 v[60:63], v50, s[12:15], s60 offen offset:2048
  buffer_load_dwordx4 v[64:67], v50, s[12:15], s60 offen offset:3072
  s_add_u32 s60, s60, 4096
  s_waitcnt vmcnt(60)
  s_sub_u32 s61, s61, 1
  s_cmp_lg_u32 s61, 0
  s_cbranch_scc1 L_pf_q
  v_lshrrev_b32 v5, 3, v2
  v_add_u32 v5, 0, v5
  v_cmp_le_u32 vcc, 20, v5
  s_nop 1
  v_cndmask_b32_e64 v6, 0, 1, vcc
  v_mul_u32_u24 v7, 20, v6
  v_sub_u32 v5, v5, v7
  v_lshlrev_b32 v84, 12, v6
  v_mul_u32_u24 v6, 52, v5
  v_lshrrev_b32 v6, 8, v6
  v_lshl_add_u32 v84, v6, 10, v84
  v_mul_u32_u24 v6, 5, v6
  v_sub_u32 v5, v5, v6
  v_lshl_add_u32 v84, v5, 7, v84
  v_and_b32 v5, 7, v2
  v_lshl_add_u32 v84, v5, 4, v84
  v_lshrrev_b32 v5, 3, v2
  v_add_u32 v5, 8, v5
  v_cmp_le_u32 vcc, 20, v5
  s_nop 1
  v_cndmask_b32_e64 v6, 0, 1, vcc
  v_mul_u32_u24 v7, 20, v6
  v_sub_u32 v5, v5, v7
  v_lshlrev_b32 v85, 12, v6
  v_mul_u32_u24 v6, 52, v5
  v_lshrrev_b32 v6, 8, v6
  v_lshl_add_u32 v85, v6, 10, v85
  v_mul_u32_u24 v6, 5, v6
  v_sub_u32 v5, v5, v6
  v_lshl_add_u32 v85, v5, 7, v85
  v_and_b32 v5, 7, v2
  v_lshl_add_u32 v85, v5, 4, v85
  v_lshrrev_b32 v5, 3, v2
  v_add_u32 v5, 16, v5
  v_cmp_le_u32 vcc, 20, v5
  s_nop 1
  v_cndmask_b32_e64 v6, 0, 1, vcc
  v_mul_u32_u24 v7, 20, v6
  v_sub_u32 v5, v5, v7
  v_lshlrev_b32 v86, 12, v6
  v_mul_u32_u24 v6, 52, v5
  v_lshrrev_b32 v6, 8, v6
  v_lshl_add_u32 v86, v6, 10, v86
  v_mul_u32_u24 v6, 5, v6
  v_sub_u32 v5, v5, v6
  v_lshl_add_u32 v86, v5, 7, v86
  v_and_b32 v5, 7, v2
  v_lshl_add_u32 v86, v5, 4, v86
  v_lshrrev_b32 v5, 3, v2
  v_add_u32 v5, 24, v5
  v_cmp_le_u32 vcc, 20, v5
  s_nop 1
  v_cndmask_b32_e64 v6, 0, 1, vcc
  v_mul_u32_u24 v7, 20, v6
  v_sub_u32 v5, v5, v7
  v_lshlrev_b32 v87, 12, v6
  v_mul_u32_u24 v6, 52, v5
  v_lshrrev_b32 v6, 8, v6
  v_lshl_add_u32 v87, v6, 10, v87
  v_mul_u32_u24 v6, 5, v6
  v_sub_u32 v5, v5, v6
  v_lshl_add_u32 v87, v5, 7, v87
  v_and_b32 v5, 7, v2
  v_lshl_add_u32 v87, v5, 4, v87
  v_lshrrev_b32 v5, 3, v2
  v_add_u32 v5, 32, v5
  v_cmp_le_u32 vcc, 20, v5
  s_nop 1
  v_cndmask_b32_e64 v6, 0, 1, vcc
  v_mul_u32_u24 v7, 20, v6
  v_sub_u32 v5, v5, v7
  v_lshlrev_b32 v88, 12, v6
  v_mul_u32_u24 v6, 52, v5
  v_lshrrev_b32 v6, 8, v6
  v_lshl_add_u32 v88, v6, 10, v88
  v_mul_u32_u24 v6, 5, v6
  v_sub_u32 v5, v5, v6
  v_lshl_add_u32 v88, v5, 7, v88
  v_and_b32 v5, 7, v2
  v_lshl_add_u32 v88, v5, 4, v88
  s_lshl_b32 s60, s89, 16
  s_mov_b32 s61, 8
L_pf_s5:
  buffer_load_dwordx4 v[52:55], v84, s[16:19], s60 offen
  buffer_load_dwordx4 v[56:59], v85, s[16:19], s60 offen
  buffer_load_dwordx4 v[60:63], v86, s[16:19], s60 offen
  buffer_load_dwordx4 v[64:67], v87, s[16:19], s60 offen
  buffer_load_dwordx4 v[68:71], v88, s[16:19], s60 offen
  s_add_u32 s60, s60, 8192
  s_waitcnt vmcnt(60)
  s_sub_u32 s61, s61, 1
  s_cmp_lg_u32 s61, 0
  s_cbranch_scc1 L_pf_s5
  v_lshrrev_b32 v5, 3, v2
  v_add_u32 v5, 0, v5
  v_cmp_le_u32 vcc, 12, v5
  s_nop 1
  v_cndmask_b32_e64 v6, 0, 1, vcc
  v_mul_u32_u24 v7, 12, v6
  v_sub_u32 v5, v5, v7
  v_lshlrev_b32 v84, 12, v6
  v_mul_u32_u24 v6, 43, v5
  v_lshrrev_b32 v6, 7, v6
  v_lshl_add_u32 v84, v6, 10, v84
  v_mul_u32_u24 v6, 3, v6
  v_sub_u32 v5, v5, v6
  v_add_u32 v5, 5, v5
  v_lshl_add_u32 v84, v5, 7, v84
  v_and_b32 v5, 7, v2
  v_lshl_add_u32 v84, v5, 4, v84
  v_lshrrev_b32 v5, 3, v2
  v_add_u32 v5, 8, v5
  v_cmp_le_u32 vcc, 12, v5
  s_nop 1
  v_cndmask_b32_e64 v6, 0, 1, vcc
  v_mul_u32_u24 v7, 12, v6
  v_sub_u32 v5, v5, v7
  v_lshlrev_b32 v85, 12, v6
  v_mul_u32_u24 v6, 43, v5
  v_lshrrev_b32 v6, 7, v6
  v_lshl_add_u32 v85, v6, 10, v85
  v_mul_u32_u24 v6, 3, v6
  v_sub_u32 v5, v5, v6
  v_add_u32 v5, 5, v5
  v_lshl_add_u32 v85, v5, 7, v85
  v_and_b32 v5, 7, v2
  v_lshl_add_u32 v85, v5, 4, v85
  v_lshrrev_b32 v5, 3, v2
  v_add_u32 v5, 16, v5
  v_cmp_le_u32 vcc, 12, v5
  s_nop 1
  v_cndmask_b32_e64 v6, 0, 1, vcc
  v_mul_u32_u24 v7, 12, v6
  v_sub_u32 v5, v5, v7
  v_lshlrev_b32 v86, 12, v6
  v_mul_u32_u24 v6, 43, v5
  v_lshrrev_b32 v6, 7, v6
  v_lshl_add_u32 v86, v6, 10, v86
  v_mul_u32_u24 v6, 3, v6
  v_sub_u32 v5, v5, v6
  v_add_u32 v5, 5, v5
  v_lshl_add_u32 v86, v5, 7, v86
  v_and_b32 v5, 7, v2
  v_lshl_add_u32 v86, v5, 4, v86
  s_lshr_b32 s60, s53, 3
  s_lshl_b32 s60, s60, 9
  s_and_b32 s62, s53, 3
  s_lshl_b32 s62, s62, 2
  s_add_u32 s62, s62, s52
  s_lshl_b32 s62, s62, 5
  s_add_u32 s60, s60, s62
  s_lshl_b32 s60, s60, 12
  s_mov_b32 s61, 8
L_pf_sp2:
  buffer_load_dwordx4 v[52:55], v84, s[16:19], s60 offen
  buffer_load_dwordx4 v[56:59], v85, s[16:19], s60 offen
  buffer_load_dwordx4 v[60:63], v86, s[16:19], s60 offen
  s_add_u32 s60, s60, 8192
  buffer_load_dwordx4 v[64:67], v84, s[16:19], s60 offen
  buffer_load_dwordx4 v[68:71], v85, s[16:19], s60 offen
  buffer_load_dwordx4 v[72:75], v86, s[16:19], s60 offen
  s_add_u32 s60, s60, 8192
  s_waitcnt vmcnt(60)
  s_sub_u32 s61, s61, 1
  s_cmp_lg_u32 s61, 0
  s_cbranch_scc1 L_pf_sp2
  s_mul_i32 s60, s89, 7168
  s_mov_b32 s61, 7
L_pft_o:
  buffer_load_dwordx4 v[68:71], v50, s[28:31], s60 offen offset:0
  s_add_u32 s60, s60, 1024
  s_waitcnt vmcnt(60)
  s_sub_u32 s61, s61, 1
  s_cmp_lg_u32 s61, 0
  s_cbranch_scc1 L_pft_o
  s_mul_i32 s60, s89, 4096
  s_mov_b32 s61, 4
L_pft_w:
  buffer_load_dwordx4 v[68:71], v50, s[24:27], s60 offen offset:0
  s_add_u32 s60, s60, 1024
  s_waitcnt vmcnt(60)
  s_sub_u32 s61, s61, 1
  s_cmp_lg_u32 s61, 0
  s_cbranch_scc1 L_pft_w
  s_waitcnt lgkmcnt(0)
  s_mul_i32 s55, s55, 1664525
  s_add_u32 s55, s55, 1013904223
  v_mov_b32 v84, s55
  s_cmp_lg_u32 s52, 0
  s_cbranch_scc1 L_arr_0
  s_lshl_b32 s60, s2, 2
  s_add_u32 s60, s60, 20480
  s_mov_b64 exec, 1
  buffer_store_dword v84, off, s[20:23], s60 sc1
  s_mov_b64 exec, -1
L_arr_0:
  v_lshlrev_b32 v85, 4, v2
  s_mul_i32 s60, s53, 172032
  s_add_u32 s65, s60, 5242880
  s_add_u32 s66, s65, 128
  s_add_u32 s67, s65, 86016
  s_add_u32 s68, s65, 86144
  s_sub_u32 s64, s65, 85888
  s_cmp_eq_u32 s53, 0
  s_cselect_b32 s64, s65, s64
  v_bfe_u32 v5, v4, 2, 1
  v_mul_u32_u24 v5, 43008, v5
  v_lshrrev_b32 v6, 3, v4
  v_lshl_add_u32 v5, v6, 6, v5
  v_and_b32 v6, 3, v4
  v_lshl_add_u32 v5, v6, 4, v5
  v_lshl_add_u32 v5, v3, 8, v5
  v_add_u32 v86, s58, v5
  s_cmp_eq_u32 s52, 3
  s_cselect_b32 s60, 0x7ff00000, 0
  v_lshrrev_b32 v5, 5, v2
  v_mul_lo_u32 v5, s60, v5
  v_add_u32 v86, v86, v5
  s_mul_i32 s60, s52, 4096
  v_lshlrev_b32 v5, 4, v4
  v_lshl_add_u32 v5, v3, 8, v5
  v_add_u32 v87, s60, v5
  v_add_u32 v88, 57344, v87
  v_lshrrev_b32 v5, 1, v33
  v_lshlrev_b32 v5, 8, v5
  v_lshl_add_u32 v6, v3, 2, v32
  v_lshl_add_u32 v5, v6, 4, v5
  v_and_b32 v6, 1, v33
  v_lshl_add_u32 v5, v6, 3, v5
  v_add_u32 v89, s60, v5
  v_add_u32 v90, 57344, v89
  s_or_b32 s61, s53, s52
  s_cmp_eq_u32 s61, 0
  s_cselect_b32 s62, 4048155338, 0
  v_lshlrev_b32 v5, 2, v3
  v_sub_u32 v5, v4, v5
  v_add_u32 v5, 16, v5
  v_and_b32 v6, 0xfffffff1, v5
  v_cmp_eq_u32 vcc, 0, v6
  v_mov_b32 v6, 4048155338
  s_nop 0
  v_cndmask_b32_e64 v92, v6, 0, vcc
  v_add_f32 v92, s62, v92
  v_lshlrev_b32 v5, 2, v3
  v_sub_u32 v5, v4, v5
  v_add_u32 v5, 15, v5
  v_and_b32 v6, 0xfffffff1, v5
  v_cmp_eq_u32 vcc, 0, v6
  v_mov_b32 v6, 4048155338
  s_nop 0
  v_cndmask_b32_e64 v93, v6, 0, vcc
  v_add_f32 v93, s62, v93
  v_lshlrev_b32 v5, 2, v3
  v_sub_u32 v5, v4, v5
  v_add_u32 v5, 14, v5
  v_and_b32 v6, 0xfffffff1, v5
  v_cmp_eq_u32 vcc, 0, v6
  v_mov_b32 v6, 4048155338
  s_nop 0
  v_cndmask_b32_e64 v94, v6, 0, vcc
  v_add_f32 v94, s62, v94
  v_lshlrev_b32 v5, 2, v3
  v_sub_u32 v5, v4, v5
  v_add_u32 v5, 13, v5
  v_and_b32 v6, 0xfffffff1, v5
  v_cmp_eq_u32 vcc, 0, v6
  v_mov_b32 v6, 4048155338
  s_nop 0
  v_cndmask_b32_e64 v95, v6, 0, vcc
  v_add_f32 v95, s62, v95
  v_lshlrev_b32 v5, 2, v3
  v_sub_u32 v5, v4, v5
  v_add_u32 v5, 0, v5
  v_and_b32 v6, 0xfffffff1, v5
  v_cmp_eq_u32 vcc, 0, v6
  v_mov_b32 v6, 4048155338
  s_nop 0
  v_cndmask_b32_e64 v96, v6, 0, vcc
  v_lshlrev_b32 v5, 2, v3
  v_sub_u32 v5, v4, v5
  v_add_u32 v5, -1, v5
  v_and_b32 v6, 0xfffffff1, v5
  v_cmp_eq_u32 vcc, 0, v6
  v_mov_b32 v6, 4048155338
  s_nop 0
  v_cndmask_b32_e64 v97, v6, 0, vcc
  v_lshlrev_b32 v5, 2, v3
  v_sub_u32 v5, v4, v5
  v_add_u32 v5, -2, v5
  v_and_b32 v6, 0xfffffff1, v5
  v_cmp_eq_u32 vcc, 0, v6
  v_mov_b32 v6, 4048155338
  s_nop 0
  v_cndmask_b32_e64 v98, v6, 0, vcc
  v_lshlrev_b32 v5, 2, v3
  v_sub_u32 v5, v4, v5
  v_add_u32 v5, -3, v5
  v_and_b32 v6, 0xfffffff1, v5
  v_cmp_eq_u32 vcc, 0, v6
  v_mov_b32 v6, 4048155338
  s_nop 0
  v_cndmask_b32_e64 v99, v6, 0, vcc
  v_bfe_u32 v5, v4, 2, 1
  s_lshr_b32 s60, s52, 1
  s_lshl_b32 s60, s60, 1
  v_add_u32 v5, s60, v5
  v_mul_u32_u24 v5, 7168, v5
  v_lshrrev_b32 v6, 3, v4
  v_lshlrev_b32 v6, 2, v6
  v_and_b32 v7, 3, v4
  v_add_u32 v6, v6, v7
  s_and_b32 s60, s52, 1
  s_lshl_b32 s60, s60, 3
  v_add_u32 v6, s60, v6
  v_lshl_add_u32 v5, v6, 4, v5
  v_add_u32 v91, 114688, v5
  v_add_u32 v5, 0, v3
  v_lshrrev_b32 v6, 3, v5
  v_lshl_add_u32 v100, v6, 10, v91
  v_and_b32 v6, 3, v5
  v_lshl_add_u32 v100, v6, 8, v100
  v_bfe_u32 v6, v5, 2, 1
  v_lshl_add_u32 v100, v6, 3, v100
  v_add_u32 v5, 1, v3
  v_lshrrev_b32 v6, 3, v5
  v_lshl_add_u32 v101, v6, 10, v91
  v_and_b32 v6, 3, v5
  v_lshl_add_u32 v101, v6, 8, v101
  v_bfe_u32 v6, v5, 2, 1
  v_lshl_add_u32 v101, v6, 3, v101
  v_add_u32 v5, 2, v3
  v_lshrrev_b32 v6, 3, v5
  v_lshl_add_u32 v102, v6, 10, v91
  v_and_b32 v6, 3, v5
  v_lshl_add_u32 v102, v6, 8, v102
  v_bfe_u32 v6, v5, 2, 1
  v_lshl_add_u32 v102, v6, 3, v102
  v_add_u32 v5, 3, v3
  v_lshrrev_b32 v6, 3, v5
  v_lshl_add_u32 v103, v6, 10, v91
  v_and_b32 v6, 3, v5
  v_lshl_add_u32 v103, v6, 8, v103
  v_bfe_u32 v6, v5, 2, 1
  v_lshl_add_u32 v103, v6, 3, v103
  v_add_u32 v5, 4, v3
  v_lshrrev_b32 v6, 3, v5
  v_lshl_add_u32 v104, v6, 10, v91
  v_and_b32 v6, 3, v5
  v_lshl_add_u32 v104, v6, 8, v104
  v_bfe_u32 v6, v5, 2, 1
  v_lshl_add_u32 v104, v6, 3, v104
  v_add_u32 v5, 5, v3
  v_lshrrev_b32 v6, 3, v5
  v_lshl_add_u32 v105, v6, 10, v91
  v_and_b32 v6, 3, v5
  v_lshl_add_u32 v105, v6, 8, v105
  v_bfe_u32 v6, v5, 2, 1
  v_lshl_add_u32 v105, v6, 3, v105
  v_add_u32 v5, 6, v3
  v_lshrrev_b32 v6, 3, v5
  v_lshl_add_u32 v106, v6, 10, v91
  v_and_b32 v6, 3, v5
  v_lshl_add_u32 v106, v6, 8, v106
  v_bfe_u32 v6, v5, 2, 1
  v_lshl_add_u32 v106, v6, 3, v106
  v_add_u32 v5, 7, v3
  v_lshrrev_b32 v6, 3, v5
  v_lshl_add_u32 v107, v6, 10, v91
  v_and_b32 v6, 3, v5
  v_lshl_add_u32 v107, v6, 8, v107
  v_bfe_u32 v6, v5, 2, 1
  v_lshl_add_u32 v107, v6, 3, v107
  s_mov_b32 s74, 0xffff
  s_mov_b32 s75, 0
  s_mov_b32 s76, 0
  s_mov_b32 s77, 0xffff0000
  s_not_b64 s[78:79], s[74:75]
  s_not_b64 s[88:89], s[76:77]
  v_and_b32 v5, 31, v2
  v_min_u32 v5, 27, v5
  v_lshlrev_b32 v5, 2, v5
  v_lshrrev_b32 v6, 5, v2
  s_cmp_eq_u32 s53, 0
  s_cselect_b32 s60, 0, 128
  v_mul_u32_u24 v6, s60, v6
  v_sub_u32 v5, v5, v6
  v_add_u32 v108, 128, v5
  s_lshl_b32 s61, s53, 7
  s_add_u32 s90, s61, 8064
  s_waitcnt vmcnt(0)
  s_mov_b32 s63, 0
L_poll_fq:
  buffer_load_dword v7, v108, s[20:23], s90 offen sc1
  s_waitcnt vmcnt(0)
  v_cmp_ne_u32 vcc, s55, v7
  s_nop 3
  s_cmp_eq_u64 vcc, 0
  s_cbranch_scc1 L_ok_fq
  s_add_u32 s63, s63, 1
  s_cmp_lt_u32 s63, 20000
  s_cbranch_scc1 L_poll_fq
L_ok_fq:
  s_mov_b32 s72, 0
  s_add_u32 s73, s64, s72
  s_add_u32 s73, s73, 14336
  s_add_u32 m0, s58, 0
  s_nop 0
  buffer_load_dwordx4 v86, s[20:23], s73 offen sc1 lds
  s_add_u32 s73, s65, s72
  s_add_u32 s73, s73, 14336
  s_add_u32 m0, s58, 4096
  s_nop 0
  buffer_load_dwordx4 v86, s[20:23], s73 offen sc1 lds
  s_add_u32 s73, s66, s72
  s_add_u32 s73, s73, 14336
  s_add_u32 m0, s58, 8192
  s_nop 0
  buffer_load_dwordx4 v86, s[20:23], s73 offen sc1 lds
  s_add_u32 s73, s67, s72
  s_add_u32 s73, s73, 14336
  s_add_u32 m0, s58, 12288
  s_nop 0
  buffer_load_dwordx4 v86, s[20:23], s73 offen sc1 lds
  s_add_u32 s73, s68, s72
  s_add_u32 s73, s73, 14336
  s_add_u32 m0, s58, 16384
  s_nop 0
  buffer_load_dwordx4 v86, s[20:23], s73 offen sc1 lds
  s_add_u32 s73, s65, s72
  s_add_u32 m0, s58, 40960
  s_nop 0
  buffer_load_dwordx4 v86, s[20:23], s73 offen sc1 lds
  s_add_u32 s73, s66, s72
  s_add_u32 m0, s58, 45056
  s_nop 0
  buffer_load_dwordx4 v86, s[20:23], s73 offen sc1 lds
  s_add_u32 s73, s67, s72
  s_add_u32 m0, s58, 49152
  s_nop 0
  buffer_load_dwordx4 v86, s[20:23], s73 offen sc1 lds
  s_add_u32 s73, s68, s72
  s_add_u32 m0, s58, 53248
  s_nop 0
  buffer_load_dwordx4 v86, s[20:23], s73 offen sc1 lds
  s_add_u32 s73, s64, s72
  s_add_u32 s73, s73, 28672
  s_add_u32 m0, s58, 20480
  s_nop 0
  buffer_load_dwordx4 v86, s[20:23], s73 offen sc1 lds
  s_add_u32 s73, s65, s72
  s_add_u32 s73, s73, 28672
  s_add_u32 m0, s58, 24576
  s_nop 0
  buffer_load_dwordx4 v86, s[20:23], s73 offen sc1 lds
  s_add_u32 s73, s66, s72
  s_add_u32 s73, s73, 28672
  s_add_u32 m0, s58, 28672
  s_nop 0
  buffer_load_dwordx4 v86, s[20:23], s73 offen sc1 lds
  s_add_u32 s73, s67, s72
  s_add_u32 s73, s73, 28672
  s_add_u32 m0, s58, 32768
  s_nop 0
  buffer_load_dwordx4 v86, s[20:23], s73 offen sc1 lds
  s_add_u32 s73, s68, s72
  s_add_u32 s73, s73, 28672
  s_add_u32 m0, s58, 36864
  s_nop 0
  buffer_load_dwordx4 v86, s[20:23], s73 offen sc1 lds
  s_add_u32 s72, s72, 3584
  s_mov_b32 s94, 1049335798
  s_mov_b32 s95, 1049335798
  s_mov_b32 s96, 3196819446
  v_mov_b32 v196, 0x3f803f80
  v_mov_b32 v197, 0x3f803f80
  v_mov_b32 v198, 0x3f803f80
  v_mov_b32 v199, 0x3f803f80
  s_mul_i32 s60, s52, 7168
  s_add_u32 s61, s60, 114688
  v_add_u32 v109, s61, v85
  s_mul_i32 s61, s53, 57344
  s_mul_i32 s60, s52, 14336
  s_add_u32 s60, s60, s61
  s_add_u32 s93, s60, 11534336
  s_waitcnt vmcnt(0)
  s_barrier
  ds_read_b128 v[52:55], v87 offset:0
  s_add_u32 s73, s64, s72
  s_add_u32 s73, s73, 14336
  s_add_u32 m0, s58, 57344
  ds_read_b128 v[56:59], v87 offset:4096
  buffer_load_dwordx4 v86, s[20:23], s73 offen sc1 lds
  ds_read_b128 v[112:115], v87 offset:40960
  ds_read_b128 v[60:63], v87 offset:768
  ds_read_b128 v[64:67], v87 offset:4864
  ds_read_b128 v[116:119], v87 offset:41728
  ds_read_b128 v[68:71], v87 offset:1792
  ds_read_b128 v[72:75], v87 offset:5888
  ds_read_b128 v[120:123], v87 offset:42752
  s_add_u32 s73, s65, s72
  s_add_u32 s73, s73, 14336
  s_add_u32 m0, s58, 61440
  ds_read_b128 v[76:79], v87 offset:2560
  buffer_load_dwordx4 v86, s[20:23], s73 offen sc1 lds
  ds_read_b128 v[80:83], v87 offset:6656
  ds_read_b128 v[124:127], v87 offset:43520
  s_waitcnt lgkmcnt(9)
  v_cndmask_b32_e64 v114, v114, 0, s[76:77]
  v_cndmask_b32_e64 v115, v115, 0, s[76:77]
  s_waitcnt lgkmcnt(6)
  v_cndmask_b32_e64 v116, v116, 0, s[74:75]
  v_cndmask_b32_e64 v117, v117, 0, s[74:75]
  s_waitcnt lgkmcnt(3)
  v_cndmask_b32_e64 v122, v122, 0, s[76:77]
  v_cndmask_b32_e64 v123, v123, 0, s[76:77]
  s_waitcnt lgkmcnt(0)
  v_cndmask_b32_e64 v124, v124, 0, s[74:75]
  v_cndmask_b32_e64 v125, v125, 0, s[74:75]
  v_mfma_f32_16x16x32_bf16 v[160:163], v[52:55], v[112:115], v[92:95]
  v_mfma_f32_16x16x32_bf16 v[164:167], v[56:59], v[112:115], v[96:99]
  s_add_u32 s73, s66, s72
  s_add_u32 s73, s73, 14336
  s_add_u32 m0, s58, 65536
  v_mfma_f32_16x16x32_bf16 v[168:171], v[60:63], v[116:119], v[92:95]
  buffer_load_dwordx4 v86, s[20:23], s73 offen sc1 lds
  v_mfma_f32_16x16x32_bf16 v[172:175], v[64:67], v[116:119], v[96:99]
  v_mfma_f32_16x16x32_bf16 v[176:179], v[68:71], v[120:123], v[92:95]
  v_mfma_f32_16x16x32_bf16 v[180:183], v[72:75], v[120:123], v[96:99]
  v_mfma_f32_16x16x32_bf16 v[184:187], v[76:79], v[124:127], v[92:95]
  v_mfma_f32_16x16x32_bf16 v[188:191], v[80:83], v[124:127], v[96:99]
  ds_read_b64_tr_b16 v[128:129], v89 offset:20480
  ds_read_b64_tr_b16 v[130:131], v89 offset:24576
  ds_read_b64_tr_b16 v[132:133], v89 offset:20992
  ds_read_b64_tr_b16 v[134:135], v89 offset:25088
  ds_read_b64_tr_b16 v[136:137], v89 offset:21248
  ds_read_b64_tr_b16 v[138:139], v89 offset:25344
  ds_read_b64_tr_b16 v[140:141], v89 offset:21760
  s_add_u32 s73, s67, s72
  s_add_u32 s73, s73, 14336
  s_add_u32 m0, s58, 69632
  ds_read_b64_tr_b16 v[142:143], v89 offset:25856
  buffer_load_dwordx4 v86, s[20:23], s73 offen sc1 lds
  ds_read_b64_tr_b16 v[144:145], v89 offset:22272
  ds_read_b64_tr_b16 v[146:147], v89 offset:26368
  ds_read_b64_tr_b16 v[148:149], v89 offset:22784
  ds_read_b64_tr_b16 v[150:151], v89 offset:26880
  ds_read_b64_tr_b16 v[152:153], v89 offset:23040
  ds_read_b64_tr_b16 v[154:155], v89 offset:27136
  ds_read_b64_tr_b16 v[156:157], v89 offset:23552
  s_waitcnt lgkmcnt(14)
  ds_read_b64_tr_b16 v[158:159], v89 offset:27648
  v_max3_f32 v50, v160, v161, v162
  v_max3_f32 v110, v168, v169, v170
  v_max3_f32 v192, v176, v177, v178
  v_max3_f32 v194, v184, v185, v186
  v_max3_f32 v50, v50, v163, v164
  v_max3_f32 v110, v110, v171, v172
  v_max3_f32 v192, v192, v179, v180
  v_max3_f32 v194, v194, v187, v188
  v_max3_f32 v50, v50, v165, v166
  v_max3_f32 v110, v110, v173, v174
  v_max3_f32 v192, v192, v181, v182
  v_max3_f32 v194, v194, v189, v190
  s_add_u32 s73, s68, s72
  s_add_u32 s73, s73, 14336
  s_add_u32 m0, s58, 73728
  v_max_f32 v50, v50, v167
  buffer_load_dwordx4 v86, s[20:23], s73 offen sc1 lds
  v_max_f32 v110, v110, v175
  v_max_f32 v192, v192, v183
  v_max_f32 v194, v194, v191
  v_permlane32_swap_b32 v50, v110
  s_nop 0
  v_permlane32_swap_b32 v192, v194
  v_max_f32 v50, v50, v110
  v_max_f32 v192, v192, v194
  s_nop 1
  v_permlane16_swap_b32 v50, v192
  v_max_f32 v50, v50, v192
  v_mul_f32 v50, s96, v50
  v_mov_b32 v192, v50
  s_nop 1
  v_permlane16_swap_b32 v50, v192
  v_mov_b32 v110, v50
  v_mov_b32 v194, v192
  s_add_u32 s73, s65, s72
  s_add_u32 m0, s58, 98304
  v_permlane32_swap_b32 v50, v110
  buffer_load_dwordx4 v86, s[20:23], s73 offen sc1 lds
  v_permlane32_swap_b32 v192, v194
  v_mov_b32 v51, v50
  v_mov_b32 v111, v110
  v_mov_b32 v193, v192
  v_mov_b32 v195, v194
  v_pk_fma_f32 v[160:161], v[160:161], s[94:95], v[50:51]
  v_pk_fma_f32 v[162:163], v[162:163], s[94:95], v[50:51]
  v_pk_fma_f32 v[164:165], v[164:165], s[94:95], v[50:51]
  v_pk_fma_f32 v[166:167], v[166:167], s[94:95], v[50:51]
  v_pk_fma_f32 v[168:169], v[168:169], s[94:95], v[110:111]
  v_pk_fma_f32 v[170:171], v[170:171], s[94:95], v[110:111]
  v_pk_fma_f32 v[172:173], v[172:173], s[94:95], v[110:111]
  v_pk_fma_f32 v[174:175], v[174:175], s[94:95], v[110:111]
  v_pk_fma_f32 v[176:177], v[176:177], s[94:95], v[192:193]
  v_pk_fma_f32 v[178:179], v[178:179], s[94:95], v[192:193]
  v_pk_fma_f32 v[180:181], v[180:181], s[94:95], v[192:193]
  s_add_u32 s73, s66, s72
  s_add_u32 m0, s58, 102400
  v_pk_fma_f32 v[182:183], v[182:183], s[94:95], v[192:193]
  buffer_load_dwordx4 v86, s[20:23], s73 offen sc1 lds
  v_pk_fma_f32 v[184:185], v[184:185], s[94:95], v[194:195]
  v_pk_fma_f32 v[186:187], v[186:187], s[94:95], v[194:195]
  v_pk_fma_f32 v[188:189], v[188:189], s[94:95], v[194:195]
  v_pk_fma_f32 v[190:191], v[190:191], s[94:95], v[194:195]
  v_exp_f32 v160, v160
  v_exp_f32 v161, v161
  v_exp_f32 v162, v162
  v_exp_f32 v163, v163
  v_exp_f32 v164, v164
  v_exp_f32 v165, v165
  v_exp_f32 v166, v166
  v_exp_f32 v167, v167
  s_add_u32 s73, s67, s72
  s_add_u32 m0, s58, 106496
  v_cvt_pk_bf16_f32 v52, v160, v161
  buffer_load_dwordx4 v86, s[20:23], s73 offen sc1 lds
  v_cvt_pk_bf16_f32 v53, v162, v163
  v_cvt_pk_bf16_f32 v54, v164, v165
  v_cvt_pk_bf16_f32 v55, v166, v167
  v_exp_f32 v168, v168
  v_exp_f32 v169, v169
  v_exp_f32 v170, v170
  v_exp_f32 v171, v171
  v_exp_f32 v172, v172
  v_exp_f32 v173, v173
  v_exp_f32 v174, v174
  v_exp_f32 v175, v175
  v_cvt_pk_bf16_f32 v60, v168, v169
  s_add_u32 s73, s68, s72
  s_add_u32 m0, s58, 110592
  v_cvt_pk_bf16_f32 v61, v170, v171
  buffer_load_dwordx4 v86, s[20:23], s73 offen sc1 lds
  v_cvt_pk_bf16_f32 v62, v172, v173
  v_cvt_pk_bf16_f32 v63, v174, v175
  v_exp_f32 v176, v176
  v_exp_f32 v177, v177
  v_exp_f32 v178, v178
  v_exp_f32 v179, v179
  v_exp_f32 v180, v180
  v_exp_f32 v181, v181
  v_exp_f32 v182, v182
  v_exp_f32 v183, v183
  v_cvt_pk_bf16_f32 v68, v176, v177
  v_cvt_pk_bf16_f32 v69, v178, v179
  s_add_u32 s73, s64, s72
  s_add_u32 s73, s73, 28672
  s_add_u32 m0, s58, 77824
  v_cvt_pk_bf16_f32 v70, v180, v181
  buffer_load_dwordx4 v86, s[20:23], s73 offen sc1 lds
  v_cvt_pk_bf16_f32 v71, v182, v183
  v_exp_f32 v184, v184
  v_exp_f32 v185, v185
  v_exp_f32 v186, v186
  v_exp_f32 v187, v187
  v_exp_f32 v188, v188
  v_exp_f32 v189, v189
  v_exp_f32 v190, v190
  v_exp_f32 v191, v191
  v_cvt_pk_bf16_f32 v76, v184, v185
  v_cvt_pk_bf16_f32 v77, v186, v187
  v_cvt_pk_bf16_f32 v78, v188, v189
  s_add_u32 s73, s65, s72
  s_add_u32 s73, s73, 28672
  s_add_u32 m0, s58, 81920
  v_cvt_pk_bf16_f32 v79, v190, v191
  buffer_load_dwordx4 v86, s[20:23], s73 offen sc1 lds
  v_mfma_f32_16x16x32_bf16 v[200:203], v[196:199], v[52:55], 0
  s_waitcnt lgkmcnt(14)
  v_mfma_f32_16x16x32_bf16 v[56:59], v[128:131], v[52:55], 0
  s_waitcnt lgkmcnt(12)
  v_mfma_f32_16x16x32_bf16 v[112:115], v[132:135], v[52:55], 0
  v_mfma_f32_16x16x32_bf16 v[204:207], v[196:199], v[60:63], 0
  s_waitcnt lgkmcnt(10)
  v_mfma_f32_16x16x32_bf16 v[64:67], v[136:139], v[60:63], 0
  s_waitcnt lgkmcnt(8)
  v_mfma_f32_16x16x32_bf16 v[116:119], v[140:143], v[60:63], 0
  v_mfma_f32_16x16x32_bf16 v[208:211], v[196:199], v[68:71], 0
  s_add_u32 s73, s66, s72
  s_add_u32 s73, s73, 28672
  s_add_u32 m0, s58, 86016
  s_waitcnt lgkmcnt(6)
  v_mfma_f32_16x16x32_bf16 v[72:75], v[144:147], v[68:71], 0
  buffer_load_dwordx4 v86, s[20:23], s73 offen sc1 lds
  s_waitcnt lgkmcnt(4)
  v_mfma_f32_16x16x32_bf16 v[120:123], v[148:151], v[68:71], 0
  v_mfma_f32_16x16x32_bf16 v[212:215], v[196:199], v[76:79], 0
  s_waitcnt lgkmcnt(2)
  v_mfma_f32_16x16x32_bf16 v[80:83], v[152:155], v[76:79], 0
  s_waitcnt lgkmcnt(0)
  v_mfma_f32_16x16x32_bf16 v[124:127], v[156:159], v[76:79], 0
  v_rcp_f32 v200, v200
  v_rcp_f32 v201, v201
  v_rcp_f32 v204, v204
  v_rcp_f32 v205, v205
  s_add_u32 s73, s67, s72
  s_add_u32 s73, s73, 28672
  s_add_u32 m0, s58, 90112
  v_rcp_f32 v208, v208
  buffer_load_dwordx4 v86, s[20:23], s73 offen sc1 lds
  v_rcp_f32 v209, v209
  v_rcp_f32 v212, v212
  v_rcp_f32 v213, v213
  v_pk_mul_f32 v[56:57], v[56:57], v[200:201]
  v_pk_mul_f32 v[58:59], v[58:59], v[200:201]
  v_pk_mul_f32 v[112:113], v[112:113], v[200:201]
  v_pk_mul_f32 v[114:115], v[114:115], v[200:201]
  v_pk_mul_f32 v[64:65], v[64:65], v[204:205]
  v_pk_mul_f32 v[66:67], v[66:67], v[204:205]
  v_pk_mul_f32 v[116:117], v[116:117], v[204:205]
  v_pk_mul_f32 v[118:119], v[118:119], v[204:205]
  v_pk_mul_f32 v[72:73], v[72:73], v[208:209]
  v_pk_mul_f32 v[74:75], v[74:75], v[208:209]
  v_pk_mul_f32 v[120:121], v[120:121], v[208:209]
  v_pk_mul_f32 v[122:123], v[122:123], v[208:209]
  s_add_u32 s73, s68, s72
  s_add_u32 s73, s73, 28672
  s_add_u32 m0, s58, 94208
  v_pk_mul_f32 v[80:81], v[80:81], v[212:213]
  buffer_load_dwordx4 v86, s[20:23], s73 offen sc1 lds
  s_add_u32 s72, s72, 3584
  v_pk_mul_f32 v[82:83], v[82:83], v[212:213]
  v_pk_mul_f32 v[124:125], v[124:125], v[212:213]
  v_pk_mul_f32 v[126:127], v[126:127], v[212:213]
  v_cvt_pk_bf16_f32 v160, v56, v57
  v_cvt_pk_bf16_f32 v161, v58, v59
  v_cvt_pk_bf16_f32 v162, v112, v113
  v_cvt_pk_bf16_f32 v163, v114, v115
  v_cvt_pk_bf16_f32 v168, v64, v65
  v_cvt_pk_bf16_f32 v169, v66, v67
  v_cvt_pk_bf16_f32 v170, v116, v117
  v_cvt_pk_bf16_f32 v171, v118, v119
  v_cvt_pk_bf16_f32 v176, v72, v73
  v_cvt_pk_bf16_f32 v177, v74, v75
  v_cvt_pk_bf16_f32 v178, v120, v121
  v_cvt_pk_bf16_f32 v179, v122, v123
  v_cvt_pk_bf16_f32 v184, v80, v81
  v_cvt_pk_bf16_f32 v185, v82, v83
  v_cvt_pk_bf16_f32 v186, v124, v125
  v_cvt_pk_bf16_f32 v187, v126, v127
  ds_write_b64 v100, v[160:161] offset:0
  ds_write_b64 v102, v[170:171] offset:1024
  ds_write_b64 v106, v[176:177] offset:1024
  ds_write_b64 v100, v[186:187] offset:3072
  s_mov_b64 exec, s[78:79]
  ds_write_b64 v106, v[168:169] offset:0
  ds_write_b64 v104, v[184:185] offset:2048
  s_mov_b64 exec, s[88:89]
  ds_write_b64 v104, v[162:163] offset:0
  ds_write_b64 v102, v[178:179] offset:2048
  s_mov_b64 exec, -1
  s_waitcnt vmcnt(0)
  s_barrier
  ds_read_b128 v[52:55], v88 offset:0
  s_add_u32 s73, s64, s72
  s_add_u32 s73, s73, 14336
  s_add_u32 m0, s58, 0
  ds_read_b128 v[56:59], v88 offset:4096
  buffer_load_dwordx4 v86, s[20:23], s73 offen sc1 lds
  ds_read_b128 v[112:115], v88 offset:40960
  ds_read_b128 v[60:63], v88 offset:768
  ds_read_b128 v[64:67], v88 offset:4864
  ds_read_b128 v[116:119], v88 offset:41728
  ds_read_b128 v[68:71], v88 offset:1792
  s_waitcnt lgkmcnt(14)
  ds_read_b128 v[72:75], v88 offset:5888
  s_waitcnt lgkmcnt(14)
  ds_read_b128 v[120:123], v88 offset:42752
  s_add_u32 s73, s65, s72
  s_add_u32 s73, s73, 14336
  s_add_u32 m0, s58, 4096
  s_waitcnt lgkmcnt(14)
  ds_read_b128 v[76:79], v88 offset:2560
  buffer_load_dwordx4 v86, s[20:23], s73 offen sc1 lds
  s_waitcnt lgkmcnt(14)
  ds_read_b128 v[80:83], v88 offset:6656
  s_waitcnt lgkmcnt(14)
  ds_read_b128 v[124:127], v88 offset:43520
  s_waitcnt lgkmcnt(9)
  v_cndmask_b32_e64 v114, v114, 0, s[76:77]
  v_cndmask_b32_e64 v115, v115, 0, s[76:77]
  s_waitcnt lgkmcnt(6)
  v_cndmask_b32_e64 v116, v116, 0, s[74:75]
  v_cndmask_b32_e64 v117, v117, 0, s[74:75]
  s_waitcnt lgkmcnt(3)
  v_cndmask_b32_e64 v122, v122, 0, s[76:77]
  v_cndmask_b32_e64 v123, v123, 0, s[76:77]
  s_waitcnt lgkmcnt(0)
  v_cndmask_b32_e64 v124, v124, 0, s[74:75]
  v_cndmask_b32_e64 v125, v125, 0, s[74:75]
  v_mfma_f32_16x16x32_bf16 v[160:163], v[52:55], v[112:115], v[92:95]
  v_mfma_f32_16x16x32_bf16 v[164:167], v[56:59], v[112:115], v[96:99]
  s_add_u32 s73, s66, s72
  s_add_u32 s73, s73, 14336
  s_add_u32 m0, s58, 8192
  v_mfma_f32_16x16x32_bf16 v[168:171], v[60:63], v[116:119], v[92:95]
  buffer_load_dwordx4 v86, s[20:23], s73 offen sc1 lds
  v_mfma_f32_16x16x32_bf16 v[172:175], v[64:67], v[116:119], v[96:99]
  v_mfma_f32_16x16x32_bf16 v[176:179], v[68:71], v[120:123], v[92:95]
  v_mfma_f32_16x16x32_bf16 v[180:183], v[72:75], v[120:123], v[96:99]
  v_mfma_f32_16x16x32_bf16 v[184:187], v[76:79], v[124:127], v[92:95]
  v_mfma_f32_16x16x32_bf16 v[188:191], v[80:83], v[124:127], v[96:99]
  ds_read_b64_tr_b16 v[128:129], v90 offset:20480
  ds_read_b64_tr_b16 v[130:131], v90 offset:24576
  ds_read_b64_tr_b16 v[132:133], v90 offset:20992
  ds_read_b64_tr_b16 v[134:135], v90 offset:25088
  ds_read_b64_tr_b16 v[136:137], v90 offset:21248
  ds_read_b64_tr_b16 v[138:139], v90 offset:25344
  ds_read_b64_tr_b16 v[140:141], v90 offset:21760
  s_add_u32 s73, s67, s72
  s_add_u32 s73, s73, 14336
  s_add_u32 m0, s58, 12288
  ds_read_b64_tr_b16 v[142:143], v90 offset:25856
  buffer_load_dwordx4 v86, s[20:23], s73 offen sc1 lds
  ds_read_b64_tr_b16 v[144:145], v90 offset:22272
  ds_read_b64_tr_b16 v[146:147], v90 offset:26368
  ds_read_b64_tr_b16 v[148:149], v90 offset:22784
  ds_read_b64_tr_b16 v[150:151], v90 offset:26880
  ds_read_b64_tr_b16 v[152:153], v90 offset:23040
  ds_read_b64_tr_b16 v[154:155], v90 offset:27136
  ds_read_b64_tr_b16 v[156:157], v90 offset:23552
  s_waitcnt lgkmcnt(14)
  ds_read_b64_tr_b16 v[158:159], v90 offset:27648
  v_max3_f32 v50, v160, v161, v162
  v_max3_f32 v110, v168, v169, v170
  v_max3_f32 v192, v176, v177, v178
  v_max3_f32 v194, v184, v185, v186
  v_max3_f32 v50, v50, v163, v164
  v_max3_f32 v110, v110, v171, v172
  v_max3_f32 v192, v192, v179, v180
  v_max3_f32 v194, v194, v187, v188
  v_max3_f32 v50, v50, v165, v166
  v_max3_f32 v110, v110, v173, v174
  v_max3_f32 v192, v192, v181, v182
  v_max3_f32 v194, v194, v189, v190
  s_add_u32 s73, s68, s72
  s_add_u32 s73, s73, 14336
  s_add_u32 m0, s58, 16384
  v_max_f32 v50, v50, v167
  buffer_load_dwordx4 v86, s[20:23], s73 offen sc1 lds
  v_max_f32 v110, v110, v175
  v_max_f32 v192, v192, v183
  v_max_f32 v194, v194, v191
  v_permlane32_swap_b32 v50, v110
  s_nop 0
  v_permlane32_swap_b32 v192, v194
  v_max_f32 v50, v50, v110
  v_max_f32 v192, v192, v194
  s_nop 1
  v_permlane16_swap_b32 v50, v192
  v_max_f32 v50, v50, v192
  v_mul_f32 v50, s96, v50
  v_mov_b32 v192, v50
  s_nop 1
  v_permlane16_swap_b32 v50, v192
  v_mov_b32 v110, v50
  v_mov_b32 v194, v192
  s_add_u32 s73, s65, s72
  s_add_u32 m0, s58, 40960
  v_permlane32_swap_b32 v50, v110
  buffer_load_dwordx4 v86, s[20:23], s73 offen sc1 lds
  v_permlane32_swap_b32 v192, v194
  v_mov_b32 v51, v50
  v_mov_b32 v111, v110
  v_mov_b32 v193, v192
  v_mov_b32 v195, v194
  v_pk_fma_f32 v[160:161], v[160:161], s[94:95], v[50:51]
  v_pk_fma_f32 v[162:163], v[162:163], s[94:95], v[50:51]
  v_pk_fma_f32 v[164:165], v[164:165], s[94:95], v[50:51]
  v_pk_fma_f32 v[166:167], v[166:167], s[94:95], v[50:51]
  v_pk_fma_f32 v[168:169], v[168:169], s[94:95], v[110:111]
  v_pk_fma_f32 v[170:171], v[170:171], s[94:95], v[110:111]
  v_pk_fma_f32 v[172:173], v[172:173], s[94:95], v[110:111]
  v_pk_fma_f32 v[174:175], v[174:175], s[94:95], v[110:111]
  v_pk_fma_f32 v[176:177], v[176:177], s[94:95], v[192:193]
  v_pk_fma_f32 v[178:179], v[178:179], s[94:95], v[192:193]
  v_pk_fma_f32 v[180:181], v[180:181], s[94:95], v[192:193]
  s_add_u32 s73, s66, s72
  s_add_u32 m0, s58, 45056
  v_pk_fma_f32 v[182:183], v[182:183], s[94:95], v[192:193]
  buffer_load_dwordx4 v86, s[20:23], s73 offen sc1 lds
  v_pk_fma_f32 v[184:185], v[184:185], s[94:95], v[194:195]
  v_pk_fma_f32 v[186:187], v[186:187], s[94:95], v[194:195]
  v_pk_fma_f32 v[188:189], v[188:189], s[94:95], v[194:195]
  v_pk_fma_f32 v[190:191], v[190:191], s[94:95], v[194:195]
  v_exp_f32 v160, v160
  v_exp_f32 v161, v161
  v_exp_f32 v162, v162
  v_exp_f32 v163, v163
  v_exp_f32 v164, v164
  v_exp_f32 v165, v165
  v_exp_f32 v166, v166
  v_exp_f32 v167, v167
  s_add_u32 s73, s67, s72
  s_add_u32 m0, s58, 49152
  v_cvt_pk_bf16_f32 v52, v160, v161
  buffer_load_dwordx4 v86, s[20:23], s73 offen sc1 lds
  v_cvt_pk_bf16_f32 v53, v162, v163
  v_cvt_pk_bf16_f32 v54, v164, v165
  v_cvt_pk_bf16_f32 v55, v166, v167
  v_exp_f32 v168, v168
  v_exp_f32 v169, v169
  v_exp_f32 v170, v170
  v_exp_f32 v171, v171
  v_exp_f32 v172, v172
  v_exp_f32 v173, v173
  v_exp_f32 v174, v174
  v_exp_f32 v175, v175
  v_cvt_pk_bf16_f32 v60, v168, v169
  s_add_u32 s73, s68, s72
  s_add_u32 m0, s58, 53248
  v_cvt_pk_bf16_f32 v61, v170, v171
  buffer_load_dwordx4 v86, s[20:23], s73 offen sc1 lds
  v_cvt_pk_bf16_f32 v62, v172, v173
  v_cvt_pk_bf16_f32 v63, v174, v175
  v_exp_f32 v176, v176
  v_exp_f32 v177, v177
  v_exp_f32 v178, v178
  v_exp_f32 v179, v179
  v_exp_f32 v180, v180
  v_exp_f32 v181, v181
  v_exp_f32 v182, v182
  v_exp_f32 v183, v183
  v_cvt_pk_bf16_f32 v68, v176, v177
  v_cvt_pk_bf16_f32 v69, v178, v179
  s_add_u32 s73, s64, s72
  s_add_u32 s73, s73, 28672
  s_add_u32 m0, s58, 20480
  v_cvt_pk_bf16_f32 v70, v180, v181
  buffer_load_dwordx4 v86, s[20:23], s73 offen sc1 lds
  v_cvt_pk_bf16_f32 v71, v182, v183
  v_exp_f32 v184, v184
  v_exp_f32 v185, v185
  v_exp_f32 v186, v186
  v_exp_f32 v187, v187
  v_exp_f32 v188, v188
  v_exp_f32 v189, v189
  v_exp_f32 v190, v190
  v_exp_f32 v191, v191
  v_cvt_pk_bf16_f32 v76, v184, v185
  v_cvt_pk_bf16_f32 v77, v186, v187
  v_cvt_pk_bf16_f32 v78, v188, v189
  s_add_u32 s73, s65, s72
  s_add_u32 s73, s73, 28672
  s_add_u32 m0, s58, 24576
  v_cvt_pk_bf16_f32 v79, v190, v191
  buffer_load_dwordx4 v86, s[20:23], s73 offen sc1 lds
  v_mfma_f32_16x16x32_bf16 v[200:203], v[196:199], v[52:55], 0
  s_waitcnt lgkmcnt(14)
  v_mfma_f32_16x16x32_bf16 v[56:59], v[128:131], v[52:55], 0
  s_waitcnt lgkmcnt(12)
  v_mfma_f32_16x16x32_bf16 v[112:115], v[132:135], v[52:55], 0
  v_mfma_f32_16x16x32_bf16 v[204:207], v[196:199], v[60:63], 0
  s_waitcnt lgkmcnt(10)
  v_mfma_f32_16x16x32_bf16 v[64:67], v[136:139], v[60:63], 0
  s_waitcnt lgkmcnt(8)
  v_mfma_f32_16x16x32_bf16 v[116:119], v[140:143], v[60:63], 0
  v_mfma_f32_16x16x32_bf16 v[208:211], v[196:199], v[68:71], 0
  s_add_u32 s73, s66, s72
  s_add_u32 s73, s73, 28672
  s_add_u32 m0, s58, 28672
  s_waitcnt lgkmcnt(6)
  v_mfma_f32_16x16x32_bf16 v[72:75], v[144:147], v[68:71], 0
  buffer_load_dwordx4 v86, s[20:23], s73 offen sc1 lds
  s_waitcnt lgkmcnt(4)
  v_mfma_f32_16x16x32_bf16 v[120:123], v[148:151], v[68:71], 0
  v_mfma_f32_16x16x32_bf16 v[212:215], v[196:199], v[76:79], 0
  s_waitcnt lgkmcnt(2)
  v_mfma_f32_16x16x32_bf16 v[80:83], v[152:155], v[76:79], 0
  s_waitcnt lgkmcnt(0)
  v_mfma_f32_16x16x32_bf16 v[124:127], v[156:159], v[76:79], 0
  v_rcp_f32 v200, v200
  v_rcp_f32 v201, v201
  v_rcp_f32 v204, v204
  v_rcp_f32 v205, v205
  s_add_u32 s73, s67, s72
  s_add_u32 s73, s73, 28672
  s_add_u32 m0, s58, 32768
  v_rcp_f32 v208, v208
  buffer_load_dwordx4 v86, s[20:23], s73 offen sc1 lds
  v_rcp_f32 v209, v209
  v_rcp_f32 v212, v212
  v_rcp_f32 v213, v213
  v_pk_mul_f32 v[56:57], v[56:57], v[200:201]
  v_pk_mul_f32 v[58:59], v[58:59], v[200:201]
  v_pk_mul_f32 v[112:113], v[112:113], v[200:201]
  v_pk_mul_f32 v[114:115], v[114:115], v[200:201]
  v_pk_mul_f32 v[64:65], v[64:65], v[204:205]
  v_pk_mul_f32 v[66:67], v[66:67], v[204:205]
  v_pk_mul_f32 v[116:117], v[116:117], v[204:205]
  v_pk_mul_f32 v[118:119], v[118:119], v[204:205]
  v_pk_mul_f32 v[72:73], v[72:73], v[208:209]
  v_pk_mul_f32 v[74:75], v[74:75], v[208:209]
  v_pk_mul_f32 v[120:121], v[120:121], v[208:209]
  v_pk_mul_f32 v[122:123], v[122:123], v[208:209]
  s_add_u32 s73, s68, s72
  s_add_u32 s73, s73, 28672
  s_add_u32 m0, s58, 36864
  v_pk_mul_f32 v[80:81], v[80:81], v[212:213]
  buffer_load_dwordx4 v86, s[20:23], s73 offen sc1 lds
  s_add_u32 s72, s72, 3584
  v_pk_mul_f32 v[82:83], v[82:83], v[212:213]
  v_pk_mul_f32 v[124:125], v[124:125], v[212:213]
  v_pk_mul_f32 v[126:127], v[126:127], v[212:213]
  v_cvt_pk_bf16_f32 v160, v56, v57
  v_cvt_pk_bf16_f32 v161, v58, v59
  v_cvt_pk_bf16_f32 v162, v112, v113
  v_cvt_pk_bf16_f32 v163, v114, v115
  v_cvt_pk_bf16_f32 v168, v64, v65
  v_cvt_pk_bf16_f32 v169, v66, v67
  v_cvt_pk_bf16_f32 v170, v116, v117
  v_cvt_pk_bf16_f32 v171, v118, v119
  v_cvt_pk_bf16_f32 v176, v72, v73
  v_cvt_pk_bf16_f32 v177, v74, v75
  v_cvt_pk_bf16_f32 v178, v120, v121
  v_cvt_pk_bf16_f32 v179, v122, v123
  v_cvt_pk_bf16_f32 v184, v80, v81
  v_cvt_pk_bf16_f32 v185, v82, v83
  v_cvt_pk_bf16_f32 v186, v124, v125
  v_cvt_pk_bf16_f32 v187, v126, v127
  ds_write_b64 v104, v[160:161] offset:3072
  ds_write_b64 v106, v[170:171] offset:4096
  ds_write_b64 v102, v[176:177] offset:5120
  ds_write_b64 v104, v[186:187] offset:6144
  s_mov_b64 exec, s[78:79]
  ds_write_b64 v102, v[168:169] offset:4096
  ds_write_b64 v100, v[184:185] offset:6144
  s_mov_b64 exec, s[88:89]
  ds_write_b64 v100, v[162:163] offset:4096
  ds_write_b64 v106, v[178:179] offset:5120
  s_mov_b64 exec, -1
  s_waitcnt lgkmcnt(0)
  s_barrier
  ds_read_b128 v[216:219], v109 offset:0
  ds_read_b128 v[220:223], v109 offset:1024
  ds_read_b128 v[224:227], v109 offset:2048
  ds_read_b128 v[228:231], v109 offset:3072
  ds_read_b128 v[232:235], v109 offset:4096
  ds_read_b128 v[236:239], v109 offset:5120
  ds_read_b128 v[240:243], v109 offset:6144
  s_waitcnt lgkmcnt(6)
  buffer_store_dwordx4 v[216:219], v85, s[20:23], s93 offen offset:0 sc1
  s_waitcnt lgkmcnt(5)
  buffer_store_dwordx4 v[220:223], v85, s[20:23], s93 offen offset:1024 sc1
  s_waitcnt lgkmcnt(4)
  buffer_store_dwordx4 v[224:227], v85, s[20:23], s93 offen offset:2048 sc1
  s_waitcnt lgkmcnt(3)
  buffer_store_dwordx4 v[228:231], v85, s[20:23], s93 offen offset:3072 sc1
  s_add_u32 s93, s93, 4096
  s_waitcnt lgkmcnt(2)
  buffer_store_dwordx4 v[232:235], v85, s[20:23], s93 offen offset:0 sc1
  s_waitcnt lgkmcnt(1)
  buffer_store_dwordx4 v[236:239], v85, s[20:23], s93 offen offset:1024 sc1
  s_waitcnt lgkmcnt(0)
  buffer_store_dwordx4 v[240:243], v85, s[20:23], s93 offen offset:2048 sc1
  s_waitcnt vmcnt(7)
  s_barrier
  ds_read_b128 v[52:55], v87 offset:0
  ds_read_b128 v[56:59], v87 offset:4096
  ds_read_b128 v[112:115], v87 offset:40960
  ds_read_b128 v[60:63], v87 offset:768
  s_add_u32 s73, s64, s72
  s_add_u32 s73, s73, 14336
  s_add_u32 m0, s58, 57344
  ds_read_b128 v[64:67], v87 offset:4864
  buffer_load_dwordx4 v86, s[20:23], s73 offen sc1 lds
  ds_read_b128 v[116:119], v87 offset:41728
  ds_read_b128 v[68:71], v87 offset:1792
  ds_read_b128 v[72:75], v87 offset:5888
  ds_read_b128 v[120:123], v87 offset:42752
  ds_read_b128 v[76:79], v87 offset:2560
  ds_read_b128 v[80:83], v87 offset:6656
  ds_read_b128 v[124:127], v87 offset:43520
  s_add_u32 s73, s65, s72
  s_add_u32 s73, s73, 14336
  s_add_u32 m0, s58, 61440
  s_waitcnt lgkmcnt(9)
  v_cndmask_b32_e64 v114, v114, 0, s[76:77]
  buffer_load_dwordx4 v86, s[20:23], s73 offen sc1 lds
  v_cndmask_b32_e64 v115, v115, 0, s[76:77]
  s_waitcnt lgkmcnt(6)
  v_cndmask_b32_e64 v116, v116, 0, s[74:75]
  v_cndmask_b32_e64 v117, v117, 0, s[74:75]
  s_waitcnt lgkmcnt(3)
  v_cndmask_b32_e64 v122, v122, 0, s[76:77]
  v_cndmask_b32_e64 v123, v123, 0, s[76:77]
  s_waitcnt lgkmcnt(0)
  v_cndmask_b32_e64 v124, v124, 0, s[74:75]
  v_cndmask_b32_e64 v125, v125, 0, s[74:75]
  v_mfma_f32_16x16x32_bf16 v[160:163], v[52:55], v[112:115], v[92:95]
  v_mfma_f32_16x16x32_bf16 v[164:167], v[56:59], v[112:115], v[96:99]
  v_mfma_f32_16x16x32_bf16 v[168:171], v[60:63], v[116:119], v[92:95]
  v_mfma_f32_16x16x32_bf16 v[172:175], v[64:67], v[116:119], v[96:99]
  s_add_u32 s73, s66, s72
  s_add_u32 s73, s73, 14336
  s_add_u32 m0, s58, 65536
  v_mfma_f32_16x16x32_bf16 v[176:179], v[68:71], v[120:123], v[92:95]
  buffer_load_dwordx4 v86, s[20:23], s73 offen sc1 lds
  v_mfma_f32_16x16x32_bf16 v[180:183], v[72:75], v[120:123], v[96:99]
  v_mfma_f32_16x16x32_bf16 v[184:187], v[76:79], v[124:127], v[92:95]
  v_mfma_f32_16x16x32_bf16 v[188:191], v[80:83], v[124:127], v[96:99]
  ds_read_b64_tr_b16 v[128:129], v89 offset:20480
  ds_read_b64_tr_b16 v[130:131], v89 offset:24576
  ds_read_b64_tr_b16 v[132:133], v89 offset:20992
  ds_read_b64_tr_b16 v[134:135], v89 offset:25088
  ds_read_b64_tr_b16 v[136:137], v89 offset:21248
  ds_read_b64_tr_b16 v[138:139], v89 offset:25344
  ds_read_b64_tr_b16 v[140:141], v89 offset:21760
  ds_read_b64_tr_b16 v[142:143], v89 offset:25856
  ds_read_b64_tr_b16 v[144:145], v89 offset:22272
  ds_read_b64_tr_b16 v[146:147], v89 offset:26368
  ds_read_b64_tr_b16 v[148:149], v89 offset:22784
  ds_read_b64_tr_b16 v[150:151], v89 offset:26880
  ds_read_b64_tr_b16 v[152:153], v89 offset:23040
  ds_read_b64_tr_b16 v[154:155], v89 offset:27136
  ds_read_b64_tr_b16 v[156:157], v89 offset:23552
  s_add_u32 s73, s67, s72
  s_add_u32 s73, s73, 14336
  s_add_u32 m0, s58, 69632
  s_waitcnt lgkmcnt(14)
  ds_read_b64_tr_b16 v[158:159], v89 offset:27648
  buffer_load_dwordx4 v86, s[20:23], s73 offen sc1 lds
  v_max3_f32 v50, v160, v161, v162
  v_max3_f32 v110, v168, v169, v170
  v_max3_f32 v192, v176, v177, v178
  v_max3_f32 v194, v184, v185, v186
  v_max3_f32 v50, v50, v163, v164
  v_max3_f32 v110, v110, v171, v172
  v_max3_f32 v192, v192, v179, v180
  v_max3_f32 v194, v194, v187, v188
  v_max3_f32 v50, v50, v165, v166
  v_max3_f32 v110, v110, v173, v174
  v_max3_f32 v192, v192, v181, v182
  v_max3_f32 v194, v194, v189, v190
  v_max_f32 v50, v50, v167
  v_max_f32 v110, v110, v175
  v_max_f32 v192, v192, v183
  v_max_f32 v194, v194, v191
  v_permlane32_swap_b32 v50, v110
  s_add_u32 s73, s68, s72
  s_add_u32 s73, s73, 14336
  s_add_u32 m0, s58, 73728
  v_permlane32_swap_b32 v192, v194
  buffer_load_dwordx4 v86, s[20:23], s73 offen sc1 lds
  v_max_f32 v50, v50, v110
  v_max_f32 v192, v192, v194
  s_nop 1
  v_permlane16_swap_b32 v50, v192
  v_max_f32 v50, v50, v192
  v_mul_f32 v50, s96, v50
  v_mov_b32 v192, v50
  s_nop 1
  v_permlane16_swap_b32 v50, v192
  v_mov_b32 v110, v50
  v_mov_b32 v194, v192
  s_nop 0
  v_permlane32_swap_b32 v50, v110
  v_permlane32_swap_b32 v192, v194
  v_mov_b32 v51, v50
  v_mov_b32 v111, v110
  v_mov_b32 v193, v192
  s_add_u32 s73, s65, s72
  s_add_u32 m0, s58, 98304
  v_mov_b32 v195, v194
  buffer_load_dwordx4 v86, s[20:23], s73 offen sc1 lds
  v_pk_fma_f32 v[160:161], v[160:161], s[94:95], v[50:51]
  v_pk_fma_f32 v[162:163], v[162:163], s[94:95], v[50:51]
  v_pk_fma_f32 v[164:165], v[164:165], s[94:95], v[50:51]
  v_pk_fma_f32 v[166:167], v[166:167], s[94:95], v[50:51]
  v_pk_fma_f32 v[168:169], v[168:169], s[94:95], v[110:111]
  v_pk_fma_f32 v[170:171], v[170:171], s[94:95], v[110:111]
  v_pk_fma_f32 v[172:173], v[172:173], s[94:95], v[110:111]
  v_pk_fma_f32 v[174:175], v[174:175], s[94:95], v[110:111]
  v_pk_fma_f32 v[176:177], v[176:177], s[94:95], v[192:193]
  v_pk_fma_f32 v[178:179], v[178:179], s[94:95], v[192:193]
  v_pk_fma_f32 v[180:181], v[180:181], s[94:95], v[192:193]
  v_pk_fma_f32 v[182:183], v[182:183], s[94:95], v[192:193]
  v_pk_fma_f32 v[184:185], v[184:185], s[94:95], v[194:195]
  v_pk_fma_f32 v[186:187], v[186:187], s[94:95], v[194:195]
  v_pk_fma_f32 v[188:189], v[188:189], s[94:95], v[194:195]
  v_pk_fma_f32 v[190:191], v[190:191], s[94:95], v[194:195]
  v_exp_f32 v160, v160
  s_add_u32 s73, s66, s72
  s_add_u32 m0, s58, 102400
  v_exp_f32 v161, v161
  buffer_load_dwordx4 v86, s[20:23], s73 offen sc1 lds
  v_exp_f32 v162, v162
  v_exp_f32 v163, v163
  v_exp_f32 v164, v164
  v_exp_f32 v165, v165
  v_exp_f32 v166, v166
  v_exp_f32 v167, v167
  v_cvt_pk_bf16_f32 v52, v160, v161
  v_cvt_pk_bf16_f32 v53, v162, v163
  v_cvt_pk_bf16_f32 v54, v164, v165
  v_cvt_pk_bf16_f32 v55, v166, v167
  v_exp_f32 v168, v168
  v_exp_f32 v169, v169
  s_add_u32 s73, s67, s72
  s_add_u32 m0, s58, 106496
  v_exp_f32 v170, v170
  buffer_load_dwordx4 v86, s[20:23], s73 offen sc1 lds
  v_exp_f32 v171, v171
  v_exp_f32 v172, v172
  v_exp_f32 v173, v173
  v_exp_f32 v174, v174
  v_exp_f32 v175, v175
  v_cvt_pk_bf16_f32 v60, v168, v169
  v_cvt_pk_bf16_f32 v61, v170, v171
  v_cvt_pk_bf16_f32 v62, v172, v173
  v_cvt_pk_bf16_f32 v63, v174, v175
  v_exp_f32 v176, v176
  v_exp_f32 v177, v177
  v_exp_f32 v178, v178
  s_add_u32 s73, s68, s72
  s_add_u32 m0, s58, 110592
  v_exp_f32 v179, v179
  buffer_load_dwordx4 v86, s[20:23], s73 offen sc1 lds
  v_exp_f32 v180, v180
  v_exp_f32 v181, v181
  v_exp_f32 v182, v182
  v_exp_f32 v183, v183
  v_cvt_pk_bf16_f32 v68, v176, v177
  v_cvt_pk_bf16_f32 v69, v178, v179
  v_cvt_pk_bf16_f32 v70, v180, v181
  v_cvt_pk_bf16_f32 v71, v182, v183
  v_exp_f32 v184, v184
  v_exp_f32 v185, v185
  v_exp_f32 v186, v186
  v_exp_f32 v187, v187
  s_add_u32 s73, s64, s72
  s_add_u32 s73, s73, 28672
  s_add_u32 m0, s58, 77824
  v_exp_f32 v188, v188
  buffer_load_dwordx4 v86, s[20:23], s73 offen sc1 lds
  v_exp_f32 v189, v189
  v_exp_f32 v190, v190
  v_exp_f32 v191, v191
  v_cvt_pk_bf16_f32 v76, v184, v185
  v_cvt_pk_bf16_f32 v77, v186, v187
  v_cvt_pk_bf16_f32 v78, v188, v189
  v_cvt_pk_bf16_f32 v79, v190, v191
  v_mfma_f32_16x16x32_bf16 v[200:203], v[196:199], v[52:55], 0
  s_waitcnt lgkmcnt(14)
  v_mfma_f32_16x16x32_bf16 v[56:59], v[128:131], v[52:55], 0
  s_waitcnt lgkmcnt(12)
  v_mfma_f32_16x16x32_bf16 v[112:115], v[132:135], v[52:55], 0
  s_add_u32 s73, s65, s72
  s_add_u32 s73, s73, 28672
  s_add_u32 m0, s58, 81920
  v_mfma_f32_16x16x32_bf16 v[204:207], v[196:199], v[60:63], 0
  buffer_load_dwordx4 v86, s[20:23], s73 offen sc1 lds
  s_waitcnt lgkmcnt(10)
  v_mfma_f32_16x16x32_bf16 v[64:67], v[136:139], v[60:63], 0
  s_waitcnt lgkmcnt(8)
  v_mfma_f32_16x16x32_bf16 v[116:119], v[140:143], v[60:63], 0
  v_mfma_f32_16x16x32_bf16 v[208:211], v[196:199], v[68:71], 0
  s_waitcnt lgkmcnt(6)
  v_mfma_f32_16x16x32_bf16 v[72:75], v[144:147], v[68:71], 0
  s_waitcnt lgkmcnt(4)
  v_mfma_f32_16x16x32_bf16 v[120:123], v[148:151], v[68:71], 0
  v_mfma_f32_16x16x32_bf16 v[212:215], v[196:199], v[76:79], 0
  s_waitcnt lgkmcnt(2)
  v_mfma_f32_16x16x32_bf16 v[80:83], v[152:155], v[76:79], 0
  s_add_u32 s73, s66, s72
  s_add_u32 s73, s73, 28672
  s_add_u32 m0, s58, 86016
  s_waitcnt lgkmcnt(0)
  v_mfma_f32_16x16x32_bf16 v[124:127], v[156:159], v[76:79], 0
  buffer_load_dwordx4 v86, s[20:23], s73 offen sc1 lds
  v_rcp_f32 v200, v200
  v_rcp_f32 v201, v201
  v_rcp_f32 v204, v204
  v_rcp_f32 v205, v205
  v_rcp_f32 v208, v208
  v_rcp_f32 v209, v209
  v_rcp_f32 v212, v212
  v_rcp_f32 v213, v213
  v_pk_mul_f32 v[56:57], v[56:57], v[200:201]
  v_pk_mul_f32 v[58:59], v[58:59], v[200:201]
  v_pk_mul_f32 v[112:113], v[112:113], v[200:201]
  v_pk_mul_f32 v[114:115], v[114:115], v[200:201]
  s_add_u32 s73, s67, s72
  s_add_u32 s73, s73, 28672
  s_add_u32 m0, s58, 90112
  v_pk_mul_f32 v[64:65], v[64:65], v[204:205]
  buffer_load_dwordx4 v86, s[20:23], s73 offen sc1 lds
  v_pk_mul_f32 v[66:67], v[66:67], v[204:205]
  v_pk_mul_f32 v[116:117], v[116:117], v[204:205]
  v_pk_mul_f32 v[118:119], v[118:119], v[204:205]
  v_pk_mul_f32 v[72:73], v[72:73], v[208:209]
  v_pk_mul_f32 v[74:75], v[74:75], v[208:209]
  v_pk_mul_f32 v[120:121], v[120:121], v[208:209]
  v_pk_mul_f32 v[122:123], v[122:123], v[208:209]
  v_pk_mul_f32 v[80:81], v[80:81], v[212:213]
  v_pk_mul_f32 v[82:83], v[82:83], v[212:213]
  v_pk_mul_f32 v[124:125], v[124:125], v[212:213]
  v_pk_mul_f32 v[126:127], v[126:127], v[212:213]
  v_cvt_pk_bf16_f32 v160, v56, v57
  v_cvt_pk_bf16_f32 v161, v58, v59
  v_cvt_pk_bf16_f32 v162, v112, v113
  v_cvt_pk_bf16_f32 v163, v114, v115
  v_cvt_pk_bf16_f32 v168, v64, v65
  v_cvt_pk_bf16_f32 v169, v66, v67
  s_add_u32 s73, s68, s72
  s_add_u32 s73, s73, 28672
  s_add_u32 m0, s58, 94208
  v_cvt_pk_bf16_f32 v170, v116, v117
  buffer_load_dwordx4 v86, s[20:23], s73 offen sc1 lds
  s_add_u32 s72, s72, 3584
  v_cvt_pk_bf16_f32 v171, v118, v119
  v_cvt_pk_bf16_f32 v176, v72, v73
  v_cvt_pk_bf16_f32 v177, v74, v75
  v_cvt_pk_bf16_f32 v178, v120, v121
  v_cvt_pk_bf16_f32 v179, v122, v123
  v_cvt_pk_bf16_f32 v184, v80, v81
  v_cvt_pk_bf16_f32 v185, v82, v83
  v_cvt_pk_bf16_f32 v186, v124, v125
  v_cvt_pk_bf16_f32 v187, v126, v127
  ds_write_b64 v100, v[160:161] offset:0
  ds_write_b64 v102, v[170:171] offset:1024
  ds_write_b64 v106, v[176:177] offset:1024
  ds_write_b64 v100, v[186:187] offset:3072
  s_mov_b64 exec, s[78:79]
  ds_write_b64 v106, v[168:169] offset:0
  ds_write_b64 v104, v[184:185] offset:2048
  s_mov_b64 exec, s[88:89]
  ds_write_b64 v104, v[162:163] offset:0
  ds_write_b64 v102, v[178:179] offset:2048
  s_mov_b64 exec, -1
  s_waitcnt vmcnt(0)
  s_barrier
  ds_read_b128 v[52:55], v88 offset:0
  ds_read_b128 v[56:59], v88 offset:4096
  ds_read_b128 v[112:115], v88 offset:40960
  ds_read_b128 v[60:63], v88 offset:768
  ds_read_b128 v[64:67], v88 offset:4864
  ds_read_b128 v[116:119], v88 offset:41728
  ds_read_b128 v[68:71], v88 offset:1792
  s_waitcnt lgkmcnt(14)
  ds_read_b128 v[72:75], v88 offset:5888
  s_waitcnt lgkmcnt(14)
  ds_read_b128 v[120:123], v88 offset:42752
  s_waitcnt lgkmcnt(14)
  ds_read_b128 v[76:79], v88 offset:2560
  s_waitcnt lgkmcnt(14)
  ds_read_b128 v[80:83], v88 offset:6656
  s_waitcnt lgkmcnt(14)
  ds_read_b128 v[124:127], v88 offset:43520
  s_waitcnt lgkmcnt(9)
  v_cndmask_b32_e64 v114, v114, 0, s[76:77]
  v_cndmask_b32_e64 v115, v115, 0, s[76:77]
  s_waitcnt lgkmcnt(6)
  v_cndmask_b32_e64 v116, v116, 0, s[74:75]
  v_cndmask_b32_e64 v117, v117, 0, s[74:75]
  s_waitcnt lgkmcnt(3)
  v_cndmask_b32_e64 v122, v122, 0, s[76:77]
  v_cndmask_b32_e64 v123, v123, 0, s[76:77]
  s_waitcnt lgkmcnt(0)
  v_cndmask_b32_e64 v124, v124, 0, s[74:75]
  v_cndmask_b32_e64 v125, v125, 0, s[74:75]
  v_mfma_f32_16x16x32_bf16 v[160:163], v[52:55], v[112:115], v[92:95]
  v_mfma_f32_16x16x32_bf16 v[164:167], v[56:59], v[112:115], v[96:99]
  v_mfma_f32_16x16x32_bf16 v[168:171], v[60:63], v[116:119], v[92:95]
  v_mfma_f32_16x16x32_bf16 v[172:175], v[64:67], v[116:119], v[96:99]
  v_mfma_f32_16x16x32_bf16 v[176:179], v[68:71], v[120:123], v[92:95]
  v_mfma_f32_16x16x32_bf16 v[180:183], v[72:75], v[120:123], v[96:99]
  v_mfma_f32_16x16x32_bf16 v[184:187], v[76:79], v[124:127], v[92:95]
  v_mfma_f32_16x16x32_bf16 v[188:191], v[80:83], v[124:127], v[96:99]
  ds_read_b64_tr_b16 v[128:129], v90 offset:20480
  ds_read_b64_tr_b16 v[130:131], v90 offset:24576
  ds_read_b64_tr_b16 v[132:133], v90 offset:20992
  ds_read_b64_tr_b16 v[134:135], v90 offset:25088
  ds_read_b64_tr_b16 v[136:137], v90 offset:21248
  ds_read_b64_tr_b16 v[138:139], v90 offset:25344
  ds_read_b64_tr_b16 v[140:141], v90 offset:21760
  ds_read_b64_tr_b16 v[142:143], v90 offset:25856
  ds_read_b64_tr_b16 v[144:145], v90 offset:22272
  ds_read_b64_tr_b16 v[146:147], v90 offset:26368
  ds_read_b64_tr_b16 v[148:149], v90 offset:22784
  ds_read_b64_tr_b16 v[150:151], v90 offset:26880
  ds_read_b64_tr_b16 v[152:153], v90 offset:23040
  ds_read_b64_tr_b16 v[154:155], v90 offset:27136
  ds_read_b64_tr_b16 v[156:157], v90 offset:23552
  s_waitcnt lgkmcnt(14)
  ds_read_b64_tr_b16 v[158:159], v90 offset:27648
  v_max3_f32 v50, v160, v161, v162
  v_max3_f32 v110, v168, v169, v170
  v_max3_f32 v192, v176, v177, v178
  v_max3_f32 v194, v184, v185, v186
  v_max3_f32 v50, v50, v163, v164
  v_max3_f32 v110, v110, v171, v172
  v_max3_f32 v192, v192, v179, v180
  v_max3_f32 v194, v194, v187, v188
  v_max3_f32 v50, v50, v165, v166
  v_max3_f32 v110, v110, v173, v174
  v_max3_f32 v192, v192, v181, v182
  v_max3_f32 v194, v194, v189, v190
  v_max_f32 v50, v50, v167
  v_max_f32 v110, v110, v175
  v_max_f32 v192, v192, v183
  v_max_f32 v194, v194, v191
  v_permlane32_swap_b32 v50, v110
  s_nop 0
  v_permlane32_swap_b32 v192, v194
  v_max_f32 v50, v50, v110
  v_max_f32 v192, v192, v194
  s_nop 1
  v_permlane16_swap_b32 v50, v192
  v_max_f32 v50, v50, v192
  v_mul_f32 v50, s96, v50
  v_mov_b32 v192, v50
  s_nop 1
  v_permlane16_swap_b32 v50, v192
  v_mov_b32 v110, v50
  v_mov_b32 v194, v192
  s_nop 0
  v_permlane32_swap_b32 v50, v110
  v_permlane32_swap_b32 v192, v194
  v_mov_b32 v51, v50
  v_mov_b32 v111, v110
  v_mov_b32 v193, v192
  v_mov_b32 v195, v194
  v_pk_fma_f32 v[160:161], v[160:161], s[94:95], v[50:51]
  v_pk_fma_f32 v[162:163], v[162:163], s[94:95], v[50:51]
  v_pk_fma_f32 v[164:165], v[164:165], s[94:95], v[50:51]
  v_pk_fma_f32 v[166:167], v[166:167], s[94:95], v[50:51]
  v_pk_fma_f32 v[168:169], v[168:169], s[94:95], v[110:111]
  v_pk_fma_f32 v[170:171], v[170:171], s[94:95], v[110:111]
  v_pk_fma_f32 v[172:173], v[172:173], s[94:95], v[110:111]
  v_pk_fma_f32 v[174:175], v[174:175], s[94:95], v[110:111]
  v_pk_fma_f32 v[176:177], v[176:177], s[94:95], v[192:193]
  v_pk_fma_f32 v[178:179], v[178:179], s[94:95], v[192:193]
  v_pk_fma_f32 v[180:181], v[180:181], s[94:95], v[192:193]
  v_pk_fma_f32 v[182:183], v[182:183], s[94:95], v[192:193]
  v_pk_fma_f32 v[184:185], v[184:185], s[94:95], v[194:195]
  v_pk_fma_f32 v[186:187], v[186:187], s[94:95], v[194:195]
  v_pk_fma_f32 v[188:189], v[188:189], s[94:95], v[194:195]
  v_pk_fma_f32 v[190:191], v[190:191], s[94:95], v[194:195]
  v_exp_f32 v160, v160
  v_exp_f32 v161, v161
  v_exp_f32 v162, v162
  v_exp_f32 v163, v163
  v_exp_f32 v164, v164
  v_exp_f32 v165, v165
  v_exp_f32 v166, v166
  v_exp_f32 v167, v167
  v_cvt_pk_bf16_f32 v52, v160, v161
  v_cvt_pk_bf16_f32 v53, v162, v163
  v_cvt_pk_bf16_f32 v54, v164, v165
  v_cvt_pk_bf16_f32 v55, v166, v167
  v_exp_f32 v168, v168
  v_exp_f32 v169, v169
  v_exp_f32 v170, v170
  v_exp_f32 v171, v171
  v_exp_f32 v172, v172
  v_exp_f32 v173, v173
  v_exp_f32 v174, v174
  v_exp_f32 v175, v175
  v_cvt_pk_bf16_f32 v60, v168, v169
  v_cvt_pk_bf16_f32 v61, v170, v171
  v_cvt_pk_bf16_f32 v62, v172, v173
  v_cvt_pk_bf16_f32 v63, v174, v175
  v_exp_f32 v176, v176
  v_exp_f32 v177, v177
  v_exp_f32 v178, v178
  v_exp_f32 v179, v179
  v_exp_f32 v180, v180
  v_exp_f32 v181, v181
  v_exp_f32 v182, v182
  v_exp_f32 v183, v183
  v_cvt_pk_bf16_f32 v68, v176, v177
  v_cvt_pk_bf16_f32 v69, v178, v179
  v_cvt_pk_bf16_f32 v70, v180, v181
  v_cvt_pk_bf16_f32 v71, v182, v183
  v_exp_f32 v184, v184
  v_exp_f32 v185, v185
  v_exp_f32 v186, v186
  v_exp_f32 v187, v187
  v_exp_f32 v188, v188
  v_exp_f32 v189, v189
  v_exp_f32 v190, v190
  v_exp_f32 v191, v191
  v_cvt_pk_bf16_f32 v76, v184, v185
  v_cvt_pk_bf16_f32 v77, v186, v187
  v_cvt_pk_bf16_f32 v78, v188, v189
  v_cvt_pk_bf16_f32 v79, v190, v191
  v_mfma_f32_16x16x32_bf16 v[200:203], v[196:199], v[52:55], 0
  s_waitcnt lgkmcnt(14)
  v_mfma_f32_16x16x32_bf16 v[56:59], v[128:131], v[52:55], 0
  s_waitcnt lgkmcnt(12)
  v_mfma_f32_16x16x32_bf16 v[112:115], v[132:135], v[52:55], 0
  v_mfma_f32_16x16x32_bf16 v[204:207], v[196:199], v[60:63], 0
  s_waitcnt lgkmcnt(10)
  v_mfma_f32_16x16x32_bf16 v[64:67], v[136:139], v[60:63], 0
  s_waitcnt lgkmcnt(8)
  v_mfma_f32_16x16x32_bf16 v[116:119], v[140:143], v[60:63], 0
  v_mfma_f32_16x16x32_bf16 v[208:211], v[196:199], v[68:71], 0
  s_waitcnt lgkmcnt(6)
  v_mfma_f32_16x16x32_bf16 v[72:75], v[144:147], v[68:71], 0
  s_waitcnt lgkmcnt(4)
  v_mfma_f32_16x16x32_bf16 v[120:123], v[148:151], v[68:71], 0
  v_mfma_f32_16x16x32_bf16 v[212:215], v[196:199], v[76:79], 0
  s_waitcnt lgkmcnt(2)
  v_mfma_f32_16x16x32_bf16 v[80:83], v[152:155], v[76:79], 0
  s_waitcnt lgkmcnt(0)
  v_mfma_f32_16x16x32_bf16 v[124:127], v[156:159], v[76:79], 0
  v_rcp_f32 v200, v200
  v_rcp_f32 v201, v201
  v_rcp_f32 v204, v204
  v_rcp_f32 v205, v205
  v_rcp_f32 v208, v208
  v_rcp_f32 v209, v209
  v_rcp_f32 v212, v212
  v_rcp_f32 v213, v213
  v_pk_mul_f32 v[56:57], v[56:57], v[200:201]
  v_pk_mul_f32 v[58:59], v[58:59], v[200:201]
  v_pk_mul_f32 v[112:113], v[112:113], v[200:201]
  v_pk_mul_f32 v[114:115], v[114:115], v[200:201]
  v_pk_mul_f32 v[64:65], v[64:65], v[204:205]
  v_pk_mul_f32 v[66:67], v[66:67], v[204:205]
  v_pk_mul_f32 v[116:117], v[116:117], v[204:205]
  v_pk_mul_f32 v[118:119], v[118:119], v[204:205]
  v_pk_mul_f32 v[72:73], v[72:73], v[208:209]
  v_pk_mul_f32 v[74:75], v[74:75], v[208:209]
  v_pk_mul_f32 v[120:121], v[120:121], v[208:209]
  v_pk_mul_f32 v[122:123], v[122:123], v[208:209]
  v_pk_mul_f32 v[80:81], v[80:81], v[212:213]
  v_pk_mul_f32 v[82:83], v[82:83], v[212:213]
  v_pk_mul_f32 v[124:125], v[124:125], v[212:213]
  v_pk_mul_f32 v[126:127], v[126:127], v[212:213]
  v_cvt_pk_bf16_f32 v160, v56, v57
  v_cvt_pk_bf16_f32 v161, v58, v59
  v_cvt_pk_bf16_f32 v162, v112, v113
  v_cvt_pk_bf16_f32 v163, v114, v115
  v_cvt_pk_bf16_f32 v168, v64, v65
  v_cvt_pk_bf16_f32 v169, v66, v67
  v_cvt_pk_bf16_f32 v170, v116, v117
  v_cvt_pk_bf16_f32 v171, v118, v119
  v_cvt_pk_bf16_f32 v176, v72, v73
  v_cvt_pk_bf16_f32 v177, v74, v75
  v_cvt_pk_bf16_f32 v178, v120, v121
  v_cvt_pk_bf16_f32 v179, v122, v123
  v_cvt_pk_bf16_f32 v184, v80, v81
  v_cvt_pk_bf16_f32 v185, v82, v83
  v_cvt_pk_bf16_f32 v186, v124, v125
  v_cvt_pk_bf16_f32 v187, v126, v127
  ds_write_b64 v104, v[160:161] offset:3072
  ds_write_b64 v106, v[170:171] offset:4096
  ds_write_b64 v102, v[176:177] offset:5120
  ds_write_b64 v104, v[186:187] offset:6144
  s_mov_b64 exec, s[78:79]
  ds_write_b64 v102, v[168:169] offset:4096
  ds_write_b64 v100, v[184:185] offset:6144
  s_mov_b64 exec, s[88:89]
  ds_write_b64 v100, v[162:163] offset:4096
  ds_write_b64 v106, v[178:179] offset:5120
  s_mov_b64 exec, -1
  s_waitcnt lgkmcnt(0)
  s_barrier
  ds_read_b128 v[216:219], v109 offset:0
  ds_read_b128 v[220:223], v109 offset:1024
  ds_read_b128 v[224:227], v109 offset:2048
  ds_read_b128 v[228:231], v109 offset:3072
  ds_read_b128 v[232:235], v109 offset:4096
  ds_read_b128 v[236:239], v109 offset:5120
  ds_read_b128 v[240:243], v109 offset:6144
  s_add_u32 s93, s93, 3072
  s_waitcnt lgkmcnt(6)
  buffer_store_dwordx4 v[216:219], v85, s[20:23], s93 offen offset:0 sc1
  s_waitcnt lgkmcnt(5)
  buffer_store_dwordx4 v[220:223], v85, s[20:23], s93 offen offset:1024 sc1
  s_waitcnt lgkmcnt(4)
  buffer_store_dwordx4 v[224:227], v85, s[20:23], s93 offen offset:2048 sc1
  s_waitcnt lgkmcnt(3)
  buffer_store_dwordx4 v[228:231], v85, s[20:23], s93 offen offset:3072 sc1
  s_add_u32 s93, s93, 4096
  s_waitcnt lgkmcnt(2)
  buffer_store_dwordx4 v[232:235], v85, s[20:23], s93 offen offset:0 sc1
  s_waitcnt lgkmcnt(1)
  buffer_store_dwordx4 v[236:239], v85, s[20:23], s93 offen offset:1024 sc1
  s_waitcnt lgkmcnt(0)
  buffer_store_dwordx4 v[240:243], v85, s[20:23], s93 offen offset:2048 sc1
  s_waitcnt vmcnt(0)
  s_lshl_b32 s60, s53, 7
  s_lshl_b32 s61, s52, 2
  s_add_u32 s60, s60, s61
  s_add_u32 s60, s60, 12288
  s_mov_b64 exec, 1
  buffer_store_dword v84, off, s[20:23], s60 sc1
  s_mov_b64 exec, -1
  s_endpgm
L_end:
  s_endpgm
.Lcode_end:
.section .rodata,"a"
.p2align 6
.amdhsa_kernel gated_mix__sliding_local_dilated__mixer_gmlp__prompt_kernel
  .amdhsa_next_free_vgpr 512
  .amdhsa_next_free_sgpr 102
  .amdhsa_accum_offset 256
  .amdhsa_group_segment_fixed_size 0
  .amdhsa_kernarg_size 96
  .amdhsa_user_sgpr_count 2
  .amdhsa_user_sgpr_kernarg_segment_ptr 1
  .amdhsa_system_sgpr_workgroup_id_x 1
.end_amdhsa_kernel
```
